```python
import torch

def _softmax(x, axis=-1):
    return torch.softmax(x, dim=axis)
def _gelu(x):
    return torch.nn.functional.gelu(x, approximate="tanh")
def _silu(x):
    return torch.nn.functional.silu(x)
def _sigmoid(x):
    return torch.sigmoid(x)
def _layernorm(x, axis=-1, eps=1e-5):
    m = x.mean(dim=axis, keepdim=True)
    v = x.var(dim=axis, keepdim=True, unbiased=False)
    return (x - m) / torch.sqrt(v + eps)
def _scatter_add(tgt, idx, src, axis=0):
    return tgt.clone().index_add_(axis, idx, src)
def _segment_sum(src, seg, n):
    out = torch.zeros((n,) + src.shape[1:], dtype=src.dtype)
    return out.index_add_(0, seg, src)
def _pad(x, pw):
    flat = tuple(v for pair in reversed(pw) for v in pair)
    return torch.nn.functional.pad(x, flat)

kernel_name = 'sequential_preLN__compressed_kv_cla__dense_activation_squared_relu__prompt'

def setup_inputs():

    _w = (lambda a: (lambda t: t.to(torch.bfloat16) if t.is_floating_point() else t)(torch.as_tensor(a)))
    def _A_setup():
        B, H, Sq, Sk, D, M = 1, 32, 2048, 2048, 128, 512
        Dc = 4 * D
        return {
            "x": _w((lambda *s: torch.randn(*s, dtype=torch.bfloat16) * 0.05)(B, Sq, M)),
            "c_kv": _w((lambda *s: torch.randn(*s, dtype=torch.bfloat16) * 0.4)(B, Sk, Dc)),
            "w_q": _w((lambda *s: torch.randn(*s, dtype=torch.bfloat16) * 3.2)(M, H, D) * (M ** -0.5)),
            "w_uk": _w((lambda *s: torch.randn(*s, dtype=torch.bfloat16) * 3.2)(Dc, H, D) * (Dc ** -0.5)),
            "w_uv": _w((lambda *s: torch.randn(*s, dtype=torch.bfloat16) * 0.4)(Dc, H, D) * (Dc ** -0.5)),
            "w_o": _w((lambda *s: torch.randn(*s, dtype=torch.bfloat16) * 0.4)(H, D, M) * ((H * D) ** -0.5)),
        }
    _A_in = _A_setup()

    def _B_setup():
        B, S, D, F = 1, 2048, 512, 1792
        return {
            "x": _w((lambda *s: torch.randn(*s, dtype=torch.bfloat16) * 0.05)(B, S, D)),
            "w1": _w((lambda *s: torch.randn(*s, dtype=torch.bfloat16) * 0.05)(D, F)),
            "b1": _w((lambda *s: torch.randn(*s, dtype=torch.bfloat16) * 0.4)(F)),
            "w2": _w((lambda *s: torch.randn(*s, dtype=torch.bfloat16) * 0.05)(F, D)),
            "b2": _w((lambda *s: torch.randn(*s, dtype=torch.bfloat16) * 1.6)(D)),
        }
    _B_in = _B_setup()

    return {
        "A_x": _A_in["x"],
        "A_c_kv": _A_in["c_kv"],
        "A_w_q": _A_in["w_q"],
        "A_w_uk": _A_in["w_uk"],
        "A_w_uv": _A_in["w_uv"],
        "A_w_o": _A_in["w_o"],
        "B_x": _B_in["x"],
        "B_w1": _B_in["w1"],
        "B_b1": _B_in["b1"],
        "B_w2": _B_in["w2"],
        "B_b2": _B_in["b2"],
    }

def reference(A_x, A_c_kv, A_w_q, A_w_uk, A_w_uv, A_w_o, B_x, B_w1, B_b1, B_w2, B_b2):
    def _A_ref(x, c_kv, w_q, w_uk, w_uv, w_o):
        B, Sq, M = x.shape[0], x.shape[1], x.shape[2]
        Sk = c_kv.shape[1]
        H, D = w_q.shape[1], w_q.shape[2]
        q = torch.einsum("bqm,mhd->bhqd", x, w_q)
        k = torch.einsum("bkc,chd->bhkd", c_kv, w_uk)
        v = torch.einsum("bkc,chd->bhkd", c_kv, w_uv)
        scores = torch.einsum("bhqd,bhkd->bhqk", q, k) * (D ** -0.5)
        off = Sk - Sq
        qi = torch.arange(Sq)[:, None]
        kj = torch.arange(Sk)[None, :]
        cmask = kj <= (qi + off)
        scores = torch.where(cmask[None, None], scores, -1e9)
        p = _softmax(scores, axis=-1)
        ctx = torch.einsum("bhqk,bhkd->bhqd", p, v)
        return torch.einsum("bhqd,hdm->bqm", ctx, w_o)

    def _B_ref(x, w1, b1, w2, b2):
        h = torch.einsum("bsd,df->bsf", x, w1) + b1
        zero = torch.zeros_like(h)
        r = torch.where(h > zero, h, zero)
        h = r * r
        out = torch.einsum("bsf,fd->bsd", h, w2) + b2
        return out

    x = A_x
    h = x + _A_ref(_layernorm(x, axis=-1), A_c_kv, A_w_q, A_w_uk, A_w_uv, A_w_o)
    h2 = h + _B_ref(_layernorm(h, axis=-1), B_w1, B_b1, B_w2, B_b2)
    return h2
```

```asm
; @launch grid=(256,1,1) block=(512,1,1) lds=147456
.amdgcn_target "amdgcn-amd-amdhsa--gfx950"
.text
.globl sequential_preLN__compressed_kv_cla__dense_activation_squared_relu__prompt_kernel
.p2align 8
.type sequential_preLN__compressed_kv_cla__dense_activation_squared_relu__prompt_kernel,@function
sequential_preLN__compressed_kv_cla__dense_activation_squared_relu__prompt_kernel:
  s_cmp_ge_u32 s2, 256
  s_cbranch_scc1 sequential_preLN__compressed_kv_cla__dense_activation_squared_relu__prompt_kernel_end
  s_load_dwordx4 s[4:7], s[0:1], 0
  s_load_dwordx4 s[12:15], s[0:1], 24
  s_load_dwordx2 s[24:25], s[0:1], 104
  s_load_dwordx2 s[20:21], s[0:1], 16
  s_load_dwordx2 s[72:73], s[0:1], 96
  v_lshrrev_b32 v10, 6, v0
  v_mov_b32 v127, v0
  v_readfirstlane_b32 s30, v10
  v_and_b32 v0, 63, v0
  v_and_b32 v125, 15, v0
  v_lshrrev_b32 v126, 4, v0
  s_and_b32 s28, s2, 31
  s_lshr_b32 s29, s2, 5
  s_lshr_b32 s31, s28, 3
  s_lshl_b32 s31, s31, 1
  s_add_u32 s34, s31, s29
  s_and_b32 s34, s34, 7
  s_lshr_b32 s31, s28, 3
  s_add_u32 s34, s31, s29
  s_and_b32 s34, s34, 1
  s_lshl_b32 s34, s34, 2
  v_bfe_u32 v10, v0, 2, 2
  v_bfe_u32 v11, v0, 4, 1
  v_lshl_add_u32 v10, v11, 2, v10
  v_lshlrev_b32 v10, 13, v10
  s_and_b32 s31, s30, 1
  s_lshl_b32 s31, s31, 1
  v_and_b32 v11, 3, v0
  v_xor_b32 v11, s31, v11
  v_lshrrev_b32 v1, 5, v0
  v_lshl_add_u32 v11, v1, 2, v11
  v_lshl_add_u32 v1, v11, 4, v10
  v_lshrrev_b32 v10, 3, v0
  v_lshrrev_b32 v11, 1, v10
  v_and_b32 v2, 7, v0
  v_xor_b32 v2, v2, v11
  v_lshlrev_b32 v2, 4, v2
  v_lshl_add_u32 v2, v10, 10, v2
  v_xor_b32 v3, 64, v2
  s_waitcnt lgkmcnt(0)
  s_mov_b32 s8, s6
  s_mov_b32 s9, s7
  s_mov_b32 s16, s14
  s_mov_b32 s17, s15
  s_mov_b32 s6, 0x200000
  s_mov_b32 s7, 0x20000
  s_mov_b32 s10, 0x200000
  s_mov_b32 s11, 0x20000
  s_mov_b32 s14, 0x400000
  s_mov_b32 s15, 0x20000
  s_mov_b32 s18, 0x400000
  s_mov_b32 s19, 0x20000
  s_mov_b32 s26, 0x10000000
  s_mov_b32 s27, 0x20000
  s_mov_b32 s22, 0x400000
  s_mov_b32 s23, 0x20000
  s_mov_b32 s74, 0x100
  s_mov_b32 s75, 0x20000
  s_lshl_b32 s35, s30, 16
  s_lshl_b32 s31, s28, 8
  s_add_u32 s35, s35, s31
  s_lshl_b32 s40, s30, 10
  s_lshl_b32 s39, s29, 18
  s_lshl_b32 s31, s30, 15
  s_add_u32 s39, s39, s31
  s_lshl_b32 s41, s30, 13
  s_add_u32 s41, s41, 65536
  s_add_u32 s32, s34, 0
  s_and_b32 s32, s32, 7
  s_lshl_b32 s32, s32, 7
  s_add_u32 s32, s32, s39
  s_add_u32 m0, s41, 0
  s_nop 0
  buffer_load_dwordx4 v2, s[8:11], s32 offen lds
  s_add_u32 s32, s32, 8192
  s_add_u32 m0, s41, 1024
  s_nop 0
  buffer_load_dwordx4 v3, s[8:11], s32 offen lds
  s_add_u32 s32, s32, 8192
  s_add_u32 m0, s41, 2048
  s_nop 0
  buffer_load_dwordx4 v2, s[8:11], s32 offen lds
  s_add_u32 s32, s32, 8192
  s_add_u32 m0, s41, 3072
  s_nop 0
  buffer_load_dwordx4 v3, s[8:11], s32 offen lds
  s_add_u32 s31, s34, 0
  s_and_b32 s31, s31, 7
  s_lshl_b32 s31, s31, 19
  s_add_u32 m0, s40, 0
  s_add_u32 s31, s31, s35
  buffer_load_dwordx4 v1, s[12:15], s31 offen lds
  s_add_u32 s31, s34, 0
  s_and_b32 s31, s31, 7
  s_lshl_b32 s31, s31, 19
  s_add_u32 m0, s40, 8192
  s_add_u32 s31, s31, s35
  s_add_u32 s31, s31, 128
  buffer_load_dwordx4 v1, s[12:15], s31 offen lds
  s_add_u32 s32, s34, 1
  s_and_b32 s32, s32, 7
  s_lshl_b32 s32, s32, 7
  s_add_u32 s32, s32, s39
  s_add_u32 m0, s41, 4096
  s_nop 0
  buffer_load_dwordx4 v2, s[8:11], s32 offen lds
  s_add_u32 s32, s32, 8192
  s_add_u32 m0, s41, 5120
  s_nop 0
  buffer_load_dwordx4 v3, s[8:11], s32 offen lds
  s_add_u32 s32, s32, 8192
  s_add_u32 m0, s41, 6144
  s_nop 0
  buffer_load_dwordx4 v2, s[8:11], s32 offen lds
  s_add_u32 s32, s32, 8192
  s_add_u32 m0, s41, 7168
  s_nop 0
  buffer_load_dwordx4 v3, s[8:11], s32 offen lds
  s_add_u32 s31, s34, 1
  s_and_b32 s31, s31, 7
  s_lshl_b32 s31, s31, 19
  s_add_u32 m0, s40, 16384
  s_add_u32 s31, s31, s35
  buffer_load_dwordx4 v1, s[12:15], s31 offen lds
  s_add_u32 s31, s34, 1
  s_and_b32 s31, s31, 7
  s_lshl_b32 s31, s31, 19
  s_add_u32 m0, s40, 24576
  s_add_u32 s31, s31, s35
  s_add_u32 s31, s31, 128
  buffer_load_dwordx4 v1, s[12:15], s31 offen lds
  s_lshl_b32 s31, s2, 3
  s_add_u32 s31, s31, s30
  s_lshl_b32 s31, s31, 10
  v_lshlrev_b32 v10, 4, v0
  buffer_load_dwordx4 v[96:99], v10, s[4:7], s31 offen
  s_getpc_b64 s[62:63]
sequential_preLN__compressed_kv_cla__dense_activation_squared_relu__prompt_kernel_pc:
  s_sub_u32 s62, s62, sequential_preLN__compressed_kv_cla__dense_activation_squared_relu__prompt_kernel_pc - sequential_preLN__compressed_kv_cla__dense_activation_squared_relu__prompt_kernel
  s_subb_u32 s63, s63, 0
  s_lshr_b32 s31, s2, 3
  s_lshl_b32 s31, s31, 3
  s_add_u32 s31, s31, s30
  s_lshl_b32 s31, s31, 8
  v_lshl_add_u32 v11, v0, 2, s31
  s_mov_b32 s31, all_code_end - sequential_preLN__compressed_kv_cla__dense_activation_squared_relu__prompt_kernel - 4
  v_min_u32 v11, s31, v11
  global_load_dword v124, v11, s[62:63]
  s_lshr_b32 s57, s30, 2
  s_sub_u32 s31, 15, s29
  s_lshl_b32 s46, s31, 1
  s_add_u32 s46, s46, 2
  s_sub_u32 s32, 7, s30
  s_cmp_eq_u32 s57, 0
  s_cselect_b32 s31, s31, s29
  s_cselect_b32 s32, s30, s32
  s_lshl_b32 s45, s31, 1
  s_lshr_b32 s33, s32, 1
  s_add_u32 s45, s45, s33
  s_add_u32 s45, s45, 1
  s_lshl_b32 s54, s31, 2
  s_add_u32 s54, s54, s32
  s_sub_u32 s55, s45, 3
  s_and_b32 s53, s30, 3
  s_lshl_b32 s44, s54, 15
  s_add_u32 s44, s44, 0x3600000
  s_mul_i32 s64, s28, 524288
  s_lshl_b32 s31, s53, 12
  s_add_u32 s64, s64, s31
  s_mov_b32 s61, 0x7ff00000
  s_mov_b32 s60, 0x53800000
  s_lshl_b32 s69, s2, 7
  s_add_u32 s69, s69, 0x5200000
  v_mov_b32 v11, 0
  s_mov_b64 exec, 1
  buffer_store_dword v11, off, s[24:27], s69 sc1
  s_mov_b64 exec, -1
  s_lshl_b32 s69, s2, 7
  s_add_u32 s69, s69, 0x5230000
  v_mov_b32 v11, 0
  s_mov_b64 exec, 1
  buffer_store_dword v11, off, s[24:27], s69 sc1
  s_mov_b64 exec, -1
  s_lshl_b32 s69, s2, 7
  s_add_u32 s69, s69, 0x5210000
  v_mov_b32 v11, 0
  s_mov_b64 exec, 1
  buffer_store_dword v11, off, s[24:27], s69 sc1
  s_mov_b64 exec, -1
  s_lshl_b32 s69, s2, 7
  s_add_u32 s69, s69, 0x5220000
  v_mov_b32 v11, 0
  s_mov_b64 exec, 1
  buffer_store_dword v11, off, s[24:27], s69 sc1
  s_mov_b64 exec, -1
  s_lshl_b32 s69, s2, 7
  s_add_u32 s69, s69, 0x5240000
  v_mov_b32 v11, 0
  s_mov_b64 exec, 1
  buffer_store_dword v11, off, s[24:27], s69 sc1
  s_mov_b64 exec, -1
  v_bfe_u32 v10, v0, 2, 2
  v_lshlrev_b32 v10, 6, v10
  v_and_b32 v11, 3, v0
  v_lshl_add_u32 v10, v11, 3, v10
  v_lshl_add_u32 v10, v126, 10, v10
  v_and_b32 v11, 1, v126
  v_lshl_add_u32 v4, v11, 5, v10
  v_xor_b32 v5, 32, v4
  v_lshrrev_b32 v10, 1, v125
  v_xor_b32 v10, v10, v126
  v_lshlrev_b32 v10, 4, v10
  v_lshl_add_u32 v10, v125, 7, v10
  v_add_u32 v6, s41, v10
  v_xor_b32 v7, 64, v6
  v_and_b32 v10, 1, v126
  v_lshlrev_b32 v8, 10, v10
  v_lshrrev_b32 v10, 1, v126
  v_lshl_add_u32 v8, v10, 9, v8
  v_lshrrev_b32 v10, 3, v125
  v_lshl_add_u32 v8, v10, 8, v8
  v_and_b32 v10, 7, v125
  v_lshl_add_u32 v8, v10, 4, v8
  v_lshrrev_b32 v10, 1, v126
  v_lshlrev_b32 v9, 12, v10
  v_and_b32 v10, 1, v126
  v_lshl_add_u32 v9, v10, 9, v9
  v_lshl_add_u32 v9, v125, 4, v9
  s_mul_i32 s36, s28, 524288
  s_lshl_b32 s31, s29, 16
  s_add_u32 s36, s36, s31
  s_lshl_b32 s31, s30, 13
  s_add_u32 s36, s36, s31
  s_add_u32 s37, s36, 0x1200000
  s_waitcnt vmcnt(13)
  ds_read_b128 v[128:131], v6 offset:0
  ds_read_b128 v[132:135], v6 offset:2048
  ds_read_b128 v[136:139], v7 offset:0
  ds_read_b128 v[140:143], v7 offset:2048
  s_barrier
  ds_read_b64_tr_b16 v[12:13], v4 offset:0
  ds_read_b64_tr_b16 v[14:15], v4 offset:256
  ds_read_b64_tr_b16 v[16:17], v5 offset:0
  ds_read_b64_tr_b16 v[18:19], v5 offset:256
  ds_read_b64_tr_b16 v[20:21], v4 offset:512
  ds_read_b64_tr_b16 v[22:23], v4 offset:768
  ds_read_b64_tr_b16 v[24:25], v5 offset:512
  ds_read_b64_tr_b16 v[26:27], v5 offset:768
  ds_read_b64_tr_b16 v[28:29], v4 offset:8192
  ds_read_b64_tr_b16 v[30:31], v4 offset:8448
  s_waitcnt lgkmcnt(8)
  v_mfma_f32_16x16x32_bf16 v[32:35], v[12:15], v[128:131], 0
  v_mfma_f32_16x16x32_bf16 v[40:43], v[12:15], v[132:135], 0
  ds_read_b64_tr_b16 v[12:13], v5 offset:8192
  ds_read_b64_tr_b16 v[14:15], v5 offset:8448
  s_waitcnt lgkmcnt(8)
  v_mfma_f32_16x16x32_bf16 v[36:39], v[16:19], v[128:131], 0
  v_mfma_f32_16x16x32_bf16 v[44:47], v[16:19], v[132:135], 0
  s_add_u32 s31, s34, 2
  s_and_b32 s31, s31, 7
  s_lshl_b32 s31, s31, 19
  s_add_u32 m0, s40, 32768
  s_add_u32 s31, s31, s35
  buffer_load_dwordx4 v1, s[12:15], s31 offen lds
  ds_read_b64_tr_b16 v[16:17], v4 offset:8704
  ds_read_b64_tr_b16 v[18:19], v4 offset:8960
  s_waitcnt lgkmcnt(8)
  v_mfma_f32_16x16x32_bf16 v[48:51], v[20:23], v[128:131], 0
  v_mfma_f32_16x16x32_bf16 v[56:59], v[20:23], v[132:135], 0
  s_add_u32 s31, s34, 2
  s_and_b32 s31, s31, 7
  s_lshl_b32 s31, s31, 19
  s_add_u32 m0, s40, 40960
  s_add_u32 s31, s31, s35
  s_add_u32 s31, s31, 128
  buffer_load_dwordx4 v1, s[12:15], s31 offen lds
  ds_read_b64_tr_b16 v[20:21], v5 offset:8704
  ds_read_b64_tr_b16 v[22:23], v5 offset:8960
  s_waitcnt lgkmcnt(8)
  v_mfma_f32_16x16x32_bf16 v[52:55], v[24:27], v[128:131], 0
  v_mfma_f32_16x16x32_bf16 v[60:63], v[24:27], v[132:135], 0
  s_add_u32 s31, s34, 3
  s_and_b32 s31, s31, 7
  s_lshl_b32 s31, s31, 19
  s_add_u32 m0, s40, 49152
  s_add_u32 s31, s31, s35
  buffer_load_dwordx4 v1, s[12:15], s31 offen lds
  ds_read_b64_tr_b16 v[24:25], v4 offset:4096
  ds_read_b64_tr_b16 v[26:27], v4 offset:4352
  s_waitcnt lgkmcnt(8)
  v_mfma_f32_16x16x32_bf16 v[64:67], v[28:31], v[128:131], 0
  v_mfma_f32_16x16x32_bf16 v[72:75], v[28:31], v[132:135], 0
  s_add_u32 s31, s34, 3
  s_and_b32 s31, s31, 7
  s_lshl_b32 s31, s31, 19
  s_add_u32 m0, s40, 57344
  s_add_u32 s31, s31, s35
  s_add_u32 s31, s31, 128
  buffer_load_dwordx4 v1, s[12:15], s31 offen lds
  ds_read_b64_tr_b16 v[28:29], v5 offset:4096
  ds_read_b64_tr_b16 v[30:31], v5 offset:4352
  s_waitcnt lgkmcnt(8)
  v_mfma_f32_16x16x32_bf16 v[68:71], v[12:15], v[128:131], 0
  v_mfma_f32_16x16x32_bf16 v[76:79], v[12:15], v[132:135], 0
  s_add_u32 s32, s34, 2
  s_and_b32 s32, s32, 7
  s_lshl_b32 s32, s32, 7
  s_add_u32 s32, s32, s39
  s_add_u32 m0, s41, 0
  s_nop 0
  buffer_load_dwordx4 v2, s[8:11], s32 offen lds
  ds_read_b64_tr_b16 v[12:13], v4 offset:4608
  ds_read_b64_tr_b16 v[14:15], v4 offset:4864
  s_waitcnt lgkmcnt(8)
  v_mfma_f32_16x16x32_bf16 v[80:83], v[16:19], v[128:131], 0
  v_mfma_f32_16x16x32_bf16 v[88:91], v[16:19], v[132:135], 0
  s_add_u32 s32, s32, 8192
  s_add_u32 m0, s41, 1024
  s_nop 0
  buffer_load_dwordx4 v3, s[8:11], s32 offen lds
  ds_read_b64_tr_b16 v[16:17], v5 offset:4608
  ds_read_b64_tr_b16 v[18:19], v5 offset:4864
  s_waitcnt lgkmcnt(8)
  v_mfma_f32_16x16x32_bf16 v[84:87], v[20:23], v[128:131], 0
  v_mfma_f32_16x16x32_bf16 v[92:95], v[20:23], v[132:135], 0
  s_add_u32 s32, s32, 8192
  s_add_u32 m0, s41, 2048
  s_nop 0
  buffer_load_dwordx4 v2, s[8:11], s32 offen lds
  ds_read_b64_tr_b16 v[20:21], v4 offset:12288
  ds_read_b64_tr_b16 v[22:23], v4 offset:12544
  s_waitcnt lgkmcnt(8)
  v_mfma_f32_16x16x32_bf16 v[32:35], v[24:27], v[136:139], v[32:35]
  v_mfma_f32_16x16x32_bf16 v[40:43], v[24:27], v[140:143], v[40:43]
  s_add_u32 s32, s32, 8192
  s_add_u32 m0, s41, 3072
  s_nop 0
  buffer_load_dwordx4 v3, s[8:11], s32 offen lds
  ds_read_b64_tr_b16 v[24:25], v5 offset:12288
  ds_read_b64_tr_b16 v[26:27], v5 offset:12544
  s_waitcnt lgkmcnt(8)
  v_mfma_f32_16x16x32_bf16 v[36:39], v[28:31], v[136:139], v[36:39]
  v_mfma_f32_16x16x32_bf16 v[44:47], v[28:31], v[140:143], v[44:47]
  ds_read_b64_tr_b16 v[28:29], v4 offset:12800
  ds_read_b64_tr_b16 v[30:31], v4 offset:13056
  s_waitcnt lgkmcnt(8)
  v_mfma_f32_16x16x32_bf16 v[48:51], v[12:15], v[136:139], v[48:51]
  v_mfma_f32_16x16x32_bf16 v[56:59], v[12:15], v[140:143], v[56:59]
  ds_read_b64_tr_b16 v[12:13], v5 offset:12800
  ds_read_b64_tr_b16 v[14:15], v5 offset:13056
  s_waitcnt lgkmcnt(8)
  v_mfma_f32_16x16x32_bf16 v[52:55], v[16:19], v[136:139], v[52:55]
  v_mfma_f32_16x16x32_bf16 v[60:63], v[16:19], v[140:143], v[60:63]
  s_waitcnt lgkmcnt(6)
  v_mfma_f32_16x16x32_bf16 v[64:67], v[20:23], v[136:139], v[64:67]
  v_mfma_f32_16x16x32_bf16 v[72:75], v[20:23], v[140:143], v[72:75]
  s_waitcnt lgkmcnt(4)
  v_mfma_f32_16x16x32_bf16 v[68:71], v[24:27], v[136:139], v[68:71]
  v_mfma_f32_16x16x32_bf16 v[76:79], v[24:27], v[140:143], v[76:79]
  s_waitcnt lgkmcnt(2)
  v_mfma_f32_16x16x32_bf16 v[80:83], v[28:31], v[136:139], v[80:83]
  v_mfma_f32_16x16x32_bf16 v[88:91], v[28:31], v[140:143], v[88:91]
  s_waitcnt lgkmcnt(0)
  v_mfma_f32_16x16x32_bf16 v[84:87], v[12:15], v[136:139], v[84:87]
  v_mfma_f32_16x16x32_bf16 v[92:95], v[12:15], v[140:143], v[92:95]
  s_waitcnt vmcnt(6)
  ds_read_b128 v[144:147], v6 offset:4096
  ds_read_b128 v[148:151], v6 offset:6144
  ds_read_b128 v[152:155], v7 offset:4096
  ds_read_b128 v[156:159], v7 offset:6144
  s_barrier
  ds_read_b64_tr_b16 v[16:17], v4 offset:16384
  ds_read_b64_tr_b16 v[18:19], v4 offset:16640
  ds_read_b64_tr_b16 v[20:21], v5 offset:16384
  ds_read_b64_tr_b16 v[22:23], v5 offset:16640
  ds_read_b64_tr_b16 v[24:25], v4 offset:16896
  ds_read_b64_tr_b16 v[26:27], v4 offset:17152
  ds_read_b64_tr_b16 v[28:29], v5 offset:16896
  ds_read_b64_tr_b16 v[30:31], v5 offset:17152
  ds_read_b64_tr_b16 v[12:13], v4 offset:24576
  ds_read_b64_tr_b16 v[14:15], v4 offset:24832
  s_waitcnt lgkmcnt(8)
  v_mfma_f32_16x16x32_bf16 v[32:35], v[16:19], v[144:147], v[32:35]
  v_mfma_f32_16x16x32_bf16 v[40:43], v[16:19], v[148:151], v[40:43]
  v_lshlrev_b32 v104, 16, v96
  v_and_b32 v105, 0xffff0000, v96
  v_lshlrev_b32 v106, 16, v97
  v_and_b32 v107, 0xffff0000, v97
  ds_read_b64_tr_b16 v[16:17], v5 offset:24576
  ds_read_b64_tr_b16 v[18:19], v5 offset:24832
  s_waitcnt lgkmcnt(8)
  v_mfma_f32_16x16x32_bf16 v[36:39], v[20:23], v[144:147], v[36:39]
  v_mfma_f32_16x16x32_bf16 v[44:47], v[20:23], v[148:151], v[44:47]
  s_add_u32 s31, s34, 4
  s_and_b32 s31, s31, 7
  s_lshl_b32 s31, s31, 19
  s_add_u32 m0, s40, 0
  s_add_u32 s31, s31, s35
  buffer_load_dwordx4 v1, s[12:15], s31 offen lds
  v_lshlrev_b32 v108, 16, v98
  v_and_b32 v109, 0xffff0000, v98
  v_lshlrev_b32 v110, 16, v99
  v_and_b32 v111, 0xffff0000, v99
  ds_read_b64_tr_b16 v[20:21], v4 offset:25088
  ds_read_b64_tr_b16 v[22:23], v4 offset:25344
  s_waitcnt lgkmcnt(8)
  v_mfma_f32_16x16x32_bf16 v[48:51], v[24:27], v[144:147], v[48:51]
  v_mfma_f32_16x16x32_bf16 v[56:59], v[24:27], v[148:151], v[56:59]
  s_add_u32 s31, s34, 4
  s_and_b32 s31, s31, 7
  s_lshl_b32 s31, s31, 19
  s_add_u32 m0, s40, 8192
  s_add_u32 s31, s31, s35
  s_add_u32 s31, s31, 128
  buffer_load_dwordx4 v1, s[12:15], s31 offen lds
  v_add_f32 v112, v104, v105
  v_add_f32 v112, v112, v106
  v_add_f32 v112, v112, v107
  v_add_f32 v112, v112, v108
  ds_read_b64_tr_b16 v[24:25], v5 offset:25088
  ds_read_b64_tr_b16 v[26:27], v5 offset:25344
  s_waitcnt lgkmcnt(8)
  v_mfma_f32_16x16x32_bf16 v[52:55], v[28:31], v[144:147], v[52:55]
  v_mfma_f32_16x16x32_bf16 v[60:63], v[28:31], v[148:151], v[60:63]
  s_add_u32 s32, s34, 3
  s_and_b32 s32, s32, 7
  s_lshl_b32 s32, s32, 7
  s_add_u32 s32, s32, s39
  s_add_u32 m0, s41, 4096
  s_nop 0
  buffer_load_dwordx4 v2, s[8:11], s32 offen lds
  v_add_f32 v112, v112, v109
  v_add_f32 v112, v112, v110
  v_add_f32 v112, v112, v111
  s_nop 1
  ds_read_b64_tr_b16 v[28:29], v4 offset:20480
  ds_read_b64_tr_b16 v[30:31], v4 offset:20736
  s_waitcnt lgkmcnt(8)
  v_mfma_f32_16x16x32_bf16 v[64:67], v[12:15], v[144:147], v[64:67]
  v_mfma_f32_16x16x32_bf16 v[72:75], v[12:15], v[148:151], v[72:75]
  s_add_u32 s32, s32, 8192
  s_add_u32 m0, s41, 5120
  s_nop 0
  buffer_load_dwordx4 v3, s[8:11], s32 offen lds
  v_add_f32_dpp v112, v112, v112 quad_perm:[1,0,3,2] row_mask:0xf bank_mask:0xf
  s_nop 1
  v_add_f32_dpp v112, v112, v112 quad_perm:[2,3,0,1] row_mask:0xf bank_mask:0xf
  s_nop 1
  ds_read_b64_tr_b16 v[12:13], v5 offset:20480
  ds_read_b64_tr_b16 v[14:15], v5 offset:20736
  s_waitcnt lgkmcnt(8)
  v_mfma_f32_16x16x32_bf16 v[68:71], v[16:19], v[144:147], v[68:71]
  v_mfma_f32_16x16x32_bf16 v[76:79], v[16:19], v[148:151], v[76:79]
  s_add_u32 s32, s32, 8192
  s_add_u32 m0, s41, 6144
  s_nop 0
  buffer_load_dwordx4 v2, s[8:11], s32 offen lds
  v_add_f32_dpp v112, v112, v112 row_half_mirror row_mask:0xf bank_mask:0xf
  s_nop 1
  v_add_f32_dpp v112, v112, v112 row_mirror row_mask:0xf bank_mask:0xf
  v_mov_b32 v113, v112
  ds_read_b64_tr_b16 v[16:17], v4 offset:20992
  ds_read_b64_tr_b16 v[18:19], v4 offset:21248
  s_waitcnt lgkmcnt(8)
  v_mfma_f32_16x16x32_bf16 v[80:83], v[20:23], v[144:147], v[80:83]
  v_mfma_f32_16x16x32_bf16 v[88:91], v[20:23], v[148:151], v[88:91]
  s_add_u32 s32, s32, 8192
  s_add_u32 m0, s41, 7168
  s_nop 0
  buffer_load_dwordx4 v3, s[8:11], s32 offen lds
  s_nop 1
  v_permlane16_swap_b32 v112, v113
  s_nop 1
  v_add_f32 v112, v112, v113
  ds_read_b64_tr_b16 v[20:21], v5 offset:20992
  ds_read_b64_tr_b16 v[22:23], v5 offset:21248
  s_waitcnt lgkmcnt(8)
  v_mfma_f32_16x16x32_bf16 v[84:87], v[24:27], v[144:147], v[84:87]
  v_mfma_f32_16x16x32_bf16 v[92:95], v[24:27], v[148:151], v[92:95]
  v_mov_b32 v113, v112
  s_nop 1
  v_permlane32_swap_b32 v112, v113
  s_nop 1
  ds_read_b64_tr_b16 v[24:25], v4 offset:28672
  ds_read_b64_tr_b16 v[26:27], v4 offset:28928
  s_waitcnt lgkmcnt(8)
  v_mfma_f32_16x16x32_bf16 v[32:35], v[28:31], v[152:155], v[32:35]
  v_mfma_f32_16x16x32_bf16 v[40:43], v[28:31], v[156:159], v[40:43]
  v_add_f32 v112, v112, v113
  v_mul_f32 v112, 0x3b000000, v112
  v_sub_f32 v104, v104, v112
  v_sub_f32 v105, v105, v112
  ds_read_b64_tr_b16 v[28:29], v5 offset:28672
  ds_read_b64_tr_b16 v[30:31], v5 offset:28928
  s_waitcnt lgkmcnt(8)
  v_mfma_f32_16x16x32_bf16 v[36:39], v[12:15], v[152:155], v[36:39]
  v_mfma_f32_16x16x32_bf16 v[44:47], v[12:15], v[156:159], v[44:47]
  v_sub_f32 v106, v106, v112
  v_sub_f32 v107, v107, v112
  v_sub_f32 v108, v108, v112
  v_sub_f32 v109, v109, v112
  ds_read_b64_tr_b16 v[12:13], v4 offset:29184
  ds_read_b64_tr_b16 v[14:15], v4 offset:29440
  s_waitcnt lgkmcnt(8)
  v_mfma_f32_16x16x32_bf16 v[48:51], v[16:19], v[152:155], v[48:51]
  v_mfma_f32_16x16x32_bf16 v[56:59], v[16:19], v[156:159], v[56:59]
  v_sub_f32 v110, v110, v112
  v_sub_f32 v111, v111, v112
  v_mul_f32 v114, v104, v104
  v_fmac_f32 v114, v105, v105
  ds_read_b64_tr_b16 v[16:17], v5 offset:29184
  ds_read_b64_tr_b16 v[18:19], v5 offset:29440
  s_waitcnt lgkmcnt(8)
  v_mfma_f32_16x16x32_bf16 v[52:55], v[20:23], v[152:155], v[52:55]
  v_mfma_f32_16x16x32_bf16 v[60:63], v[20:23], v[156:159], v[60:63]
  v_fmac_f32 v114, v106, v106
  v_fmac_f32 v114, v107, v107
  v_fmac_f32 v114, v108, v108
  v_fmac_f32 v114, v109, v109
  s_waitcnt vmcnt(6)
  ds_read_b128 v[160:163], v6 offset:0
  ds_read_b128 v[164:167], v6 offset:2048
  ds_read_b128 v[168:171], v7 offset:0
  ds_read_b128 v[172:175], v7 offset:2048
  ds_read_b64_tr_b16 v[20:21], v4 offset:32768
  ds_read_b64_tr_b16 v[22:23], v4 offset:33024
  s_waitcnt lgkmcnt(12)
  v_mfma_f32_16x16x32_bf16 v[64:67], v[24:27], v[152:155], v[64:67]
  v_mfma_f32_16x16x32_bf16 v[72:75], v[24:27], v[156:159], v[72:75]
  v_fmac_f32 v114, v110, v110
  v_fmac_f32 v114, v111, v111
  s_nop 1
  v_add_f32_dpp v114, v114, v114 quad_perm:[1,0,3,2] row_mask:0xf bank_mask:0xf
  ds_read_b64_tr_b16 v[24:25], v5 offset:32768
  ds_read_b64_tr_b16 v[26:27], v5 offset:33024
  s_waitcnt lgkmcnt(12)
  v_mfma_f32_16x16x32_bf16 v[68:71], v[28:31], v[152:155], v[68:71]
  v_mfma_f32_16x16x32_bf16 v[76:79], v[28:31], v[156:159], v[76:79]
  s_nop 1
  v_add_f32_dpp v114, v114, v114 quad_perm:[2,3,0,1] row_mask:0xf bank_mask:0xf
  s_nop 1
  v_add_f32_dpp v114, v114, v114 row_half_mirror row_mask:0xf bank_mask:0xf
  ds_read_b64_tr_b16 v[28:29], v4 offset:33280
  ds_read_b64_tr_b16 v[30:31], v4 offset:33536
  s_waitcnt lgkmcnt(12)
  v_mfma_f32_16x16x32_bf16 v[80:83], v[12:15], v[152:155], v[80:83]
  v_mfma_f32_16x16x32_bf16 v[88:91], v[12:15], v[156:159], v[88:91]
  s_nop 1
  v_add_f32_dpp v114, v114, v114 row_mirror row_mask:0xf bank_mask:0xf
  v_mov_b32 v113, v114
  s_nop 1
  ds_read_b64_tr_b16 v[12:13], v5 offset:33280
  ds_read_b64_tr_b16 v[14:15], v5 offset:33536
  s_waitcnt lgkmcnt(12)
  v_mfma_f32_16x16x32_bf16 v[84:87], v[16:19], v[152:155], v[84:87]
  v_mfma_f32_16x16x32_bf16 v[92:95], v[16:19], v[156:159], v[92:95]
  v_permlane16_swap_b32 v114, v113
  s_nop 1
  v_add_f32 v114, v114, v113
  v_mov_b32 v113, v114
  s_barrier
  ds_read_b64_tr_b16 v[16:17], v4 offset:40960
  ds_read_b64_tr_b16 v[18:19], v4 offset:41216
  s_waitcnt lgkmcnt(8)
  v_mfma_f32_16x16x32_bf16 v[32:35], v[20:23], v[160:163], v[32:35]
  v_mfma_f32_16x16x32_bf16 v[40:43], v[20:23], v[164:167], v[40:43]
  s_nop 1
  v_permlane32_swap_b32 v114, v113
  s_nop 1
  v_add_f32 v114, v114, v113
  ds_read_b64_tr_b16 v[20:21], v5 offset:40960
  ds_read_b64_tr_b16 v[22:23], v5 offset:41216
  s_waitcnt lgkmcnt(8)
  v_mfma_f32_16x16x32_bf16 v[36:39], v[24:27], v[160:163], v[36:39]
  v_mfma_f32_16x16x32_bf16 v[44:47], v[24:27], v[164:167], v[44:47]
  s_add_u32 s31, s34, 5
  s_and_b32 s31, s31, 7
  s_lshl_b32 s31, s31, 19
  s_add_u32 m0, s40, 16384
  s_add_u32 s31, s31, s35
  buffer_load_dwordx4 v1, s[12:15], s31 offen lds
  v_mov_b32 v115, 0x3727c5ac
  v_fmac_f32 v115, 0x3b000000, v114
  v_rsq_f32 v115, v115
  s_nop 0
  ds_read_b64_tr_b16 v[24:25], v4 offset:41472
  ds_read_b64_tr_b16 v[26:27], v4 offset:41728
  s_waitcnt lgkmcnt(8)
  v_mfma_f32_16x16x32_bf16 v[48:51], v[28:31], v[160:163], v[48:51]
  v_mfma_f32_16x16x32_bf16 v[56:59], v[28:31], v[164:167], v[56:59]
  s_add_u32 s31, s34, 5
  s_and_b32 s31, s31, 7
  s_lshl_b32 s31, s31, 19
  s_add_u32 m0, s40, 24576
  s_add_u32 s31, s31, s35
  s_add_u32 s31, s31, 128
  buffer_load_dwordx4 v1, s[12:15], s31 offen lds
  v_mul_f32 v115, 0x3e0293ee, v115
  v_mul_f32 v104, v104, v115
  v_mul_f32 v105, v105, v115
  v_mul_f32 v106, v106, v115
  ds_read_b64_tr_b16 v[28:29], v5 offset:41472
  ds_read_b64_tr_b16 v[30:31], v5 offset:41728
  s_waitcnt lgkmcnt(8)
  v_mfma_f32_16x16x32_bf16 v[52:55], v[12:15], v[160:163], v[52:55]
  v_mfma_f32_16x16x32_bf16 v[60:63], v[12:15], v[164:167], v[60:63]
  s_add_u32 s32, s34, 4
  s_and_b32 s32, s32, 7
  s_lshl_b32 s32, s32, 7
  s_add_u32 s32, s32, s39
  s_add_u32 m0, s41, 0
  s_nop 0
  buffer_load_dwordx4 v2, s[8:11], s32 offen lds
  v_mul_f32 v107, v107, v115
  v_mul_f32 v108, v108, v115
  v_mul_f32 v109, v109, v115
  v_mul_f32 v110, v110, v115
  ds_read_b64_tr_b16 v[12:13], v4 offset:36864
  ds_read_b64_tr_b16 v[14:15], v4 offset:37120
  s_waitcnt lgkmcnt(8)
  v_mfma_f32_16x16x32_bf16 v[64:67], v[16:19], v[160:163], v[64:67]
  v_mfma_f32_16x16x32_bf16 v[72:75], v[16:19], v[164:167], v[72:75]
  s_add_u32 s32, s32, 8192
  s_add_u32 m0, s41, 1024
  s_nop 0
  buffer_load_dwordx4 v3, s[8:11], s32 offen lds
  v_mul_f32 v111, v111, v115
  v_cvt_pk_bf16_f32 v96, v104, v105
  v_cvt_pk_bf16_f32 v97, v106, v107
  v_cvt_pk_bf16_f32 v98, v108, v109
  ds_read_b64_tr_b16 v[16:17], v5 offset:36864
  ds_read_b64_tr_b16 v[18:19], v5 offset:37120
  s_waitcnt lgkmcnt(8)
  v_mfma_f32_16x16x32_bf16 v[68:71], v[20:23], v[160:163], v[68:71]
  v_mfma_f32_16x16x32_bf16 v[76:79], v[20:23], v[164:167], v[76:79]
  s_add_u32 s32, s32, 8192
  s_add_u32 m0, s41, 2048
  s_nop 0
  buffer_load_dwordx4 v2, s[8:11], s32 offen lds
  v_cvt_pk_bf16_f32 v99, v110, v111
  s_lshl_b32 s42, s30, 10
  s_add_u32 s42, s42, 131072
  v_lshl_add_u32 v116, v0, 4, s42
  ds_read_b64_tr_b16 v[20:21], v4 offset:37376
  ds_read_b64_tr_b16 v[22:23], v4 offset:37632
  s_waitcnt lgkmcnt(8)
  v_mfma_f32_16x16x32_bf16 v[80:83], v[24:27], v[160:163], v[80:83]
  v_mfma_f32_16x16x32_bf16 v[88:91], v[24:27], v[164:167], v[88:91]
  s_add_u32 s32, s32, 8192
  s_add_u32 m0, s41, 3072
  s_nop 0
  buffer_load_dwordx4 v3, s[8:11], s32 offen lds
  ds_read_b64_tr_b16 v[24:25], v5 offset:37376
  ds_read_b64_tr_b16 v[26:27], v5 offset:37632
  s_waitcnt lgkmcnt(8)
  v_mfma_f32_16x16x32_bf16 v[84:87], v[28:31], v[160:163], v[84:87]
  v_mfma_f32_16x16x32_bf16 v[92:95], v[28:31], v[164:167], v[92:95]
  ds_read_b64_tr_b16 v[28:29], v4 offset:45056
  ds_read_b64_tr_b16 v[30:31], v4 offset:45312
  s_waitcnt lgkmcnt(8)
  v_mfma_f32_16x16x32_bf16 v[32:35], v[12:15], v[168:171], v[32:35]
  v_mfma_f32_16x16x32_bf16 v[40:43], v[12:15], v[172:175], v[40:43]
  ds_read_b64_tr_b16 v[12:13], v5 offset:45056
  ds_read_b64_tr_b16 v[14:15], v5 offset:45312
  s_waitcnt lgkmcnt(8)
  v_mfma_f32_16x16x32_bf16 v[36:39], v[16:19], v[168:171], v[36:39]
  v_mfma_f32_16x16x32_bf16 v[44:47], v[16:19], v[172:175], v[44:47]
  ds_read_b64_tr_b16 v[16:17], v4 offset:45568
  ds_read_b64_tr_b16 v[18:19], v4 offset:45824
  s_waitcnt lgkmcnt(8)
  v_mfma_f32_16x16x32_bf16 v[48:51], v[20:23], v[168:171], v[48:51]
  v_mfma_f32_16x16x32_bf16 v[56:59], v[20:23], v[172:175], v[56:59]
  ds_read_b64_tr_b16 v[20:21], v5 offset:45568
  ds_read_b64_tr_b16 v[22:23], v5 offset:45824
  s_waitcnt lgkmcnt(8)
  v_mfma_f32_16x16x32_bf16 v[52:55], v[24:27], v[168:171], v[52:55]
  v_mfma_f32_16x16x32_bf16 v[60:63], v[24:27], v[172:175], v[60:63]
  s_waitcnt vmcnt(6)
  ds_read_b128 v[176:179], v6 offset:4096
  ds_read_b128 v[180:183], v6 offset:6144
  ds_read_b128 v[184:187], v7 offset:4096
  ds_read_b128 v[188:191], v7 offset:6144
  ds_read_b64_tr_b16 v[24:25], v4 offset:49152
  ds_read_b64_tr_b16 v[26:27], v4 offset:49408
  s_waitcnt lgkmcnt(12)
  v_mfma_f32_16x16x32_bf16 v[64:67], v[28:31], v[168:171], v[64:67]
  v_mfma_f32_16x16x32_bf16 v[72:75], v[28:31], v[172:175], v[72:75]
  ds_read_b64_tr_b16 v[28:29], v5 offset:49152
  ds_read_b64_tr_b16 v[30:31], v5 offset:49408
  s_waitcnt lgkmcnt(12)
  v_mfma_f32_16x16x32_bf16 v[68:71], v[12:15], v[168:171], v[68:71]
  v_mfma_f32_16x16x32_bf16 v[76:79], v[12:15], v[172:175], v[76:79]
  ds_read_b64_tr_b16 v[12:13], v4 offset:49664
  ds_read_b64_tr_b16 v[14:15], v4 offset:49920
  s_waitcnt lgkmcnt(12)
  v_mfma_f32_16x16x32_bf16 v[80:83], v[16:19], v[168:171], v[80:83]
  v_mfma_f32_16x16x32_bf16 v[88:91], v[16:19], v[172:175], v[88:91]
  ds_read_b64_tr_b16 v[16:17], v5 offset:49664
  ds_read_b64_tr_b16 v[18:19], v5 offset:49920
  s_waitcnt lgkmcnt(12)
  v_mfma_f32_16x16x32_bf16 v[84:87], v[20:23], v[168:171], v[84:87]
  v_mfma_f32_16x16x32_bf16 v[92:95], v[20:23], v[172:175], v[92:95]
  ds_write_b128 v116, v[96:99]
  s_waitcnt lgkmcnt(0)
  s_barrier
  ds_read_b64_tr_b16 v[20:21], v4 offset:57344
  ds_read_b64_tr_b16 v[22:23], v4 offset:57600
  v_mfma_f32_16x16x32_bf16 v[32:35], v[24:27], v[176:179], v[32:35]
  v_mfma_f32_16x16x32_bf16 v[40:43], v[24:27], v[180:183], v[40:43]
  v_and_b32 v116, 7, v0
  v_lshrrev_b32 v117, 3, v0
  ds_read_b64_tr_b16 v[24:25], v5 offset:57344
  ds_read_b64_tr_b16 v[26:27], v5 offset:57600
  v_mfma_f32_16x16x32_bf16 v[36:39], v[28:31], v[176:179], v[36:39]
  v_mfma_f32_16x16x32_bf16 v[44:47], v[28:31], v[180:183], v[44:47]
  s_add_u32 s31, s34, 6
  s_and_b32 s31, s31, 7
  s_lshl_b32 s31, s31, 19
  s_add_u32 m0, s40, 32768
  s_add_u32 s31, s31, s35
  buffer_load_dwordx4 v1, s[12:15], s31 offen lds
  s_lshl_b32 s42, s30, 3
  v_add_u32 v117, s42, v117
  ds_read_b64_tr_b16 v[28:29], v4 offset:57856
  ds_read_b64_tr_b16 v[30:31], v4 offset:58112
  v_mfma_f32_16x16x32_bf16 v[48:51], v[12:15], v[176:179], v[48:51]
  v_mfma_f32_16x16x32_bf16 v[56:59], v[12:15], v[180:183], v[56:59]
  s_add_u32 s31, s34, 6
  s_and_b32 s31, s31, 7
  s_lshl_b32 s31, s31, 19
  s_add_u32 m0, s40, 40960
  s_add_u32 s31, s31, s35
  s_add_u32 s31, s31, 128
  buffer_load_dwordx4 v1, s[12:15], s31 offen lds
  v_lshlrev_b32 v104, 10, v116
  v_lshl_add_u32 v104, v117, 4, v104
  ds_read_b64_tr_b16 v[12:13], v5 offset:57856
  ds_read_b64_tr_b16 v[14:15], v5 offset:58112
  v_mfma_f32_16x16x32_bf16 v[52:55], v[16:19], v[176:179], v[52:55]
  v_mfma_f32_16x16x32_bf16 v[60:63], v[16:19], v[180:183], v[60:63]
  s_add_u32 s32, s34, 5
  s_and_b32 s32, s32, 7
  s_lshl_b32 s32, s32, 7
  s_add_u32 s32, s32, s39
  s_add_u32 m0, s41, 4096
  s_nop 0
  buffer_load_dwordx4 v2, s[8:11], s32 offen lds
  v_add_u32 v104, 131072, v104
  ds_read_b64_tr_b16 v[16:17], v4 offset:53248
  ds_read_b64_tr_b16 v[18:19], v4 offset:53504
  s_waitcnt lgkmcnt(8)
  v_mfma_f32_16x16x32_bf16 v[64:67], v[20:23], v[176:179], v[64:67]
  v_mfma_f32_16x16x32_bf16 v[72:75], v[20:23], v[180:183], v[72:75]
  s_add_u32 s32, s32, 8192
  s_add_u32 m0, s41, 5120
  s_nop 0
  buffer_load_dwordx4 v3, s[8:11], s32 offen lds
  ds_read_b128 v[96:99], v104
  ds_read_b64_tr_b16 v[20:21], v5 offset:53248
  ds_read_b64_tr_b16 v[22:23], v5 offset:53504
  s_waitcnt lgkmcnt(9)
  v_mfma_f32_16x16x32_bf16 v[68:71], v[24:27], v[176:179], v[68:71]
  v_mfma_f32_16x16x32_bf16 v[76:79], v[24:27], v[180:183], v[76:79]
  s_add_u32 s32, s32, 8192
  s_add_u32 m0, s41, 6144
  s_nop 0
  buffer_load_dwordx4 v2, s[8:11], s32 offen lds
  v_lshrrev_b32 v105, 2, v117
  v_lshlrev_b32 v105, 10, v105
  ds_read_b64_tr_b16 v[24:25], v4 offset:53760
  ds_read_b64_tr_b16 v[26:27], v4 offset:54016
  s_waitcnt lgkmcnt(9)
  v_mfma_f32_16x16x32_bf16 v[80:83], v[28:31], v[176:179], v[80:83]
  v_mfma_f32_16x16x32_bf16 v[88:91], v[28:31], v[180:183], v[88:91]
  s_add_u32 s32, s32, 8192
  s_add_u32 m0, s41, 7168
  s_nop 0
  buffer_load_dwordx4 v3, s[8:11], s32 offen lds
  v_and_b32 v117, 3, v117
  v_lshl_add_u32 v105, v117, 8, v105
  ds_read_b64_tr_b16 v[28:29], v5 offset:53760
  ds_read_b64_tr_b16 v[30:31], v5 offset:54016
  s_waitcnt lgkmcnt(9)
  v_mfma_f32_16x16x32_bf16 v[84:87], v[12:15], v[176:179], v[84:87]
  v_mfma_f32_16x16x32_bf16 v[92:95], v[12:15], v[180:183], v[92:95]
  v_lshl_add_u32 v105, v116, 4, v105
  s_lshr_b32 s42, s2, 1
  ds_read_b64_tr_b16 v[12:13], v4 offset:61440
  ds_read_b64_tr_b16 v[14:15], v4 offset:61696
  s_waitcnt lgkmcnt(9)
  v_mfma_f32_16x16x32_bf16 v[32:35], v[16:19], v[184:187], v[32:35]
  v_mfma_f32_16x16x32_bf16 v[40:43], v[16:19], v[188:191], v[40:43]
  v_lshlrev_b32 v11, 4, v0
  s_lshl_b32 s31, s2, 14
  s_lshl_b32 s32, s30, 11
  s_add_u32 s31, s31, s32
  s_mov_b32 m0, 139264
  s_nop 0
  s_add_u32 s32, s31, 0
  buffer_load_dwordx4 v11, s[16:19], s32 offen lds
  s_add_u32 s32, s31, 1024
  buffer_load_dwordx4 v11, s[16:19], s32 offen lds
  s_add_u32 s32, s31, 0
  buffer_load_dwordx4 v11, s[20:23], s32 offen lds
  s_add_u32 s32, s31, 1024
  buffer_load_dwordx4 v11, s[20:23], s32 offen lds
  s_lshl_b32 s42, s42, 14
  s_and_b32 s38, s2, 1
  ds_read_b64_tr_b16 v[16:17], v5 offset:61440
  ds_read_b64_tr_b16 v[18:19], v5 offset:61696
  s_waitcnt lgkmcnt(8)
  v_mfma_f32_16x16x32_bf16 v[36:39], v[20:23], v[184:187], v[36:39]
  v_mfma_f32_16x16x32_bf16 v[44:47], v[20:23], v[188:191], v[44:47]
  s_lshl_b32 s38, s38, 7
  s_add_u32 s42, s42, s38
  ds_read_b64_tr_b16 v[20:21], v4 offset:61952
  ds_read_b64_tr_b16 v[22:23], v4 offset:62208
  s_waitcnt lgkmcnt(8)
  v_mfma_f32_16x16x32_bf16 v[48:51], v[24:27], v[184:187], v[48:51]
  v_mfma_f32_16x16x32_bf16 v[56:59], v[24:27], v[188:191], v[56:59]
  s_add_u32 s42, s42, 0x3600000
  ds_read_b64_tr_b16 v[24:25], v5 offset:61952
  ds_read_b64_tr_b16 v[26:27], v5 offset:62208
  s_waitcnt lgkmcnt(8)
  v_mfma_f32_16x16x32_bf16 v[52:55], v[28:31], v[184:187], v[52:55]
  v_mfma_f32_16x16x32_bf16 v[60:63], v[28:31], v[188:191], v[60:63]
  s_waitcnt vmcnt(10)
  ds_read_b128 v[192:195], v6 offset:0
  ds_read_b128 v[196:199], v6 offset:2048
  ds_read_b128 v[200:203], v7 offset:0
  ds_read_b128 v[204:207], v7 offset:2048
  ds_read_b64_tr_b16 v[28:29], v4 offset:0
  ds_read_b64_tr_b16 v[30:31], v4 offset:256
  s_waitcnt lgkmcnt(12)
  v_mfma_f32_16x16x32_bf16 v[64:67], v[12:15], v[184:187], v[64:67]
  v_mfma_f32_16x16x32_bf16 v[72:75], v[12:15], v[188:191], v[72:75]
  buffer_store_dwordx4 v[96:99], v105, s[24:27], s42 offen sc1
  ds_read_b64_tr_b16 v[12:13], v5 offset:0
  ds_read_b64_tr_b16 v[14:15], v5 offset:256
  s_waitcnt lgkmcnt(12)
  v_mfma_f32_16x16x32_bf16 v[68:71], v[16:19], v[184:187], v[68:71]
  v_mfma_f32_16x16x32_bf16 v[76:79], v[16:19], v[188:191], v[76:79]
  ds_read_b64_tr_b16 v[16:17], v4 offset:512
  ds_read_b64_tr_b16 v[18:19], v4 offset:768
  s_waitcnt lgkmcnt(12)
  v_mfma_f32_16x16x32_bf16 v[80:83], v[20:23], v[184:187], v[80:83]
  v_mfma_f32_16x16x32_bf16 v[88:91], v[20:23], v[188:191], v[88:91]
  ds_read_b64_tr_b16 v[20:21], v5 offset:512
  ds_read_b64_tr_b16 v[22:23], v5 offset:768
  s_waitcnt lgkmcnt(12)
  v_mfma_f32_16x16x32_bf16 v[84:87], v[24:27], v[184:187], v[84:87]
  v_mfma_f32_16x16x32_bf16 v[92:95], v[24:27], v[188:191], v[92:95]
  s_barrier
  ds_read_b64_tr_b16 v[24:25], v4 offset:8192
  ds_read_b64_tr_b16 v[26:27], v4 offset:8448
  s_waitcnt lgkmcnt(8)
  v_mfma_f32_16x16x32_bf16 v[32:35], v[28:31], v[192:195], v[32:35]
  v_mfma_f32_16x16x32_bf16 v[40:43], v[28:31], v[196:199], v[40:43]
  ds_read_b64_tr_b16 v[28:29], v5 offset:8192
  ds_read_b64_tr_b16 v[30:31], v5 offset:8448
  s_waitcnt lgkmcnt(8)
  v_mfma_f32_16x16x32_bf16 v[36:39], v[12:15], v[192:195], v[36:39]
  v_mfma_f32_16x16x32_bf16 v[44:47], v[12:15], v[196:199], v[44:47]
  s_add_u32 s31, s34, 7
  s_and_b32 s31, s31, 7
  s_lshl_b32 s31, s31, 19
  s_add_u32 m0, s40, 49152
  s_add_u32 s31, s31, s35
  buffer_load_dwordx4 v1, s[12:15], s31 offen lds
  ds_read_b64_tr_b16 v[12:13], v4 offset:8704
  ds_read_b64_tr_b16 v[14:15], v4 offset:8960
  s_waitcnt lgkmcnt(8)
  v_mfma_f32_16x16x32_bf16 v[48:51], v[16:19], v[192:195], v[48:51]
  v_mfma_f32_16x16x32_bf16 v[56:59], v[16:19], v[196:199], v[56:59]
  s_add_u32 s31, s34, 7
  s_and_b32 s31, s31, 7
  s_lshl_b32 s31, s31, 19
  s_add_u32 m0, s40, 57344
  s_add_u32 s31, s31, s35
  s_add_u32 s31, s31, 128
  buffer_load_dwordx4 v1, s[12:15], s31 offen lds
  ds_read_b64_tr_b16 v[16:17], v5 offset:8704
  ds_read_b64_tr_b16 v[18:19], v5 offset:8960
  s_waitcnt lgkmcnt(8)
  v_mfma_f32_16x16x32_bf16 v[52:55], v[20:23], v[192:195], v[52:55]
  v_mfma_f32_16x16x32_bf16 v[60:63], v[20:23], v[196:199], v[60:63]
  s_add_u32 s32, s34, 6
  s_and_b32 s32, s32, 7
  s_lshl_b32 s32, s32, 7
  s_add_u32 s32, s32, s39
  s_add_u32 m0, s41, 0
  s_nop 0
  buffer_load_dwordx4 v2, s[8:11], s32 offen lds
  ds_read_b64_tr_b16 v[20:21], v4 offset:4096
  ds_read_b64_tr_b16 v[22:23], v4 offset:4352
  s_waitcnt lgkmcnt(8)
  v_mfma_f32_16x16x32_bf16 v[64:67], v[24:27], v[192:195], v[64:67]
  v_mfma_f32_16x16x32_bf16 v[72:75], v[24:27], v[196:199], v[72:75]
  s_add_u32 s32, s32, 8192
  s_add_u32 m0, s41, 1024
  s_nop 0
  buffer_load_dwordx4 v3, s[8:11], s32 offen lds
  ds_read_b64_tr_b16 v[24:25], v5 offset:4096
  ds_read_b64_tr_b16 v[26:27], v5 offset:4352
  s_waitcnt lgkmcnt(8)
  v_mfma_f32_16x16x32_bf16 v[68:71], v[28:31], v[192:195], v[68:71]
  v_mfma_f32_16x16x32_bf16 v[76:79], v[28:31], v[196:199], v[76:79]
  s_add_u32 s32, s32, 8192
  s_add_u32 m0, s41, 2048
  s_nop 0
  buffer_load_dwordx4 v2, s[8:11], s32 offen lds
  ds_read_b64_tr_b16 v[28:29], v4 offset:4608
  ds_read_b64_tr_b16 v[30:31], v4 offset:4864
  s_waitcnt lgkmcnt(8)
  v_mfma_f32_16x16x32_bf16 v[80:83], v[12:15], v[192:195], v[80:83]
  v_mfma_f32_16x16x32_bf16 v[88:91], v[12:15], v[196:199], v[88:91]
  s_add_u32 s32, s32, 8192
  s_add_u32 m0, s41, 3072
  s_nop 0
  buffer_load_dwordx4 v3, s[8:11], s32 offen lds
  ds_read_b64_tr_b16 v[12:13], v5 offset:4608
  ds_read_b64_tr_b16 v[14:15], v5 offset:4864
  s_waitcnt lgkmcnt(8)
  v_mfma_f32_16x16x32_bf16 v[84:87], v[16:19], v[192:195], v[84:87]
  v_mfma_f32_16x16x32_bf16 v[92:95], v[16:19], v[196:199], v[92:95]
  ds_read_b64_tr_b16 v[16:17], v4 offset:12288
  ds_read_b64_tr_b16 v[18:19], v4 offset:12544
  s_waitcnt lgkmcnt(8)
  v_mfma_f32_16x16x32_bf16 v[32:35], v[20:23], v[200:203], v[32:35]
  v_mfma_f32_16x16x32_bf16 v[40:43], v[20:23], v[204:207], v[40:43]
  ds_read_b64_tr_b16 v[20:21], v5 offset:12288
  ds_read_b64_tr_b16 v[22:23], v5 offset:12544
  s_waitcnt lgkmcnt(8)
  v_mfma_f32_16x16x32_bf16 v[36:39], v[24:27], v[200:203], v[36:39]
  v_mfma_f32_16x16x32_bf16 v[44:47], v[24:27], v[204:207], v[44:47]
  ds_read_b64_tr_b16 v[24:25], v4 offset:12800
  ds_read_b64_tr_b16 v[26:27], v4 offset:13056
  s_waitcnt lgkmcnt(8)
  v_mfma_f32_16x16x32_bf16 v[48:51], v[28:31], v[200:203], v[48:51]
  v_mfma_f32_16x16x32_bf16 v[56:59], v[28:31], v[204:207], v[56:59]
  ds_read_b64_tr_b16 v[28:29], v5 offset:12800
  ds_read_b64_tr_b16 v[30:31], v5 offset:13056
  s_waitcnt lgkmcnt(8)
  v_mfma_f32_16x16x32_bf16 v[52:55], v[12:15], v[200:203], v[52:55]
  v_mfma_f32_16x16x32_bf16 v[60:63], v[12:15], v[204:207], v[60:63]
  s_waitcnt vmcnt(11)
  ds_read_b128 v[208:211], v6 offset:4096
  ds_read_b128 v[212:215], v6 offset:6144
  ds_read_b128 v[216:219], v7 offset:4096
  ds_read_b128 v[220:223], v7 offset:6144
  ds_read_b64_tr_b16 v[12:13], v4 offset:16384
  ds_read_b64_tr_b16 v[14:15], v4 offset:16640
  s_waitcnt lgkmcnt(12)
  v_mfma_f32_16x16x32_bf16 v[64:67], v[16:19], v[200:203], v[64:67]
  v_mfma_f32_16x16x32_bf16 v[72:75], v[16:19], v[204:207], v[72:75]
  ds_read_b64_tr_b16 v[16:17], v5 offset:16384
  ds_read_b64_tr_b16 v[18:19], v5 offset:16640
  s_waitcnt lgkmcnt(12)
  v_mfma_f32_16x16x32_bf16 v[68:71], v[20:23], v[200:203], v[68:71]
  v_mfma_f32_16x16x32_bf16 v[76:79], v[20:23], v[204:207], v[76:79]
  ds_read_b64_tr_b16 v[20:21], v4 offset:16896
  ds_read_b64_tr_b16 v[22:23], v4 offset:17152
  s_waitcnt lgkmcnt(12)
  v_mfma_f32_16x16x32_bf16 v[80:83], v[24:27], v[200:203], v[80:83]
  v_mfma_f32_16x16x32_bf16 v[88:91], v[24:27], v[204:207], v[88:91]
  ds_read_b64_tr_b16 v[24:25], v5 offset:16896
  ds_read_b64_tr_b16 v[26:27], v5 offset:17152
  s_waitcnt lgkmcnt(12)
  v_mfma_f32_16x16x32_bf16 v[84:87], v[28:31], v[200:203], v[84:87]
  v_mfma_f32_16x16x32_bf16 v[92:95], v[28:31], v[204:207], v[92:95]
  s_barrier
  ds_read_b64_tr_b16 v[28:29], v4 offset:24576
  ds_read_b64_tr_b16 v[30:31], v4 offset:24832
  s_waitcnt lgkmcnt(8)
  v_mfma_f32_16x16x32_bf16 v[32:35], v[12:15], v[208:211], v[32:35]
  v_mfma_f32_16x16x32_bf16 v[40:43], v[12:15], v[212:215], v[40:43]
  ds_read_b64_tr_b16 v[12:13], v5 offset:24576
  ds_read_b64_tr_b16 v[14:15], v5 offset:24832
  s_waitcnt lgkmcnt(8)
  v_mfma_f32_16x16x32_bf16 v[36:39], v[16:19], v[208:211], v[36:39]
  v_mfma_f32_16x16x32_bf16 v[44:47], v[16:19], v[212:215], v[44:47]
  s_add_u32 s31, s34, 0
  s_and_b32 s31, s31, 7
  s_lshl_b32 s31, s31, 19
  s_add_u32 m0, s40, 0
  s_add_u32 s31, s31, s35
  buffer_load_dwordx4 v1, s[16:19], s31 offen lds
  ds_read_b64_tr_b16 v[16:17], v4 offset:25088
  ds_read_b64_tr_b16 v[18:19], v4 offset:25344
  s_waitcnt lgkmcnt(8)
  v_mfma_f32_16x16x32_bf16 v[48:51], v[20:23], v[208:211], v[48:51]
  v_mfma_f32_16x16x32_bf16 v[56:59], v[20:23], v[212:215], v[56:59]
  s_add_u32 s31, s34, 1
  s_and_b32 s31, s31, 7
  s_lshl_b32 s31, s31, 19
  s_add_u32 m0, s40, 8192
  s_add_u32 s31, s31, s35
  buffer_load_dwordx4 v1, s[16:19], s31 offen lds
  ds_read_b64_tr_b16 v[20:21], v5 offset:25088
  ds_read_b64_tr_b16 v[22:23], v5 offset:25344
  s_waitcnt lgkmcnt(8)
  v_mfma_f32_16x16x32_bf16 v[52:55], v[24:27], v[208:211], v[52:55]
  v_mfma_f32_16x16x32_bf16 v[60:63], v[24:27], v[212:215], v[60:63]
  s_add_u32 s32, s34, 7
  s_and_b32 s32, s32, 7
  s_lshl_b32 s32, s32, 7
  s_add_u32 s32, s32, s39
  s_add_u32 m0, s41, 4096
  s_nop 0
  buffer_load_dwordx4 v2, s[8:11], s32 offen lds
  ds_read_b64_tr_b16 v[24:25], v4 offset:20480
  ds_read_b64_tr_b16 v[26:27], v4 offset:20736
  s_waitcnt lgkmcnt(8)
  v_mfma_f32_16x16x32_bf16 v[64:67], v[28:31], v[208:211], v[64:67]
  v_mfma_f32_16x16x32_bf16 v[72:75], v[28:31], v[212:215], v[72:75]
  s_add_u32 s32, s32, 8192
  s_add_u32 m0, s41, 5120
  s_nop 0
  buffer_load_dwordx4 v3, s[8:11], s32 offen lds
  ds_read_b64_tr_b16 v[28:29], v5 offset:20480
  ds_read_b64_tr_b16 v[30:31], v5 offset:20736
  s_waitcnt lgkmcnt(8)
  v_mfma_f32_16x16x32_bf16 v[68:71], v[12:15], v[208:211], v[68:71]
  v_mfma_f32_16x16x32_bf16 v[76:79], v[12:15], v[212:215], v[76:79]
  s_add_u32 s32, s32, 8192
  s_add_u32 m0, s41, 6144
  s_nop 0
  buffer_load_dwordx4 v2, s[8:11], s32 offen lds
  ds_read_b64_tr_b16 v[12:13], v4 offset:20992
  ds_read_b64_tr_b16 v[14:15], v4 offset:21248
  s_waitcnt lgkmcnt(8)
  v_mfma_f32_16x16x32_bf16 v[80:83], v[16:19], v[208:211], v[80:83]
  v_mfma_f32_16x16x32_bf16 v[88:91], v[16:19], v[212:215], v[88:91]
  s_add_u32 s32, s32, 8192
  s_add_u32 m0, s41, 7168
  s_nop 0
  buffer_load_dwordx4 v3, s[8:11], s32 offen lds
  ds_read_b64_tr_b16 v[16:17], v5 offset:20992
  ds_read_b64_tr_b16 v[18:19], v5 offset:21248
  s_waitcnt lgkmcnt(8)
  v_mfma_f32_16x16x32_bf16 v[84:87], v[20:23], v[208:211], v[84:87]
  v_mfma_f32_16x16x32_bf16 v[92:95], v[20:23], v[212:215], v[92:95]
  ds_read_b64_tr_b16 v[20:21], v4 offset:28672
  ds_read_b64_tr_b16 v[22:23], v4 offset:28928
  s_waitcnt lgkmcnt(8)
  v_mfma_f32_16x16x32_bf16 v[32:35], v[24:27], v[216:219], v[32:35]
  v_mfma_f32_16x16x32_bf16 v[40:43], v[24:27], v[220:223], v[40:43]
  ds_read_b64_tr_b16 v[24:25], v5 offset:28672
  ds_read_b64_tr_b16 v[26:27], v5 offset:28928
  s_waitcnt lgkmcnt(8)
  v_mfma_f32_16x16x32_bf16 v[36:39], v[28:31], v[216:219], v[36:39]
  v_mfma_f32_16x16x32_bf16 v[44:47], v[28:31], v[220:223], v[44:47]
  ds_read_b64_tr_b16 v[28:29], v4 offset:29184
  ds_read_b64_tr_b16 v[30:31], v4 offset:29440
  s_waitcnt lgkmcnt(8)
  v_mfma_f32_16x16x32_bf16 v[48:51], v[12:15], v[216:219], v[48:51]
  v_mfma_f32_16x16x32_bf16 v[56:59], v[12:15], v[220:223], v[56:59]
  ds_read_b64_tr_b16 v[12:13], v5 offset:29184
  ds_read_b64_tr_b16 v[14:15], v5 offset:29440
  s_waitcnt lgkmcnt(8)
  v_mfma_f32_16x16x32_bf16 v[52:55], v[16:19], v[216:219], v[52:55]
  v_mfma_f32_16x16x32_bf16 v[60:63], v[16:19], v[220:223], v[60:63]
  s_waitcnt vmcnt(6)
  ds_read_b128 v[224:227], v6 offset:0
  ds_read_b128 v[228:231], v6 offset:2048
  ds_read_b128 v[232:235], v7 offset:0
  ds_read_b128 v[236:239], v7 offset:2048
  ds_read_b64_tr_b16 v[16:17], v4 offset:32768
  ds_read_b64_tr_b16 v[18:19], v4 offset:33024
  s_waitcnt lgkmcnt(12)
  v_mfma_f32_16x16x32_bf16 v[64:67], v[20:23], v[216:219], v[64:67]
  v_mfma_f32_16x16x32_bf16 v[72:75], v[20:23], v[220:223], v[72:75]
  ds_read_b64_tr_b16 v[20:21], v5 offset:32768
  ds_read_b64_tr_b16 v[22:23], v5 offset:33024
  s_waitcnt lgkmcnt(12)
  v_mfma_f32_16x16x32_bf16 v[68:71], v[24:27], v[216:219], v[68:71]
  v_mfma_f32_16x16x32_bf16 v[76:79], v[24:27], v[220:223], v[76:79]
  ds_read_b64_tr_b16 v[24:25], v4 offset:33280
  ds_read_b64_tr_b16 v[26:27], v4 offset:33536
  s_waitcnt lgkmcnt(12)
  v_mfma_f32_16x16x32_bf16 v[80:83], v[28:31], v[216:219], v[80:83]
  v_mfma_f32_16x16x32_bf16 v[88:91], v[28:31], v[220:223], v[88:91]
  ds_read_b64_tr_b16 v[28:29], v5 offset:33280
  ds_read_b64_tr_b16 v[30:31], v5 offset:33536
  s_waitcnt lgkmcnt(12)
  v_mfma_f32_16x16x32_bf16 v[84:87], v[12:15], v[216:219], v[84:87]
  v_mfma_f32_16x16x32_bf16 v[92:95], v[12:15], v[220:223], v[92:95]
  s_barrier
  ds_read_b64_tr_b16 v[12:13], v4 offset:40960
  ds_read_b64_tr_b16 v[14:15], v4 offset:41216
  s_waitcnt lgkmcnt(8)
  v_mfma_f32_16x16x32_bf16 v[32:35], v[16:19], v[224:227], v[32:35]
  v_mfma_f32_16x16x32_bf16 v[40:43], v[16:19], v[228:231], v[40:43]
  ds_read_b64_tr_b16 v[16:17], v5 offset:40960
  ds_read_b64_tr_b16 v[18:19], v5 offset:41216
  s_waitcnt lgkmcnt(8)
  v_mfma_f32_16x16x32_bf16 v[36:39], v[20:23], v[224:227], v[36:39]
  v_mfma_f32_16x16x32_bf16 v[44:47], v[20:23], v[228:231], v[44:47]
  s_add_u32 s31, s34, 2
  s_and_b32 s31, s31, 7
  s_lshl_b32 s31, s31, 19
  s_add_u32 m0, s40, 16384
  s_add_u32 s31, s31, s35
  buffer_load_dwordx4 v1, s[16:19], s31 offen lds
  ds_read_b64_tr_b16 v[20:21], v4 offset:41472
  ds_read_b64_tr_b16 v[22:23], v4 offset:41728
  s_waitcnt lgkmcnt(8)
  v_mfma_f32_16x16x32_bf16 v[48:51], v[24:27], v[224:227], v[48:51]
  v_mfma_f32_16x16x32_bf16 v[56:59], v[24:27], v[228:231], v[56:59]
  s_add_u32 s31, s34, 3
  s_and_b32 s31, s31, 7
  s_lshl_b32 s31, s31, 19
  s_add_u32 m0, s40, 24576
  s_add_u32 s31, s31, s35
  buffer_load_dwordx4 v1, s[16:19], s31 offen lds
  ds_read_b64_tr_b16 v[24:25], v5 offset:41472
  ds_read_b64_tr_b16 v[26:27], v5 offset:41728
  s_waitcnt lgkmcnt(8)
  v_mfma_f32_16x16x32_bf16 v[52:55], v[28:31], v[224:227], v[52:55]
  v_mfma_f32_16x16x32_bf16 v[60:63], v[28:31], v[228:231], v[60:63]
  ds_read_b64_tr_b16 v[28:29], v4 offset:36864
  ds_read_b64_tr_b16 v[30:31], v4 offset:37120
  s_waitcnt lgkmcnt(8)
  v_mfma_f32_16x16x32_bf16 v[64:67], v[12:15], v[224:227], v[64:67]
  v_mfma_f32_16x16x32_bf16 v[72:75], v[12:15], v[228:231], v[72:75]
  ds_read_b64_tr_b16 v[12:13], v5 offset:36864
  ds_read_b64_tr_b16 v[14:15], v5 offset:37120
  s_waitcnt lgkmcnt(8)
  v_mfma_f32_16x16x32_bf16 v[68:71], v[16:19], v[224:227], v[68:71]
  v_mfma_f32_16x16x32_bf16 v[76:79], v[16:19], v[228:231], v[76:79]
  ds_read_b64_tr_b16 v[16:17], v4 offset:37376
  ds_read_b64_tr_b16 v[18:19], v4 offset:37632
  s_waitcnt lgkmcnt(8)
  v_mfma_f32_16x16x32_bf16 v[80:83], v[20:23], v[224:227], v[80:83]
  v_mfma_f32_16x16x32_bf16 v[88:91], v[20:23], v[228:231], v[88:91]
  ds_read_b64_tr_b16 v[20:21], v5 offset:37376
  ds_read_b64_tr_b16 v[22:23], v5 offset:37632
  s_waitcnt lgkmcnt(8)
  v_mfma_f32_16x16x32_bf16 v[84:87], v[24:27], v[224:227], v[84:87]
  v_mfma_f32_16x16x32_bf16 v[92:95], v[24:27], v[228:231], v[92:95]
  ds_read_b64_tr_b16 v[24:25], v4 offset:45056
  ds_read_b64_tr_b16 v[26:27], v4 offset:45312
  s_waitcnt lgkmcnt(8)
  v_mfma_f32_16x16x32_bf16 v[32:35], v[28:31], v[232:235], v[32:35]
  v_mfma_f32_16x16x32_bf16 v[40:43], v[28:31], v[236:239], v[40:43]
  ds_read_b64_tr_b16 v[28:29], v5 offset:45056
  ds_read_b64_tr_b16 v[30:31], v5 offset:45312
  s_waitcnt lgkmcnt(8)
  v_mfma_f32_16x16x32_bf16 v[36:39], v[12:15], v[232:235], v[36:39]
  v_mfma_f32_16x16x32_bf16 v[44:47], v[12:15], v[236:239], v[44:47]
  ds_read_b64_tr_b16 v[12:13], v4 offset:45568
  ds_read_b64_tr_b16 v[14:15], v4 offset:45824
  s_waitcnt lgkmcnt(8)
  v_mfma_f32_16x16x32_bf16 v[48:51], v[16:19], v[232:235], v[48:51]
  v_mfma_f32_16x16x32_bf16 v[56:59], v[16:19], v[236:239], v[56:59]
  ds_read_b64_tr_b16 v[16:17], v5 offset:45568
  ds_read_b64_tr_b16 v[18:19], v5 offset:45824
  s_waitcnt lgkmcnt(8)
  v_mfma_f32_16x16x32_bf16 v[52:55], v[20:23], v[232:235], v[52:55]
  v_mfma_f32_16x16x32_bf16 v[60:63], v[20:23], v[236:239], v[60:63]
  s_waitcnt vmcnt(2)
  ds_read_b128 v[240:243], v6 offset:4096
  ds_read_b128 v[244:247], v6 offset:6144
  ds_read_b128 v[248:251], v7 offset:4096
  ds_read_b128 v[252:255], v7 offset:6144
  ds_read_b64_tr_b16 v[20:21], v4 offset:49152
  ds_read_b64_tr_b16 v[22:23], v4 offset:49408
  s_waitcnt lgkmcnt(12)
  v_mfma_f32_16x16x32_bf16 v[64:67], v[24:27], v[232:235], v[64:67]
  v_mfma_f32_16x16x32_bf16 v[72:75], v[24:27], v[236:239], v[72:75]
  s_cmp_lg_u32 s30, 0
  s_cbranch_scc1 Lsig_1
  v_mov_b32 v11, 1
  s_mov_b64 exec, 1
  buffer_atomic_add v11, off, s[72:75], 0 sc1
  s_mov_b64 exec, -1
  s_branch Lsig_2
Lsig_1:
  buffer_load_dword v11, off, s[72:75], s61
Lsig_2:
  ds_read_b64_tr_b16 v[24:25], v5 offset:49152
  ds_read_b64_tr_b16 v[26:27], v5 offset:49408
  s_waitcnt lgkmcnt(12)
  v_mfma_f32_16x16x32_bf16 v[68:71], v[28:31], v[232:235], v[68:71]
  v_mfma_f32_16x16x32_bf16 v[76:79], v[28:31], v[236:239], v[76:79]
  ds_read_b64_tr_b16 v[28:29], v4 offset:49664
  ds_read_b64_tr_b16 v[30:31], v4 offset:49920
  s_waitcnt lgkmcnt(12)
  v_mfma_f32_16x16x32_bf16 v[80:83], v[12:15], v[232:235], v[80:83]
  v_mfma_f32_16x16x32_bf16 v[88:91], v[12:15], v[236:239], v[88:91]
  ds_read_b64_tr_b16 v[12:13], v5 offset:49664
  ds_read_b64_tr_b16 v[14:15], v5 offset:49920
  s_waitcnt lgkmcnt(12)
  v_mfma_f32_16x16x32_bf16 v[84:87], v[16:19], v[232:235], v[84:87]
  v_mfma_f32_16x16x32_bf16 v[92:95], v[16:19], v[236:239], v[92:95]
  s_barrier
  ds_read_b64_tr_b16 v[16:17], v4 offset:57344
  ds_read_b64_tr_b16 v[18:19], v4 offset:57600
  s_waitcnt lgkmcnt(8)
  v_mfma_f32_16x16x32_bf16 v[32:35], v[20:23], v[240:243], v[32:35]
  v_mfma_f32_16x16x32_bf16 v[40:43], v[20:23], v[244:247], v[40:43]
  ds_read_b64_tr_b16 v[20:21], v5 offset:57344
  ds_read_b64_tr_b16 v[22:23], v5 offset:57600
  s_waitcnt lgkmcnt(8)
  v_mfma_f32_16x16x32_bf16 v[36:39], v[24:27], v[240:243], v[36:39]
  v_mfma_f32_16x16x32_bf16 v[44:47], v[24:27], v[244:247], v[44:47]
  s_add_u32 s31, s34, 4
  s_and_b32 s31, s31, 7
  s_lshl_b32 s31, s31, 19
  s_add_u32 m0, s40, 32768
  s_add_u32 s31, s31, s35
  buffer_load_dwordx4 v1, s[16:19], s31 offen lds
  ds_read_b64_tr_b16 v[24:25], v4 offset:57856
  ds_read_b64_tr_b16 v[26:27], v4 offset:58112
  s_waitcnt lgkmcnt(8)
  v_mfma_f32_16x16x32_bf16 v[48:51], v[28:31], v[240:243], v[48:51]
  v_mfma_f32_16x16x32_bf16 v[56:59], v[28:31], v[244:247], v[56:59]
  s_add_u32 s31, s34, 5
  s_and_b32 s31, s31, 7
  s_lshl_b32 s31, s31, 19
  s_add_u32 m0, s40, 40960
  s_add_u32 s31, s31, s35
  buffer_load_dwordx4 v1, s[16:19], s31 offen lds
  ds_read_b64_tr_b16 v[28:29], v5 offset:57856
  ds_read_b64_tr_b16 v[30:31], v5 offset:58112
  s_waitcnt lgkmcnt(8)
  v_mfma_f32_16x16x32_bf16 v[52:55], v[12:15], v[240:243], v[52:55]
  v_mfma_f32_16x16x32_bf16 v[60:63], v[12:15], v[244:247], v[60:63]
  ds_read_b64_tr_b16 v[12:13], v4 offset:53248
  ds_read_b64_tr_b16 v[14:15], v4 offset:53504
  s_waitcnt lgkmcnt(8)
  v_mfma_f32_16x16x32_bf16 v[64:67], v[16:19], v[240:243], v[64:67]
  v_mfma_f32_16x16x32_bf16 v[72:75], v[16:19], v[244:247], v[72:75]
  ds_read_b64_tr_b16 v[16:17], v5 offset:53248
  ds_read_b64_tr_b16 v[18:19], v5 offset:53504
  s_waitcnt lgkmcnt(8)
  v_mfma_f32_16x16x32_bf16 v[68:71], v[20:23], v[240:243], v[68:71]
  v_mfma_f32_16x16x32_bf16 v[76:79], v[20:23], v[244:247], v[76:79]
  ds_read_b64_tr_b16 v[20:21], v4 offset:53760
  ds_read_b64_tr_b16 v[22:23], v4 offset:54016
  s_waitcnt lgkmcnt(8)
  v_mfma_f32_16x16x32_bf16 v[80:83], v[24:27], v[240:243], v[80:83]
  v_mfma_f32_16x16x32_bf16 v[88:91], v[24:27], v[244:247], v[88:91]
  ds_read_b64_tr_b16 v[24:25], v5 offset:53760
  ds_read_b64_tr_b16 v[26:27], v5 offset:54016
  s_waitcnt lgkmcnt(8)
  v_mfma_f32_16x16x32_bf16 v[84:87], v[28:31], v[240:243], v[84:87]
  v_mfma_f32_16x16x32_bf16 v[92:95], v[28:31], v[244:247], v[92:95]
  ds_read_b64_tr_b16 v[28:29], v4 offset:61440
  ds_read_b64_tr_b16 v[30:31], v4 offset:61696
  s_waitcnt lgkmcnt(8)
  v_mfma_f32_16x16x32_bf16 v[32:35], v[12:15], v[248:251], v[32:35]
  v_mfma_f32_16x16x32_bf16 v[40:43], v[12:15], v[252:255], v[40:43]
  ds_read_b64_tr_b16 v[12:13], v5 offset:61440
  ds_read_b64_tr_b16 v[14:15], v5 offset:61696
  s_waitcnt lgkmcnt(8)
  v_mfma_f32_16x16x32_bf16 v[36:39], v[16:19], v[248:251], v[36:39]
  v_mfma_f32_16x16x32_bf16 v[44:47], v[16:19], v[252:255], v[44:47]
  ds_read_b64_tr_b16 v[16:17], v4 offset:61952
  ds_read_b64_tr_b16 v[18:19], v4 offset:62208
  s_waitcnt lgkmcnt(8)
  v_mfma_f32_16x16x32_bf16 v[48:51], v[20:23], v[248:251], v[48:51]
  v_mfma_f32_16x16x32_bf16 v[56:59], v[20:23], v[252:255], v[56:59]
  ds_read_b64_tr_b16 v[20:21], v5 offset:61952
  ds_read_b64_tr_b16 v[22:23], v5 offset:62208
  s_waitcnt lgkmcnt(8)
  v_mfma_f32_16x16x32_bf16 v[52:55], v[24:27], v[248:251], v[52:55]
  v_mfma_f32_16x16x32_bf16 v[60:63], v[24:27], v[252:255], v[60:63]
  s_waitcnt vmcnt(3)
  ds_read_b64_tr_b16 v[24:25], v4 offset:0
  ds_read_b64_tr_b16 v[26:27], v4 offset:256
  s_waitcnt lgkmcnt(8)
  v_mfma_f32_16x16x32_bf16 v[64:67], v[28:31], v[248:251], v[64:67]
  v_mfma_f32_16x16x32_bf16 v[72:75], v[28:31], v[252:255], v[72:75]
  ds_read_b64_tr_b16 v[28:29], v5 offset:0
  ds_read_b64_tr_b16 v[30:31], v5 offset:256
  s_waitcnt lgkmcnt(8)
  v_mfma_f32_16x16x32_bf16 v[68:71], v[12:15], v[248:251], v[68:71]
  v_mfma_f32_16x16x32_bf16 v[76:79], v[12:15], v[252:255], v[76:79]
  ds_read_b64_tr_b16 v[12:13], v4 offset:512
  ds_read_b64_tr_b16 v[14:15], v4 offset:768
  s_waitcnt lgkmcnt(8)
  v_mfma_f32_16x16x32_bf16 v[80:83], v[16:19], v[248:251], v[80:83]
  v_mfma_f32_16x16x32_bf16 v[88:91], v[16:19], v[252:255], v[88:91]
  ds_read_b64_tr_b16 v[16:17], v5 offset:512
  ds_read_b64_tr_b16 v[18:19], v5 offset:768
  s_waitcnt lgkmcnt(8)
  v_mfma_f32_16x16x32_bf16 v[84:87], v[20:23], v[248:251], v[84:87]
  v_mfma_f32_16x16x32_bf16 v[92:95], v[20:23], v[252:255], v[92:95]
  s_barrier
  ds_read_b64_tr_b16 v[20:21], v4 offset:4096
  ds_read_b64_tr_b16 v[22:23], v4 offset:4352
  s_waitcnt lgkmcnt(8)
  v_mfma_f32_16x16x32_bf16 v[96:99], v[128:131], v[24:27], 0
  v_mfma_f32_16x16x32_bf16 v[100:103], v[132:135], v[24:27], 0
  ds_read_b64_tr_b16 v[24:25], v5 offset:4096
  ds_read_b64_tr_b16 v[26:27], v5 offset:4352
  s_waitcnt lgkmcnt(8)
  v_mfma_f32_16x16x32_bf16 v[104:107], v[128:131], v[28:31], 0
  v_mfma_f32_16x16x32_bf16 v[108:111], v[132:135], v[28:31], 0
  s_add_u32 s31, s34, 6
  s_and_b32 s31, s31, 7
  s_lshl_b32 s31, s31, 19
  s_add_u32 m0, s40, 49152
  s_add_u32 s31, s31, s35
  buffer_load_dwordx4 v1, s[16:19], s31 offen lds
  v_lshlrev_b32 v2, 4, v0
  v_add_u32 v6, 0x10000, v4
  v_add_u32 v7, 0x10000, v5
  v_and_b32 v3, 31, v0
  s_lshl_b32 s31, s54, 5
  v_add_u32 v3, s31, v3
  v_lshrrev_b32 v10, 5, v0
  v_lshlrev_b32 v10, 2, v10
  v_sub_u32 v3, v3, v10
  ds_read_b64_tr_b16 v[28:29], v4 offset:4608
  ds_read_b64_tr_b16 v[30:31], v4 offset:4864
  s_waitcnt lgkmcnt(8)
  v_mfma_f32_16x16x32_bf16 v[112:115], v[128:131], v[12:15], 0
  v_mfma_f32_16x16x32_bf16 v[116:119], v[132:135], v[12:15], 0
  s_add_u32 s31, s34, 7
  s_and_b32 s31, s31, 7
  s_lshl_b32 s31, s31, 19
  s_add_u32 m0, s40, 57344
  s_add_u32 s31, s31, s35
  buffer_load_dwordx4 v1, s[16:19], s31 offen lds
  ds_read_b64_tr_b16 v[12:13], v5 offset:4608
  ds_read_b64_tr_b16 v[14:15], v5 offset:4864
  s_waitcnt lgkmcnt(8)
  v_mfma_f32_16x16x32_bf16 v[120:123], v[128:131], v[16:19], 0
  v_mfma_f32_16x16x32_bf16 v[124:127], v[132:135], v[16:19], 0
  v_cvt_pk_bf16_f32 v32, v32, v33
  ds_read_b64_tr_b16 v[16:17], v4 offset:8192
  ds_read_b64_tr_b16 v[18:19], v4 offset:8448
  s_waitcnt lgkmcnt(8)
  v_mfma_f32_16x16x32_bf16 v[96:99], v[136:139], v[20:23], v[96:99]
  v_mfma_f32_16x16x32_bf16 v[100:103], v[140:143], v[20:23], v[100:103]
  v_cvt_pk_bf16_f32 v33, v34, v35
  ds_read_b64_tr_b16 v[20:21], v5 offset:8192
  ds_read_b64_tr_b16 v[22:23], v5 offset:8448
  s_waitcnt lgkmcnt(8)
  v_mfma_f32_16x16x32_bf16 v[104:107], v[136:139], v[24:27], v[104:107]
  v_mfma_f32_16x16x32_bf16 v[108:111], v[140:143], v[24:27], v[108:111]
  v_cvt_pk_bf16_f32 v34, v36, v37
  ds_read_b64_tr_b16 v[24:25], v4 offset:8704
  ds_read_b64_tr_b16 v[26:27], v4 offset:8960
  s_waitcnt lgkmcnt(8)
  v_mfma_f32_16x16x32_bf16 v[112:115], v[136:139], v[28:31], v[112:115]
  v_mfma_f32_16x16x32_bf16 v[116:119], v[140:143], v[28:31], v[116:119]
  v_cvt_pk_bf16_f32 v35, v38, v39
  ds_read_b64_tr_b16 v[28:29], v5 offset:8704
  ds_read_b64_tr_b16 v[30:31], v5 offset:8960
  s_waitcnt lgkmcnt(8)
  v_mfma_f32_16x16x32_bf16 v[120:123], v[136:139], v[12:15], v[120:123]
  v_mfma_f32_16x16x32_bf16 v[124:127], v[140:143], v[12:15], v[124:127]
  s_add_u32 s33, s36, 0
  ds_read_b64_tr_b16 v[12:13], v4 offset:12288
  ds_read_b64_tr_b16 v[14:15], v4 offset:12544
  s_waitcnt lgkmcnt(8)
  v_mfma_f32_16x16x32_bf16 v[96:99], v[144:147], v[16:19], v[96:99]
  v_mfma_f32_16x16x32_bf16 v[100:103], v[148:151], v[16:19], v[100:103]
  buffer_store_dwordx4 v[32:35], v8, s[24:27], s33 offen offset:0 sc1
  ds_read_b64_tr_b16 v[16:17], v5 offset:12288
  ds_read_b64_tr_b16 v[18:19], v5 offset:12544
  s_waitcnt lgkmcnt(8)
  v_mfma_f32_16x16x32_bf16 v[104:107], v[144:147], v[20:23], v[104:107]
  v_mfma_f32_16x16x32_bf16 v[108:111], v[148:151], v[20:23], v[108:111]
  v_cvt_pk_bf16_f32 v40, v40, v41
  ds_read_b64_tr_b16 v[20:21], v4 offset:12800
  ds_read_b64_tr_b16 v[22:23], v4 offset:13056
  s_waitcnt lgkmcnt(8)
  v_mfma_f32_16x16x32_bf16 v[112:115], v[144:147], v[24:27], v[112:115]
  v_mfma_f32_16x16x32_bf16 v[116:119], v[148:151], v[24:27], v[116:119]
  v_cvt_pk_bf16_f32 v41, v42, v43
  ds_read_b64_tr_b16 v[24:25], v5 offset:12800
  ds_read_b64_tr_b16 v[26:27], v5 offset:13056
  s_waitcnt lgkmcnt(8)
  v_mfma_f32_16x16x32_bf16 v[120:123], v[144:147], v[28:31], v[120:123]
  v_mfma_f32_16x16x32_bf16 v[124:127], v[148:151], v[28:31], v[124:127]
  s_waitcnt vmcnt(3)
  v_cvt_pk_bf16_f32 v42, v44, v45
  ds_read_b64_tr_b16 v[28:29], v4 offset:16384
  ds_read_b64_tr_b16 v[30:31], v4 offset:16640
  s_waitcnt lgkmcnt(8)
  v_mfma_f32_16x16x32_bf16 v[96:99], v[152:155], v[12:15], v[96:99]
  v_mfma_f32_16x16x32_bf16 v[100:103], v[156:159], v[12:15], v[100:103]
  v_cvt_pk_bf16_f32 v43, v46, v47
  ds_read_b64_tr_b16 v[12:13], v5 offset:16384
  ds_read_b64_tr_b16 v[14:15], v5 offset:16640
  s_waitcnt lgkmcnt(8)
  v_mfma_f32_16x16x32_bf16 v[104:107], v[152:155], v[16:19], v[104:107]
  v_mfma_f32_16x16x32_bf16 v[108:111], v[156:159], v[16:19], v[108:111]
  s_add_u32 s33, s36, 0
  ds_read_b64_tr_b16 v[16:17], v4 offset:16896
  ds_read_b64_tr_b16 v[18:19], v4 offset:17152
  s_waitcnt lgkmcnt(8)
  v_mfma_f32_16x16x32_bf16 v[112:115], v[152:155], v[20:23], v[112:115]
  v_mfma_f32_16x16x32_bf16 v[116:119], v[156:159], v[20:23], v[116:119]
  buffer_store_dwordx4 v[40:43], v8, s[24:27], s33 offen offset:128 sc1
  ds_read_b64_tr_b16 v[20:21], v5 offset:16896
  ds_read_b64_tr_b16 v[22:23], v5 offset:17152
  s_waitcnt lgkmcnt(8)
  v_mfma_f32_16x16x32_bf16 v[120:123], v[152:155], v[24:27], v[120:123]
  v_mfma_f32_16x16x32_bf16 v[124:127], v[156:159], v[24:27], v[124:127]
  v_cvt_pk_bf16_f32 v48, v48, v49
  s_barrier
  ds_read_b64_tr_b16 v[24:25], v4 offset:20480
  ds_read_b64_tr_b16 v[26:27], v4 offset:20736
  s_waitcnt lgkmcnt(8)
  v_mfma_f32_16x16x32_bf16 v[96:99], v[160:163], v[28:31], v[96:99]
  v_mfma_f32_16x16x32_bf16 v[100:103], v[164:167], v[28:31], v[100:103]
  ds_read_b64_tr_b16 v[28:29], v5 offset:20480
  ds_read_b64_tr_b16 v[30:31], v5 offset:20736
  s_waitcnt lgkmcnt(8)
  v_mfma_f32_16x16x32_bf16 v[104:107], v[160:163], v[12:15], v[104:107]
  v_mfma_f32_16x16x32_bf16 v[108:111], v[164:167], v[12:15], v[108:111]
  s_add_u32 s31, s34, 0
  s_and_b32 s31, s31, 7
  s_lshl_b32 s31, s31, 19
  s_add_u32 m0, s40, 0
  s_add_u32 s31, s31, s35
  s_add_u32 s31, s31, 128
  buffer_load_dwordx4 v1, s[16:19], s31 offen lds
  ds_read_b64_tr_b16 v[12:13], v4 offset:20992
  ds_read_b64_tr_b16 v[14:15], v4 offset:21248
  s_waitcnt lgkmcnt(8)
  v_mfma_f32_16x16x32_bf16 v[112:115], v[160:163], v[16:19], v[112:115]
  v_mfma_f32_16x16x32_bf16 v[116:119], v[164:167], v[16:19], v[116:119]
  s_add_u32 s31, s34, 1
  s_and_b32 s31, s31, 7
  s_lshl_b32 s31, s31, 19
  s_add_u32 m0, s40, 8192
  s_add_u32 s31, s31, s35
  s_add_u32 s31, s31, 128
  buffer_load_dwordx4 v1, s[16:19], s31 offen lds
  ds_read_b64_tr_b16 v[16:17], v5 offset:20992
  ds_read_b64_tr_b16 v[18:19], v5 offset:21248
  s_waitcnt lgkmcnt(8)
  v_mfma_f32_16x16x32_bf16 v[120:123], v[160:163], v[20:23], v[120:123]
  v_mfma_f32_16x16x32_bf16 v[124:127], v[164:167], v[20:23], v[124:127]
  v_cvt_pk_bf16_f32 v49, v50, v51
  ds_read_b64_tr_b16 v[20:21], v4 offset:24576
  ds_read_b64_tr_b16 v[22:23], v4 offset:24832
  s_waitcnt lgkmcnt(8)
  v_mfma_f32_16x16x32_bf16 v[96:99], v[168:171], v[24:27], v[96:99]
  v_mfma_f32_16x16x32_bf16 v[100:103], v[172:175], v[24:27], v[100:103]
  v_cvt_pk_bf16_f32 v50, v52, v53
  ds_read_b64_tr_b16 v[24:25], v5 offset:24576
  ds_read_b64_tr_b16 v[26:27], v5 offset:24832
  s_waitcnt lgkmcnt(8)
  v_mfma_f32_16x16x32_bf16 v[104:107], v[168:171], v[28:31], v[104:107]
  v_mfma_f32_16x16x32_bf16 v[108:111], v[172:175], v[28:31], v[108:111]
  v_cvt_pk_bf16_f32 v51, v54, v55
  ds_read_b64_tr_b16 v[28:29], v4 offset:25088
  ds_read_b64_tr_b16 v[30:31], v4 offset:25344
  s_waitcnt lgkmcnt(8)
  v_mfma_f32_16x16x32_bf16 v[112:115], v[168:171], v[12:15], v[112:115]
  v_mfma_f32_16x16x32_bf16 v[116:119], v[172:175], v[12:15], v[116:119]
  s_add_u32 s33, s36, 0
  ds_read_b64_tr_b16 v[12:13], v5 offset:25088
  ds_read_b64_tr_b16 v[14:15], v5 offset:25344
  s_waitcnt lgkmcnt(8)
  v_mfma_f32_16x16x32_bf16 v[120:123], v[168:171], v[16:19], v[120:123]
  v_mfma_f32_16x16x32_bf16 v[124:127], v[172:175], v[16:19], v[124:127]
  buffer_store_dwordx4 v[48:51], v8, s[24:27], s33 offen offset:2048 sc1
  ds_read_b64_tr_b16 v[16:17], v4 offset:28672
  ds_read_b64_tr_b16 v[18:19], v4 offset:28928
  s_waitcnt lgkmcnt(8)
  v_mfma_f32_16x16x32_bf16 v[96:99], v[176:179], v[20:23], v[96:99]
  v_mfma_f32_16x16x32_bf16 v[100:103], v[180:183], v[20:23], v[100:103]
  v_cvt_pk_bf16_f32 v56, v56, v57
  ds_read_b64_tr_b16 v[20:21], v5 offset:28672
  ds_read_b64_tr_b16 v[22:23], v5 offset:28928
  s_waitcnt lgkmcnt(8)
  v_mfma_f32_16x16x32_bf16 v[104:107], v[176:179], v[24:27], v[104:107]
  v_mfma_f32_16x16x32_bf16 v[108:111], v[180:183], v[24:27], v[108:111]
  v_cvt_pk_bf16_f32 v57, v58, v59
  ds_read_b64_tr_b16 v[24:25], v4 offset:29184
  ds_read_b64_tr_b16 v[26:27], v4 offset:29440
  s_waitcnt lgkmcnt(8)
  v_mfma_f32_16x16x32_bf16 v[112:115], v[176:179], v[28:31], v[112:115]
  v_mfma_f32_16x16x32_bf16 v[116:119], v[180:183], v[28:31], v[116:119]
  v_cvt_pk_bf16_f32 v58, v60, v61
  ds_read_b64_tr_b16 v[28:29], v5 offset:29184
  ds_read_b64_tr_b16 v[30:31], v5 offset:29440
  s_waitcnt lgkmcnt(8)
  v_mfma_f32_16x16x32_bf16 v[120:123], v[176:179], v[12:15], v[120:123]
  v_mfma_f32_16x16x32_bf16 v[124:127], v[180:183], v[12:15], v[124:127]
  s_waitcnt vmcnt(5)
  v_cvt_pk_bf16_f32 v59, v62, v63
  ds_read_b64_tr_b16 v[12:13], v4 offset:32768
  ds_read_b64_tr_b16 v[14:15], v4 offset:33024
  s_waitcnt lgkmcnt(8)
  v_mfma_f32_16x16x32_bf16 v[96:99], v[184:187], v[16:19], v[96:99]
  v_mfma_f32_16x16x32_bf16 v[100:103], v[188:191], v[16:19], v[100:103]
  s_add_u32 s33, s36, 0
  ds_read_b64_tr_b16 v[16:17], v5 offset:32768
  ds_read_b64_tr_b16 v[18:19], v5 offset:33024
  s_waitcnt lgkmcnt(8)
  v_mfma_f32_16x16x32_bf16 v[104:107], v[184:187], v[20:23], v[104:107]
  v_mfma_f32_16x16x32_bf16 v[108:111], v[188:191], v[20:23], v[108:111]
  buffer_store_dwordx4 v[56:59], v8, s[24:27], s33 offen offset:2176 sc1
  ds_read_b64_tr_b16 v[20:21], v4 offset:33280
  ds_read_b64_tr_b16 v[22:23], v4 offset:33536
  s_waitcnt lgkmcnt(8)
  v_mfma_f32_16x16x32_bf16 v[112:115], v[184:187], v[24:27], v[112:115]
  v_mfma_f32_16x16x32_bf16 v[116:119], v[188:191], v[24:27], v[116:119]
  v_cvt_pk_bf16_f32 v64, v64, v65
  ds_read_b64_tr_b16 v[24:25], v5 offset:33280
  ds_read_b64_tr_b16 v[26:27], v5 offset:33536
  s_waitcnt lgkmcnt(8)
  v_mfma_f32_16x16x32_bf16 v[120:123], v[184:187], v[28:31], v[120:123]
  v_mfma_f32_16x16x32_bf16 v[124:127], v[188:191], v[28:31], v[124:127]
  v_cvt_pk_bf16_f32 v65, v66, v67
  s_barrier
  ds_read_b64_tr_b16 v[28:29], v4 offset:36864
  ds_read_b64_tr_b16 v[30:31], v4 offset:37120
  s_waitcnt lgkmcnt(8)
  v_mfma_f32_16x16x32_bf16 v[96:99], v[192:195], v[12:15], v[96:99]
  v_mfma_f32_16x16x32_bf16 v[100:103], v[196:199], v[12:15], v[100:103]
  ds_read_b64_tr_b16 v[12:13], v5 offset:36864
  ds_read_b64_tr_b16 v[14:15], v5 offset:37120
  s_waitcnt lgkmcnt(8)
  v_mfma_f32_16x16x32_bf16 v[104:107], v[192:195], v[16:19], v[104:107]
  v_mfma_f32_16x16x32_bf16 v[108:111], v[196:199], v[16:19], v[108:111]
  s_add_u32 s31, s34, 2
  s_and_b32 s31, s31, 7
  s_lshl_b32 s31, s31, 19
  s_add_u32 m0, s40, 16384
  s_add_u32 s31, s31, s35
  s_add_u32 s31, s31, 128
  buffer_load_dwordx4 v1, s[16:19], s31 offen lds
  ds_read_b64_tr_b16 v[16:17], v4 offset:37376
  ds_read_b64_tr_b16 v[18:19], v4 offset:37632
  s_waitcnt lgkmcnt(8)
  v_mfma_f32_16x16x32_bf16 v[112:115], v[192:195], v[20:23], v[112:115]
  v_mfma_f32_16x16x32_bf16 v[116:119], v[196:199], v[20:23], v[116:119]
  s_add_u32 s31, s34, 3
  s_and_b32 s31, s31, 7
  s_lshl_b32 s31, s31, 19
  s_add_u32 m0, s40, 24576
  s_add_u32 s31, s31, s35
  s_add_u32 s31, s31, 128
  buffer_load_dwordx4 v1, s[16:19], s31 offen lds
  s_cmp_lg_u32 s30, 0
  s_cbranch_scc1 Lw1_3
  buffer_load_dword v10, off, s[72:75], 0 sc1
Lw1_3:
  ds_read_b64_tr_b16 v[20:21], v5 offset:37376
  ds_read_b64_tr_b16 v[22:23], v5 offset:37632
  s_waitcnt lgkmcnt(8)
  v_mfma_f32_16x16x32_bf16 v[120:123], v[192:195], v[24:27], v[120:123]
  v_mfma_f32_16x16x32_bf16 v[124:127], v[196:199], v[24:27], v[124:127]
  v_cvt_pk_bf16_f32 v66, v68, v69
  ds_read_b64_tr_b16 v[24:25], v4 offset:40960
  ds_read_b64_tr_b16 v[26:27], v4 offset:41216
  s_waitcnt lgkmcnt(8)
  v_mfma_f32_16x16x32_bf16 v[96:99], v[200:203], v[28:31], v[96:99]
  v_mfma_f32_16x16x32_bf16 v[100:103], v[204:207], v[28:31], v[100:103]
  v_cvt_pk_bf16_f32 v67, v70, v71
  ds_read_b64_tr_b16 v[28:29], v5 offset:40960
  ds_read_b64_tr_b16 v[30:31], v5 offset:41216
  s_waitcnt lgkmcnt(8)
  v_mfma_f32_16x16x32_bf16 v[104:107], v[200:203], v[12:15], v[104:107]
  v_mfma_f32_16x16x32_bf16 v[108:111], v[204:207], v[12:15], v[108:111]
  s_add_u32 s33, s36, 4096
  ds_read_b64_tr_b16 v[12:13], v4 offset:41472
  ds_read_b64_tr_b16 v[14:15], v4 offset:41728
  s_waitcnt lgkmcnt(8)
  v_mfma_f32_16x16x32_bf16 v[112:115], v[200:203], v[16:19], v[112:115]
  v_mfma_f32_16x16x32_bf16 v[116:119], v[204:207], v[16:19], v[116:119]
  buffer_store_dwordx4 v[64:67], v8, s[24:27], s33 offen offset:0 sc1
  ds_read_b64_tr_b16 v[16:17], v5 offset:41472
  ds_read_b64_tr_b16 v[18:19], v5 offset:41728
  s_waitcnt lgkmcnt(8)
  v_mfma_f32_16x16x32_bf16 v[120:123], v[200:203], v[20:23], v[120:123]
  v_mfma_f32_16x16x32_bf16 v[124:127], v[204:207], v[20:23], v[124:127]
  v_cvt_pk_bf16_f32 v72, v72, v73
  ds_read_b64_tr_b16 v[20:21], v4 offset:45056
  ds_read_b64_tr_b16 v[22:23], v4 offset:45312
  s_waitcnt lgkmcnt(8)
  v_mfma_f32_16x16x32_bf16 v[96:99], v[208:211], v[24:27], v[96:99]
  v_mfma_f32_16x16x32_bf16 v[100:103], v[212:215], v[24:27], v[100:103]
  v_cvt_pk_bf16_f32 v73, v74, v75
  ds_read_b64_tr_b16 v[24:25], v5 offset:45056
  ds_read_b64_tr_b16 v[26:27], v5 offset:45312
  s_waitcnt lgkmcnt(8)
  v_mfma_f32_16x16x32_bf16 v[104:107], v[208:211], v[28:31], v[104:107]
  v_mfma_f32_16x16x32_bf16 v[108:111], v[212:215], v[28:31], v[108:111]
  v_cvt_pk_bf16_f32 v74, v76, v77
  ds_read_b64_tr_b16 v[28:29], v4 offset:45568
  ds_read_b64_tr_b16 v[30:31], v4 offset:45824
  s_waitcnt lgkmcnt(8)
  v_mfma_f32_16x16x32_bf16 v[112:115], v[208:211], v[12:15], v[112:115]
  v_mfma_f32_16x16x32_bf16 v[116:119], v[212:215], v[12:15], v[116:119]
  v_cvt_pk_bf16_f32 v75, v78, v79
  ds_read_b64_tr_b16 v[12:13], v5 offset:45568
  ds_read_b64_tr_b16 v[14:15], v5 offset:45824
  s_waitcnt lgkmcnt(8)
  v_mfma_f32_16x16x32_bf16 v[120:123], v[208:211], v[16:19], v[120:123]
  v_mfma_f32_16x16x32_bf16 v[124:127], v[212:215], v[16:19], v[124:127]
  s_waitcnt vmcnt(5)
  s_add_u32 s33, s36, 4096
  ds_read_b64_tr_b16 v[16:17], v4 offset:49152
  ds_read_b64_tr_b16 v[18:19], v4 offset:49408
  s_waitcnt lgkmcnt(8)
  v_mfma_f32_16x16x32_bf16 v[96:99], v[216:219], v[20:23], v[96:99]
  v_mfma_f32_16x16x32_bf16 v[100:103], v[220:223], v[20:23], v[100:103]
  buffer_store_dwordx4 v[72:75], v8, s[24:27], s33 offen offset:128 sc1
  ds_read_b64_tr_b16 v[20:21], v5 offset:49152
  ds_read_b64_tr_b16 v[22:23], v5 offset:49408
  s_waitcnt lgkmcnt(8)
  v_mfma_f32_16x16x32_bf16 v[104:107], v[216:219], v[24:27], v[104:107]
  v_mfma_f32_16x16x32_bf16 v[108:111], v[220:223], v[24:27], v[108:111]
  ds_read_b64_tr_b16 v[24:25], v4 offset:49664
  ds_read_b64_tr_b16 v[26:27], v4 offset:49920
  s_waitcnt lgkmcnt(8)
  v_mfma_f32_16x16x32_bf16 v[112:115], v[216:219], v[28:31], v[112:115]
  v_mfma_f32_16x16x32_bf16 v[116:119], v[220:223], v[28:31], v[116:119]
  ds_read_b64_tr_b16 v[28:29], v5 offset:49664
  ds_read_b64_tr_b16 v[30:31], v5 offset:49920
  s_waitcnt lgkmcnt(8)
  v_mfma_f32_16x16x32_bf16 v[120:123], v[216:219], v[12:15], v[120:123]
  v_mfma_f32_16x16x32_bf16 v[124:127], v[220:223], v[12:15], v[124:127]
  s_barrier
  ds_read_b64_tr_b16 v[12:13], v4 offset:53248
  ds_read_b64_tr_b16 v[14:15], v4 offset:53504
  s_waitcnt lgkmcnt(8)
  v_mfma_f32_16x16x32_bf16 v[96:99], v[224:227], v[16:19], v[96:99]
  v_mfma_f32_16x16x32_bf16 v[100:103], v[228:231], v[16:19], v[100:103]
  ds_read_b64_tr_b16 v[16:17], v5 offset:53248
  ds_read_b64_tr_b16 v[18:19], v5 offset:53504
  s_waitcnt lgkmcnt(8)
  v_mfma_f32_16x16x32_bf16 v[104:107], v[224:227], v[20:23], v[104:107]
  v_mfma_f32_16x16x32_bf16 v[108:111], v[228:231], v[20:23], v[108:111]
  s_add_u32 s31, s34, 4
  s_and_b32 s31, s31, 7
  s_lshl_b32 s31, s31, 19
  s_add_u32 m0, s40, 32768
  s_add_u32 s31, s31, s35
  s_add_u32 s31, s31, 128
  buffer_load_dwordx4 v1, s[16:19], s31 offen lds
  ds_read_b64_tr_b16 v[20:21], v4 offset:53760
  ds_read_b64_tr_b16 v[22:23], v4 offset:54016
  s_waitcnt lgkmcnt(8)
  v_mfma_f32_16x16x32_bf16 v[112:115], v[224:227], v[24:27], v[112:115]
  v_mfma_f32_16x16x32_bf16 v[116:119], v[228:231], v[24:27], v[116:119]
  s_add_u32 s31, s34, 5
  s_and_b32 s31, s31, 7
  s_lshl_b32 s31, s31, 19
  s_add_u32 m0, s40, 40960
  s_add_u32 s31, s31, s35
  s_add_u32 s31, s31, 128
  buffer_load_dwordx4 v1, s[16:19], s31 offen lds
  ds_read_b64_tr_b16 v[24:25], v5 offset:53760
  ds_read_b64_tr_b16 v[26:27], v5 offset:54016
  s_waitcnt lgkmcnt(8)
  v_mfma_f32_16x16x32_bf16 v[120:123], v[224:227], v[28:31], v[120:123]
  v_mfma_f32_16x16x32_bf16 v[124:127], v[228:231], v[28:31], v[124:127]
  ds_read_b64_tr_b16 v[28:29], v4 offset:57344
  ds_read_b64_tr_b16 v[30:31], v4 offset:57600
  s_waitcnt lgkmcnt(8)
  v_mfma_f32_16x16x32_bf16 v[96:99], v[232:235], v[12:15], v[96:99]
  v_mfma_f32_16x16x32_bf16 v[100:103], v[236:239], v[12:15], v[100:103]
  ds_read_b64_tr_b16 v[12:13], v5 offset:57344
  ds_read_b64_tr_b16 v[14:15], v5 offset:57600
  s_waitcnt lgkmcnt(8)
  v_mfma_f32_16x16x32_bf16 v[104:107], v[232:235], v[16:19], v[104:107]
  v_mfma_f32_16x16x32_bf16 v[108:111], v[236:239], v[16:19], v[108:111]
  ds_read_b64_tr_b16 v[16:17], v4 offset:57856
  ds_read_b64_tr_b16 v[18:19], v4 offset:58112
  s_waitcnt lgkmcnt(8)
  v_mfma_f32_16x16x32_bf16 v[112:115], v[232:235], v[20:23], v[112:115]
  v_mfma_f32_16x16x32_bf16 v[116:119], v[236:239], v[20:23], v[116:119]
  ds_read_b64_tr_b16 v[20:21], v5 offset:57856
  ds_read_b64_tr_b16 v[22:23], v5 offset:58112
  s_waitcnt lgkmcnt(8)
  v_mfma_f32_16x16x32_bf16 v[120:123], v[232:235], v[24:27], v[120:123]
  v_mfma_f32_16x16x32_bf16 v[124:127], v[236:239], v[24:27], v[124:127]
  ds_read_b64_tr_b16 v[24:25], v4 offset:61440
  ds_read_b64_tr_b16 v[26:27], v4 offset:61696
  s_waitcnt lgkmcnt(8)
  v_mfma_f32_16x16x32_bf16 v[96:99], v[240:243], v[28:31], v[96:99]
  v_mfma_f32_16x16x32_bf16 v[100:103], v[244:247], v[28:31], v[100:103]
  ds_read_b64_tr_b16 v[28:29], v5 offset:61440
  ds_read_b64_tr_b16 v[30:31], v5 offset:61696
  s_waitcnt lgkmcnt(8)
  v_mfma_f32_16x16x32_bf16 v[104:107], v[240:243], v[12:15], v[104:107]
  v_mfma_f32_16x16x32_bf16 v[108:111], v[244:247], v[12:15], v[108:111]
  ds_read_b64_tr_b16 v[12:13], v4 offset:61952
  ds_read_b64_tr_b16 v[14:15], v4 offset:62208
  s_waitcnt lgkmcnt(8)
  v_mfma_f32_16x16x32_bf16 v[112:115], v[240:243], v[16:19], v[112:115]
  v_mfma_f32_16x16x32_bf16 v[116:119], v[244:247], v[16:19], v[116:119]
  ds_read_b64_tr_b16 v[16:17], v5 offset:61952
  ds_read_b64_tr_b16 v[18:19], v5 offset:62208
  s_waitcnt lgkmcnt(8)
  v_mfma_f32_16x16x32_bf16 v[120:123], v[240:243], v[20:23], v[120:123]
  v_mfma_f32_16x16x32_bf16 v[124:127], v[244:247], v[20:23], v[124:127]
  s_waitcnt vmcnt(4)
  ds_read_b64_tr_b16 v[20:21], v4 offset:0
  ds_read_b64_tr_b16 v[22:23], v4 offset:256
  s_waitcnt lgkmcnt(8)
  v_mfma_f32_16x16x32_bf16 v[96:99], v[248:251], v[24:27], v[96:99]
  v_mfma_f32_16x16x32_bf16 v[100:103], v[252:255], v[24:27], v[100:103]
  ds_read_b64_tr_b16 v[24:25], v5 offset:0
  ds_read_b64_tr_b16 v[26:27], v5 offset:256
  s_waitcnt lgkmcnt(8)
  v_mfma_f32_16x16x32_bf16 v[104:107], v[248:251], v[28:31], v[104:107]
  v_mfma_f32_16x16x32_bf16 v[108:111], v[252:255], v[28:31], v[108:111]
  ds_read_b64_tr_b16 v[28:29], v4 offset:512
  ds_read_b64_tr_b16 v[30:31], v4 offset:768
  s_waitcnt lgkmcnt(8)
  v_mfma_f32_16x16x32_bf16 v[112:115], v[248:251], v[12:15], v[112:115]
  v_mfma_f32_16x16x32_bf16 v[116:119], v[252:255], v[12:15], v[116:119]
  ds_read_b64_tr_b16 v[12:13], v5 offset:512
  ds_read_b64_tr_b16 v[14:15], v5 offset:768
  s_waitcnt lgkmcnt(8)
  v_mfma_f32_16x16x32_bf16 v[120:123], v[248:251], v[16:19], v[120:123]
  v_mfma_f32_16x16x32_bf16 v[124:127], v[252:255], v[16:19], v[124:127]
  s_barrier
  ds_read_b64_tr_b16 v[16:17], v4 offset:4096
  ds_read_b64_tr_b16 v[18:19], v4 offset:4352
  s_waitcnt lgkmcnt(8)
  v_mfma_f32_16x16x32_bf16 v[32:35], v[128:131], v[20:23], 0
  v_mfma_f32_16x16x32_bf16 v[36:39], v[132:135], v[20:23], 0
  ds_read_b64_tr_b16 v[20:21], v5 offset:4096
  ds_read_b64_tr_b16 v[22:23], v5 offset:4352
  s_waitcnt lgkmcnt(8)
  v_mfma_f32_16x16x32_bf16 v[40:43], v[128:131], v[24:27], 0
  v_mfma_f32_16x16x32_bf16 v[44:47], v[132:135], v[24:27], 0
  s_add_u32 s31, s34, 6
  s_and_b32 s31, s31, 7
  s_lshl_b32 s31, s31, 19
  s_add_u32 m0, s40, 49152
  s_add_u32 s31, s31, s35
  s_add_u32 s31, s31, 128
  buffer_load_dwordx4 v1, s[16:19], s31 offen lds
  ds_read_b64_tr_b16 v[24:25], v4 offset:4608
  ds_read_b64_tr_b16 v[26:27], v4 offset:4864
  s_waitcnt lgkmcnt(8)
  v_mfma_f32_16x16x32_bf16 v[48:51], v[128:131], v[28:31], 0
  v_mfma_f32_16x16x32_bf16 v[52:55], v[132:135], v[28:31], 0
  s_add_u32 s31, s34, 7
  s_and_b32 s31, s31, 7
  s_lshl_b32 s31, s31, 19
  s_add_u32 m0, s40, 57344
  s_add_u32 s31, s31, s35
  s_add_u32 s31, s31, 128
  buffer_load_dwordx4 v1, s[16:19], s31 offen lds
  ds_read_b64_tr_b16 v[28:29], v5 offset:4608
  ds_read_b64_tr_b16 v[30:31], v5 offset:4864
  s_waitcnt lgkmcnt(8)
  v_mfma_f32_16x16x32_bf16 v[56:59], v[128:131], v[12:15], 0
  v_mfma_f32_16x16x32_bf16 v[60:63], v[132:135], v[12:15], 0
  v_cvt_pk_bf16_f32 v80, v80, v81
  v_cvt_pk_bf16_f32 v81, v82, v83
  ds_read_b64_tr_b16 v[12:13], v4 offset:8192
  ds_read_b64_tr_b16 v[14:15], v4 offset:8448
  s_waitcnt lgkmcnt(8)
  v_mfma_f32_16x16x32_bf16 v[32:35], v[136:139], v[16:19], v[32:35]
  v_mfma_f32_16x16x32_bf16 v[36:39], v[140:143], v[16:19], v[36:39]
  v_cvt_pk_bf16_f32 v82, v84, v85
  v_cvt_pk_bf16_f32 v83, v86, v87
  ds_read_b64_tr_b16 v[16:17], v5 offset:8192
  ds_read_b64_tr_b16 v[18:19], v5 offset:8448
  s_waitcnt lgkmcnt(8)
  v_mfma_f32_16x16x32_bf16 v[40:43], v[136:139], v[20:23], v[40:43]
  v_mfma_f32_16x16x32_bf16 v[44:47], v[140:143], v[20:23], v[44:47]
  s_add_u32 s31, s34, 0
  s_and_b32 s31, s31, 7
  s_lshl_b32 s31, s31, 19
  s_add_u32 m0, s40, 65536
  s_add_u32 s31, s31, s35
  buffer_load_dwordx4 v1, s[20:23], s31 offen lds
  s_add_u32 s33, s36, 4096
  buffer_store_dwordx4 v[80:83], v8, s[24:27], s33 offen offset:2048 sc1
  ds_read_b64_tr_b16 v[20:21], v4 offset:8704
  ds_read_b64_tr_b16 v[22:23], v4 offset:8960
  s_waitcnt lgkmcnt(8)
  v_mfma_f32_16x16x32_bf16 v[48:51], v[136:139], v[24:27], v[48:51]
  v_mfma_f32_16x16x32_bf16 v[52:55], v[140:143], v[24:27], v[52:55]
  v_cvt_pk_bf16_f32 v88, v88, v89
  v_cvt_pk_bf16_f32 v89, v90, v91
  ds_read_b64_tr_b16 v[24:25], v5 offset:8704
  ds_read_b64_tr_b16 v[26:27], v5 offset:8960
  s_waitcnt lgkmcnt(8)
  v_mfma_f32_16x16x32_bf16 v[56:59], v[136:139], v[28:31], v[56:59]
  v_mfma_f32_16x16x32_bf16 v[60:63], v[140:143], v[28:31], v[60:63]
  v_cvt_pk_bf16_f32 v90, v92, v93
  v_cvt_pk_bf16_f32 v91, v94, v95
  ds_read_b64_tr_b16 v[28:29], v4 offset:12288
  ds_read_b64_tr_b16 v[30:31], v4 offset:12544
  s_waitcnt lgkmcnt(8)
  v_mfma_f32_16x16x32_bf16 v[32:35], v[144:147], v[12:15], v[32:35]
  v_mfma_f32_16x16x32_bf16 v[36:39], v[148:151], v[12:15], v[36:39]
  s_add_u32 s33, s36, 4096
  buffer_store_dwordx4 v[88:91], v8, s[24:27], s33 offen offset:2176 sc1
  ds_read_b64_tr_b16 v[12:13], v5 offset:12288
  ds_read_b64_tr_b16 v[14:15], v5 offset:12544
  s_waitcnt lgkmcnt(8)
  v_mfma_f32_16x16x32_bf16 v[40:43], v[144:147], v[16:19], v[40:43]
  v_mfma_f32_16x16x32_bf16 v[44:47], v[148:151], v[16:19], v[44:47]
  s_add_u32 s31, s34, 0
  s_and_b32 s31, s31, 7
  s_lshl_b32 s31, s31, 19
  s_add_u32 m0, s40, 73728
  s_add_u32 s31, s31, s35
  s_add_u32 s31, s31, 128
  buffer_load_dwordx4 v1, s[20:23], s31 offen lds
  v_cvt_pk_bf16_f32 v96, v96, v97
  v_cvt_pk_bf16_f32 v97, v98, v99
  ds_read_b64_tr_b16 v[16:17], v4 offset:12800
  ds_read_b64_tr_b16 v[18:19], v4 offset:13056
  s_waitcnt lgkmcnt(8)
  v_mfma_f32_16x16x32_bf16 v[48:51], v[144:147], v[20:23], v[48:51]
  v_mfma_f32_16x16x32_bf16 v[52:55], v[148:151], v[20:23], v[52:55]
  v_cvt_pk_bf16_f32 v98, v100, v101
  v_cvt_pk_bf16_f32 v99, v102, v103
  ds_read_b64_tr_b16 v[20:21], v5 offset:12800
  ds_read_b64_tr_b16 v[22:23], v5 offset:13056
  s_waitcnt lgkmcnt(8)
  v_mfma_f32_16x16x32_bf16 v[56:59], v[144:147], v[24:27], v[56:59]
  v_mfma_f32_16x16x32_bf16 v[60:63], v[148:151], v[24:27], v[60:63]
  s_waitcnt vmcnt(6)
  v_cvt_pk_bf16_f32 v104, v104, v105
  v_cvt_pk_bf16_f32 v105, v106, v107
  ds_read_b64_tr_b16 v[24:25], v4 offset:16384
  ds_read_b64_tr_b16 v[26:27], v4 offset:16640
  s_waitcnt lgkmcnt(8)
  v_mfma_f32_16x16x32_bf16 v[32:35], v[152:155], v[28:31], v[32:35]
  v_mfma_f32_16x16x32_bf16 v[36:39], v[156:159], v[28:31], v[36:39]
  v_cvt_pk_bf16_f32 v106, v108, v109
  v_cvt_pk_bf16_f32 v107, v110, v111
  ds_read_b64_tr_b16 v[28:29], v5 offset:16384
  ds_read_b64_tr_b16 v[30:31], v5 offset:16640
  s_waitcnt lgkmcnt(8)
  v_mfma_f32_16x16x32_bf16 v[40:43], v[152:155], v[12:15], v[40:43]
  v_mfma_f32_16x16x32_bf16 v[44:47], v[156:159], v[12:15], v[44:47]
  s_cmp_lg_u32 s30, 0
  s_cbranch_scc1 Lw1_4
  s_waitcnt vmcnt(6)
  v_readfirstlane_b32 s69, v10
  s_nop 3
  s_cmp_ge_u32 s69, 256
  s_cbranch_scc1 Lpok_5
  s_mov_b32 s65, 0x20000
Lpsp_6:
  s_sleep 16
  buffer_load_dword v10, off, s[72:75], 0 sc1
  s_waitcnt vmcnt(0)
  v_readfirstlane_b32 s69, v10
  s_nop 3
  s_cmp_ge_u32 s69, 256
  s_cbranch_scc1 Lpok_5
  s_sub_u32 s65, s65, 1
  s_cbranch_scc0 Lpsp_6
Lpok_5:
Lw1_4:
  v_cvt_pk_bf16_f32 v112, v112, v113
  v_cvt_pk_bf16_f32 v113, v114, v115
  ds_read_b64_tr_b16 v[12:13], v4 offset:16896
  ds_read_b64_tr_b16 v[14:15], v4 offset:17152
  s_waitcnt lgkmcnt(8)
  v_mfma_f32_16x16x32_bf16 v[48:51], v[152:155], v[16:19], v[48:51]
  v_mfma_f32_16x16x32_bf16 v[52:55], v[156:159], v[16:19], v[52:55]
  v_cvt_pk_bf16_f32 v114, v116, v117
  v_cvt_pk_bf16_f32 v115, v118, v119
  ds_read_b64_tr_b16 v[16:17], v5 offset:16896
  ds_read_b64_tr_b16 v[18:19], v5 offset:17152
  s_waitcnt lgkmcnt(8)
  v_mfma_f32_16x16x32_bf16 v[56:59], v[152:155], v[20:23], v[56:59]
  v_mfma_f32_16x16x32_bf16 v[60:63], v[156:159], v[20:23], v[60:63]
  v_cvt_pk_bf16_f32 v120, v120, v121
  v_cvt_pk_bf16_f32 v121, v122, v123
  s_barrier
  ds_read_b64_tr_b16 v[20:21], v4 offset:20480
  ds_read_b64_tr_b16 v[22:23], v4 offset:20736
  s_waitcnt lgkmcnt(8)
  v_mfma_f32_16x16x32_bf16 v[32:35], v[160:163], v[24:27], v[32:35]
  v_mfma_f32_16x16x32_bf16 v[36:39], v[164:167], v[24:27], v[36:39]
  ds_read_b64_tr_b16 v[24:25], v5 offset:20480
  ds_read_b64_tr_b16 v[26:27], v5 offset:20736
  s_waitcnt lgkmcnt(8)
  v_mfma_f32_16x16x32_bf16 v[40:43], v[160:163], v[28:31], v[40:43]
  v_mfma_f32_16x16x32_bf16 v[44:47], v[164:167], v[28:31], v[44:47]
  ds_read_b64_tr_b16 v[28:29], v4 offset:20992
  ds_read_b64_tr_b16 v[30:31], v4 offset:21248
  s_waitcnt lgkmcnt(8)
  v_mfma_f32_16x16x32_bf16 v[48:51], v[160:163], v[12:15], v[48:51]
  v_mfma_f32_16x16x32_bf16 v[52:55], v[164:167], v[12:15], v[52:55]
  ds_read_b64_tr_b16 v[12:13], v5 offset:20992
  ds_read_b64_tr_b16 v[14:15], v5 offset:21248
  s_waitcnt lgkmcnt(8)
  v_mfma_f32_16x16x32_bf16 v[56:59], v[160:163], v[16:19], v[56:59]
  v_mfma_f32_16x16x32_bf16 v[60:63], v[164:167], v[16:19], v[60:63]
  v_cvt_pk_bf16_f32 v122, v124, v125
  v_cvt_pk_bf16_f32 v123, v126, v127
  ds_read_b64_tr_b16 v[16:17], v4 offset:24576
  ds_read_b64_tr_b16 v[18:19], v4 offset:24832
  s_waitcnt lgkmcnt(8)
  v_mfma_f32_16x16x32_bf16 v[32:35], v[168:171], v[20:23], v[32:35]
  v_mfma_f32_16x16x32_bf16 v[36:39], v[172:175], v[20:23], v[36:39]
  ds_read_b64_tr_b16 v[20:21], v5 offset:24576
  ds_read_b64_tr_b16 v[22:23], v5 offset:24832
  s_waitcnt lgkmcnt(8)
  v_mfma_f32_16x16x32_bf16 v[40:43], v[168:171], v[24:27], v[40:43]
  v_mfma_f32_16x16x32_bf16 v[44:47], v[172:175], v[24:27], v[44:47]
  s_add_u32 s31, s34, 1
  s_and_b32 s31, s31, 7
  s_lshl_b32 s31, s31, 19
  s_add_u32 m0, s40, 81920
  s_add_u32 s31, s31, s35
  buffer_load_dwordx4 v1, s[20:23], s31 offen lds
  ds_read_b64_tr_b16 v[24:25], v4 offset:25088
  ds_read_b64_tr_b16 v[26:27], v4 offset:25344
  s_waitcnt lgkmcnt(8)
  v_mfma_f32_16x16x32_bf16 v[48:51], v[168:171], v[28:31], v[48:51]
  v_mfma_f32_16x16x32_bf16 v[52:55], v[172:175], v[28:31], v[52:55]
  ds_read_b64_tr_b16 v[28:29], v5 offset:25088
  ds_read_b64_tr_b16 v[30:31], v5 offset:25344
  s_waitcnt lgkmcnt(8)
  v_mfma_f32_16x16x32_bf16 v[56:59], v[168:171], v[12:15], v[56:59]
  v_mfma_f32_16x16x32_bf16 v[60:63], v[172:175], v[12:15], v[60:63]
  ds_read_b64_tr_b16 v[12:13], v4 offset:28672
  ds_read_b64_tr_b16 v[14:15], v4 offset:28928
  s_waitcnt lgkmcnt(8)
  v_mfma_f32_16x16x32_bf16 v[32:35], v[176:179], v[16:19], v[32:35]
  v_mfma_f32_16x16x32_bf16 v[36:39], v[180:183], v[16:19], v[36:39]
  ds_read_b64_tr_b16 v[16:17], v5 offset:28672
  ds_read_b64_tr_b16 v[18:19], v5 offset:28928
  s_waitcnt lgkmcnt(8)
  v_mfma_f32_16x16x32_bf16 v[40:43], v[176:179], v[20:23], v[40:43]
  v_mfma_f32_16x16x32_bf16 v[44:47], v[180:183], v[20:23], v[44:47]
  s_add_u32 s31, s34, 1
  s_and_b32 s31, s31, 7
  s_lshl_b32 s31, s31, 19
  s_add_u32 m0, s40, 90112
  s_add_u32 s31, s31, s35
  s_add_u32 s31, s31, 128
  buffer_load_dwordx4 v1, s[20:23], s31 offen lds
  ds_read_b64_tr_b16 v[20:21], v4 offset:29184
  ds_read_b64_tr_b16 v[22:23], v4 offset:29440
  s_waitcnt lgkmcnt(8)
  v_mfma_f32_16x16x32_bf16 v[48:51], v[176:179], v[24:27], v[48:51]
  v_mfma_f32_16x16x32_bf16 v[52:55], v[180:183], v[24:27], v[52:55]
  ds_read_b64_tr_b16 v[24:25], v5 offset:29184
  ds_read_b64_tr_b16 v[26:27], v5 offset:29440
  s_waitcnt lgkmcnt(8)
  v_mfma_f32_16x16x32_bf16 v[56:59], v[176:179], v[28:31], v[56:59]
  v_mfma_f32_16x16x32_bf16 v[60:63], v[180:183], v[28:31], v[60:63]
  s_waitcnt vmcnt(6)
  ds_read_b64_tr_b16 v[28:29], v4 offset:32768
  ds_read_b64_tr_b16 v[30:31], v4 offset:33024
  s_waitcnt lgkmcnt(8)
  v_mfma_f32_16x16x32_bf16 v[32:35], v[184:187], v[12:15], v[32:35]
  v_mfma_f32_16x16x32_bf16 v[36:39], v[188:191], v[12:15], v[36:39]
  ds_read_b64_tr_b16 v[12:13], v5 offset:32768
  ds_read_b64_tr_b16 v[14:15], v5 offset:33024
  s_waitcnt lgkmcnt(8)
  v_mfma_f32_16x16x32_bf16 v[40:43], v[184:187], v[16:19], v[40:43]
  v_mfma_f32_16x16x32_bf16 v[44:47], v[188:191], v[16:19], v[44:47]
  ds_read_b64_tr_b16 v[16:17], v4 offset:33280
  ds_read_b64_tr_b16 v[18:19], v4 offset:33536
  s_waitcnt lgkmcnt(8)
  v_mfma_f32_16x16x32_bf16 v[48:51], v[184:187], v[20:23], v[48:51]
  v_mfma_f32_16x16x32_bf16 v[52:55], v[188:191], v[20:23], v[52:55]
  ds_read_b64_tr_b16 v[20:21], v5 offset:33280
  ds_read_b64_tr_b16 v[22:23], v5 offset:33536
  s_waitcnt lgkmcnt(8)
  v_mfma_f32_16x16x32_bf16 v[56:59], v[184:187], v[24:27], v[56:59]
  v_mfma_f32_16x16x32_bf16 v[60:63], v[188:191], v[24:27], v[60:63]
  s_barrier
  ds_read_b64_tr_b16 v[24:25], v4 offset:36864
  ds_read_b64_tr_b16 v[26:27], v4 offset:37120
  s_waitcnt lgkmcnt(8)
  v_mfma_f32_16x16x32_bf16 v[32:35], v[192:195], v[28:31], v[32:35]
  v_mfma_f32_16x16x32_bf16 v[36:39], v[196:199], v[28:31], v[36:39]
  ds_read_b64_tr_b16 v[28:29], v5 offset:36864
  ds_read_b64_tr_b16 v[30:31], v5 offset:37120
  s_waitcnt lgkmcnt(8)
  v_mfma_f32_16x16x32_bf16 v[40:43], v[192:195], v[12:15], v[40:43]
  v_mfma_f32_16x16x32_bf16 v[44:47], v[196:199], v[12:15], v[44:47]
  ds_read_b64_tr_b16 v[12:13], v4 offset:37376
  ds_read_b64_tr_b16 v[14:15], v4 offset:37632
  s_waitcnt lgkmcnt(8)
  v_mfma_f32_16x16x32_bf16 v[48:51], v[192:195], v[16:19], v[48:51]
  v_mfma_f32_16x16x32_bf16 v[52:55], v[196:199], v[16:19], v[52:55]
  s_add_u32 s67, s34, 0
  s_and_b32 s67, s67, 7
  s_lshl_b32 s67, s67, 11
  s_add_u32 s67, s67, s44
  s_add_u32 s68, s67, 16384
  buffer_load_dwordx4 v[128:131], v2, s[24:27], s67 offen offset:0 sc1
  ds_read_b64_tr_b16 v[16:17], v5 offset:37376
  ds_read_b64_tr_b16 v[18:19], v5 offset:37632
  s_waitcnt lgkmcnt(8)
  v_mfma_f32_16x16x32_bf16 v[56:59], v[192:195], v[20:23], v[56:59]
  v_mfma_f32_16x16x32_bf16 v[60:63], v[196:199], v[20:23], v[60:63]
  ds_read_b64_tr_b16 v[20:21], v4 offset:40960
  ds_read_b64_tr_b16 v[22:23], v4 offset:41216
  s_waitcnt lgkmcnt(8)
  v_mfma_f32_16x16x32_bf16 v[32:35], v[200:203], v[24:27], v[32:35]
  v_mfma_f32_16x16x32_bf16 v[36:39], v[204:207], v[24:27], v[36:39]
  ds_read_b64_tr_b16 v[24:25], v5 offset:40960
  ds_read_b64_tr_b16 v[26:27], v5 offset:41216
  s_waitcnt lgkmcnt(8)
  v_mfma_f32_16x16x32_bf16 v[40:43], v[200:203], v[28:31], v[40:43]
  v_mfma_f32_16x16x32_bf16 v[44:47], v[204:207], v[28:31], v[44:47]
  buffer_load_dwordx4 v[132:135], v2, s[24:27], s68 offen offset:0 sc1
  ds_read_b64_tr_b16 v[28:29], v4 offset:41472
  ds_read_b64_tr_b16 v[30:31], v4 offset:41728
  s_waitcnt lgkmcnt(8)
  v_mfma_f32_16x16x32_bf16 v[48:51], v[200:203], v[12:15], v[48:51]
  v_mfma_f32_16x16x32_bf16 v[52:55], v[204:207], v[12:15], v[52:55]
  ds_read_b64_tr_b16 v[12:13], v5 offset:41472
  ds_read_b64_tr_b16 v[14:15], v5 offset:41728
  s_waitcnt lgkmcnt(8)
  v_mfma_f32_16x16x32_bf16 v[56:59], v[200:203], v[16:19], v[56:59]
  v_mfma_f32_16x16x32_bf16 v[60:63], v[204:207], v[16:19], v[60:63]
  ds_read_b64_tr_b16 v[16:17], v4 offset:45056
  ds_read_b64_tr_b16 v[18:19], v4 offset:45312
  s_waitcnt lgkmcnt(8)
  v_mfma_f32_16x16x32_bf16 v[32:35], v[208:211], v[20:23], v[32:35]
  v_mfma_f32_16x16x32_bf16 v[36:39], v[212:215], v[20:23], v[36:39]
  buffer_load_dwordx4 v[136:139], v2, s[24:27], s67 offen offset:1024 sc1
  ds_read_b64_tr_b16 v[20:21], v5 offset:45056
  ds_read_b64_tr_b16 v[22:23], v5 offset:45312
  s_waitcnt lgkmcnt(8)
  v_mfma_f32_16x16x32_bf16 v[40:43], v[208:211], v[24:27], v[40:43]
  v_mfma_f32_16x16x32_bf16 v[44:47], v[212:215], v[24:27], v[44:47]
  ds_read_b64_tr_b16 v[24:25], v4 offset:45568
  ds_read_b64_tr_b16 v[26:27], v4 offset:45824
  s_waitcnt lgkmcnt(8)
  v_mfma_f32_16x16x32_bf16 v[48:51], v[208:211], v[28:31], v[48:51]
  v_mfma_f32_16x16x32_bf16 v[52:55], v[212:215], v[28:31], v[52:55]
  ds_read_b64_tr_b16 v[28:29], v5 offset:45568
  ds_read_b64_tr_b16 v[30:31], v5 offset:45824
  s_waitcnt lgkmcnt(8)
  v_mfma_f32_16x16x32_bf16 v[56:59], v[208:211], v[12:15], v[56:59]
  v_mfma_f32_16x16x32_bf16 v[60:63], v[212:215], v[12:15], v[60:63]
  ds_read_b64_tr_b16 v[12:13], v4 offset:49152
  ds_read_b64_tr_b16 v[14:15], v4 offset:49408
  s_waitcnt lgkmcnt(8)
  v_mfma_f32_16x16x32_bf16 v[32:35], v[216:219], v[16:19], v[32:35]
  v_mfma_f32_16x16x32_bf16 v[36:39], v[220:223], v[16:19], v[36:39]
  buffer_load_dwordx4 v[140:143], v2, s[24:27], s68 offen offset:1024 sc1
  ds_read_b64_tr_b16 v[16:17], v5 offset:49152
  ds_read_b64_tr_b16 v[18:19], v5 offset:49408
  s_waitcnt lgkmcnt(8)
  v_mfma_f32_16x16x32_bf16 v[40:43], v[216:219], v[20:23], v[40:43]
  v_mfma_f32_16x16x32_bf16 v[44:47], v[220:223], v[20:23], v[44:47]
  ds_read_b64_tr_b16 v[20:21], v4 offset:49664
  ds_read_b64_tr_b16 v[22:23], v4 offset:49920
  s_waitcnt lgkmcnt(8)
  v_mfma_f32_16x16x32_bf16 v[48:51], v[216:219], v[24:27], v[48:51]
  v_mfma_f32_16x16x32_bf16 v[52:55], v[220:223], v[24:27], v[52:55]
  ds_read_b64_tr_b16 v[24:25], v5 offset:49664
  ds_read_b64_tr_b16 v[26:27], v5 offset:49920
  s_waitcnt lgkmcnt(8)
  v_mfma_f32_16x16x32_bf16 v[56:59], v[216:219], v[28:31], v[56:59]
  v_mfma_f32_16x16x32_bf16 v[60:63], v[220:223], v[28:31], v[60:63]
  s_barrier
  ds_read_b64_tr_b16 v[28:29], v4 offset:53248
  ds_read_b64_tr_b16 v[30:31], v4 offset:53504
  s_waitcnt lgkmcnt(8)
  v_mfma_f32_16x16x32_bf16 v[32:35], v[224:227], v[12:15], v[32:35]
  v_mfma_f32_16x16x32_bf16 v[36:39], v[228:231], v[12:15], v[36:39]
  ds_read_b64_tr_b16 v[12:13], v5 offset:53248
  ds_read_b64_tr_b16 v[14:15], v5 offset:53504
  s_waitcnt lgkmcnt(8)
  v_mfma_f32_16x16x32_bf16 v[40:43], v[224:227], v[16:19], v[40:43]
  v_mfma_f32_16x16x32_bf16 v[44:47], v[228:231], v[16:19], v[44:47]
  ds_read_b64_tr_b16 v[16:17], v4 offset:53760
  ds_read_b64_tr_b16 v[18:19], v4 offset:54016
  s_waitcnt lgkmcnt(8)
  v_mfma_f32_16x16x32_bf16 v[48:51], v[224:227], v[20:23], v[48:51]
  v_mfma_f32_16x16x32_bf16 v[52:55], v[228:231], v[20:23], v[52:55]
  s_add_u32 s67, s34, 1
  s_and_b32 s67, s67, 7
  s_lshl_b32 s67, s67, 11
  s_add_u32 s67, s67, s44
  s_add_u32 s68, s67, 16384
  buffer_load_dwordx4 v[144:147], v2, s[24:27], s67 offen offset:0 sc1
  ds_read_b64_tr_b16 v[20:21], v5 offset:53760
  ds_read_b64_tr_b16 v[22:23], v5 offset:54016
  s_waitcnt lgkmcnt(8)
  v_mfma_f32_16x16x32_bf16 v[56:59], v[224:227], v[24:27], v[56:59]
  v_mfma_f32_16x16x32_bf16 v[60:63], v[228:231], v[24:27], v[60:63]
  ds_read_b64_tr_b16 v[24:25], v4 offset:57344
  ds_read_b64_tr_b16 v[26:27], v4 offset:57600
  s_waitcnt lgkmcnt(8)
  v_mfma_f32_16x16x32_bf16 v[32:35], v[232:235], v[28:31], v[32:35]
  v_mfma_f32_16x16x32_bf16 v[36:39], v[236:239], v[28:31], v[36:39]
  ds_read_b64_tr_b16 v[28:29], v5 offset:57344
  ds_read_b64_tr_b16 v[30:31], v5 offset:57600
  s_waitcnt lgkmcnt(8)
  v_mfma_f32_16x16x32_bf16 v[40:43], v[232:235], v[12:15], v[40:43]
  v_mfma_f32_16x16x32_bf16 v[44:47], v[236:239], v[12:15], v[44:47]
  buffer_load_dwordx4 v[148:151], v2, s[24:27], s68 offen offset:0 sc1
  ds_read_b64_tr_b16 v[12:13], v4 offset:57856
  ds_read_b64_tr_b16 v[14:15], v4 offset:58112
  s_waitcnt lgkmcnt(8)
  v_mfma_f32_16x16x32_bf16 v[48:51], v[232:235], v[16:19], v[48:51]
  v_mfma_f32_16x16x32_bf16 v[52:55], v[236:239], v[16:19], v[52:55]
  ds_read_b64_tr_b16 v[16:17], v5 offset:57856
  ds_read_b64_tr_b16 v[18:19], v5 offset:58112
  s_waitcnt lgkmcnt(8)
  v_mfma_f32_16x16x32_bf16 v[56:59], v[232:235], v[20:23], v[56:59]
  v_mfma_f32_16x16x32_bf16 v[60:63], v[236:239], v[20:23], v[60:63]
  ds_read_b64_tr_b16 v[20:21], v4 offset:61440
  ds_read_b64_tr_b16 v[22:23], v4 offset:61696
  s_waitcnt lgkmcnt(8)
  v_mfma_f32_16x16x32_bf16 v[32:35], v[240:243], v[24:27], v[32:35]
  v_mfma_f32_16x16x32_bf16 v[36:39], v[244:247], v[24:27], v[36:39]
  buffer_load_dwordx4 v[152:155], v2, s[24:27], s67 offen offset:1024 sc1
  ds_read_b64_tr_b16 v[24:25], v5 offset:61440
  ds_read_b64_tr_b16 v[26:27], v5 offset:61696
  s_waitcnt lgkmcnt(8)
  v_mfma_f32_16x16x32_bf16 v[40:43], v[240:243], v[28:31], v[40:43]
  v_mfma_f32_16x16x32_bf16 v[44:47], v[244:247], v[28:31], v[44:47]
  ds_read_b64_tr_b16 v[28:29], v4 offset:61952
  ds_read_b64_tr_b16 v[30:31], v4 offset:62208
  s_waitcnt lgkmcnt(8)
  v_mfma_f32_16x16x32_bf16 v[48:51], v[240:243], v[12:15], v[48:51]
  v_mfma_f32_16x16x32_bf16 v[52:55], v[244:247], v[12:15], v[52:55]
  ds_read_b64_tr_b16 v[12:13], v5 offset:61952
  ds_read_b64_tr_b16 v[14:15], v5 offset:62208
  s_waitcnt lgkmcnt(8)
  v_mfma_f32_16x16x32_bf16 v[56:59], v[240:243], v[16:19], v[56:59]
  v_mfma_f32_16x16x32_bf16 v[60:63], v[244:247], v[16:19], v[60:63]
  s_waitcnt lgkmcnt(6)
  v_mfma_f32_16x16x32_bf16 v[32:35], v[248:251], v[20:23], v[32:35]
  v_mfma_f32_16x16x32_bf16 v[36:39], v[252:255], v[20:23], v[36:39]
  buffer_load_dwordx4 v[156:159], v2, s[24:27], s68 offen offset:1024 sc1
  s_waitcnt lgkmcnt(4)
  v_mfma_f32_16x16x32_bf16 v[40:43], v[248:251], v[24:27], v[40:43]
  v_mfma_f32_16x16x32_bf16 v[44:47], v[252:255], v[24:27], v[44:47]
  s_waitcnt lgkmcnt(2)
  v_mfma_f32_16x16x32_bf16 v[48:51], v[248:251], v[28:31], v[48:51]
  v_mfma_f32_16x16x32_bf16 v[52:55], v[252:255], v[28:31], v[52:55]
  s_waitcnt lgkmcnt(0)
  v_mfma_f32_16x16x32_bf16 v[56:59], v[248:251], v[12:15], v[56:59]
  v_mfma_f32_16x16x32_bf16 v[60:63], v[252:255], v[12:15], v[60:63]
  s_nop 7
  v_cvt_pk_bf16_f32 v100, v32, v33
  v_cvt_pk_bf16_f32 v101, v34, v35
  v_cvt_pk_bf16_f32 v102, v36, v37
  v_cvt_pk_bf16_f32 v103, v38, v39
  v_cvt_pk_bf16_f32 v108, v40, v41
  v_cvt_pk_bf16_f32 v109, v42, v43
  v_cvt_pk_bf16_f32 v110, v44, v45
  v_cvt_pk_bf16_f32 v111, v46, v47
  v_cvt_pk_bf16_f32 v116, v48, v49
  v_cvt_pk_bf16_f32 v117, v50, v51
  v_cvt_pk_bf16_f32 v118, v52, v53
  v_cvt_pk_bf16_f32 v119, v54, v55
  v_cvt_pk_bf16_f32 v124, v56, v57
  v_cvt_pk_bf16_f32 v125, v58, v59
  v_cvt_pk_bf16_f32 v126, v60, v61
  v_cvt_pk_bf16_f32 v127, v62, v63
  s_lshl_b32 s55, s28, 2
  s_add_u32 s55, s55, 128
  s_waitcnt vmcnt(4)
  s_barrier
  ds_read_b64_tr_b16 v[12:13], v6 offset:0
  ds_read_b64_tr_b16 v[14:15], v6 offset:256
  ds_read_b64_tr_b16 v[16:17], v7 offset:0
  ds_read_b64_tr_b16 v[18:19], v7 offset:256
  ds_read_b64_tr_b16 v[20:21], v6 offset:512
  ds_read_b64_tr_b16 v[22:23], v6 offset:768
  ds_read_b64_tr_b16 v[24:25], v7 offset:512
  ds_read_b64_tr_b16 v[26:27], v7 offset:768
  ds_read_b64_tr_b16 v[28:29], v6 offset:8192
  ds_read_b64_tr_b16 v[30:31], v6 offset:8448
  s_waitcnt lgkmcnt(8)
  v_mfma_f32_16x16x32_bf16 v[32:35], v[12:15], v[128:131], 0
  v_mfma_f32_16x16x32_bf16 v[40:43], v[12:15], v[132:135], 0
  ds_read_b64_tr_b16 v[12:13], v7 offset:8192
  ds_read_b64_tr_b16 v[14:15], v7 offset:8448
  s_waitcnt lgkmcnt(8)
  v_mfma_f32_16x16x32_bf16 v[36:39], v[16:19], v[128:131], 0
  v_mfma_f32_16x16x32_bf16 v[44:47], v[16:19], v[132:135], 0
  s_add_u32 s31, s34, 2
  s_and_b32 s31, s31, 7
  s_lshl_b32 s31, s31, 19
  s_add_u32 m0, s40, 98304
  s_add_u32 s31, s31, s35
  buffer_load_dwordx4 v1, s[20:23], s31 offen lds
  ds_read_b64_tr_b16 v[16:17], v6 offset:8704
  ds_read_b64_tr_b16 v[18:19], v6 offset:8960
  s_waitcnt lgkmcnt(8)
  v_mfma_f32_16x16x32_bf16 v[48:51], v[20:23], v[128:131], 0
  v_mfma_f32_16x16x32_bf16 v[56:59], v[20:23], v[132:135], 0
  s_add_u32 s31, s34, 2
  s_and_b32 s31, s31, 7
  s_lshl_b32 s31, s31, 19
  s_add_u32 m0, s40, 106496
  s_add_u32 s31, s31, s35
  s_add_u32 s31, s31, 128
  buffer_load_dwordx4 v1, s[20:23], s31 offen lds
  ds_read_b64_tr_b16 v[20:21], v7 offset:8704
  ds_read_b64_tr_b16 v[22:23], v7 offset:8960
  s_waitcnt lgkmcnt(8)
  v_mfma_f32_16x16x32_bf16 v[52:55], v[24:27], v[128:131], 0
  v_mfma_f32_16x16x32_bf16 v[60:63], v[24:27], v[132:135], 0
  s_add_u32 s67, s34, 2
  s_and_b32 s67, s67, 7
  s_lshl_b32 s67, s67, 11
  s_add_u32 s67, s67, s44
  s_add_u32 s68, s67, 16384
  buffer_load_dwordx4 v[160:163], v2, s[24:27], s67 offen offset:0 sc1
  ds_read_b64_tr_b16 v[24:25], v6 offset:4096
  ds_read_b64_tr_b16 v[26:27], v6 offset:4352
  s_waitcnt lgkmcnt(8)
  v_mfma_f32_16x16x32_bf16 v[64:67], v[28:31], v[128:131], 0
  v_mfma_f32_16x16x32_bf16 v[72:75], v[28:31], v[132:135], 0
  buffer_load_dwordx4 v[164:167], v2, s[24:27], s68 offen offset:0 sc1
  ds_read_b64_tr_b16 v[28:29], v7 offset:4096
  ds_read_b64_tr_b16 v[30:31], v7 offset:4352
  s_waitcnt lgkmcnt(8)
  v_mfma_f32_16x16x32_bf16 v[68:71], v[12:15], v[128:131], 0
  v_mfma_f32_16x16x32_bf16 v[76:79], v[12:15], v[132:135], 0
  buffer_load_dwordx4 v[168:171], v2, s[24:27], s67 offen offset:1024 sc1
  ds_read_b64_tr_b16 v[12:13], v6 offset:4608
  ds_read_b64_tr_b16 v[14:15], v6 offset:4864
  s_waitcnt lgkmcnt(8)
  v_mfma_f32_16x16x32_bf16 v[80:83], v[16:19], v[128:131], 0
  v_mfma_f32_16x16x32_bf16 v[88:91], v[16:19], v[132:135], 0
  buffer_load_dwordx4 v[172:175], v2, s[24:27], s68 offen offset:1024 sc1
  ds_read_b64_tr_b16 v[16:17], v7 offset:4608
  ds_read_b64_tr_b16 v[18:19], v7 offset:4864
  s_waitcnt lgkmcnt(8)
  v_mfma_f32_16x16x32_bf16 v[84:87], v[20:23], v[128:131], 0
  v_mfma_f32_16x16x32_bf16 v[92:95], v[20:23], v[132:135], 0
  s_add_u32 s31, s34, 3
  s_and_b32 s31, s31, 7
  s_lshl_b32 s31, s31, 19
  s_add_u32 m0, s40, 114688
  s_add_u32 s31, s31, s35
  buffer_load_dwordx4 v1, s[20:23], s31 offen lds
  ds_read_b64_tr_b16 v[20:21], v6 offset:12288
  ds_read_b64_tr_b16 v[22:23], v6 offset:12544
  s_waitcnt lgkmcnt(8)
  v_mfma_f32_16x16x32_bf16 v[32:35], v[24:27], v[136:139], v[32:35]
  v_mfma_f32_16x16x32_bf16 v[40:43], v[24:27], v[140:143], v[40:43]
  s_add_u32 s31, s34, 3
  s_and_b32 s31, s31, 7
  s_lshl_b32 s31, s31, 19
  s_add_u32 m0, s40, 122880
  s_add_u32 s31, s31, s35
  s_add_u32 s31, s31, 128
  buffer_load_dwordx4 v1, s[20:23], s31 offen lds
  ds_read_b64_tr_b16 v[24:25], v7 offset:12288
  ds_read_b64_tr_b16 v[26:27], v7 offset:12544
  s_waitcnt lgkmcnt(8)
  v_mfma_f32_16x16x32_bf16 v[36:39], v[28:31], v[136:139], v[36:39]
  v_mfma_f32_16x16x32_bf16 v[44:47], v[28:31], v[140:143], v[44:47]
  s_add_u32 s33, s37, 0
  buffer_store_dwordx4 v[96:99], v9, s[24:27], s33 offen offset:0 sc1
  ds_read_b64_tr_b16 v[28:29], v6 offset:12800
  ds_read_b64_tr_b16 v[30:31], v6 offset:13056
  s_waitcnt lgkmcnt(8)
  v_mfma_f32_16x16x32_bf16 v[48:51], v[12:15], v[136:139], v[48:51]
  v_mfma_f32_16x16x32_bf16 v[56:59], v[12:15], v[140:143], v[56:59]
  s_add_u32 s33, s37, 0
  buffer_store_dwordx4 v[104:107], v9, s[24:27], s33 offen offset:256 sc1
  ds_read_b64_tr_b16 v[12:13], v7 offset:12800
  ds_read_b64_tr_b16 v[14:15], v7 offset:13056
  s_waitcnt lgkmcnt(8)
  v_mfma_f32_16x16x32_bf16 v[52:55], v[16:19], v[136:139], v[52:55]
  v_mfma_f32_16x16x32_bf16 v[60:63], v[16:19], v[140:143], v[60:63]
  s_add_u32 s33, s37, 0
  buffer_store_dwordx4 v[112:115], v9, s[24:27], s33 offen offset:1024 sc1
  ds_read_b64_tr_b16 v[16:17], v6 offset:16384
  ds_read_b64_tr_b16 v[18:19], v6 offset:16640
  s_waitcnt lgkmcnt(8)
  v_mfma_f32_16x16x32_bf16 v[64:67], v[20:23], v[136:139], v[64:67]
  v_mfma_f32_16x16x32_bf16 v[72:75], v[20:23], v[140:143], v[72:75]
  s_add_u32 s33, s37, 0
  buffer_store_dwordx4 v[120:123], v9, s[24:27], s33 offen offset:1280 sc1
  ds_read_b64_tr_b16 v[20:21], v7 offset:16384
  ds_read_b64_tr_b16 v[22:23], v7 offset:16640
  s_waitcnt lgkmcnt(8)
  v_mfma_f32_16x16x32_bf16 v[68:71], v[24:27], v[136:139], v[68:71]
  v_mfma_f32_16x16x32_bf16 v[76:79], v[24:27], v[140:143], v[76:79]
  ds_read_b64_tr_b16 v[24:25], v6 offset:16896
  ds_read_b64_tr_b16 v[26:27], v6 offset:17152
  s_waitcnt lgkmcnt(8)
  v_mfma_f32_16x16x32_bf16 v[80:83], v[28:31], v[136:139], v[80:83]
  v_mfma_f32_16x16x32_bf16 v[88:91], v[28:31], v[140:143], v[88:91]
  ds_read_b64_tr_b16 v[28:29], v7 offset:16896
  ds_read_b64_tr_b16 v[30:31], v7 offset:17152
  s_waitcnt lgkmcnt(8)
  v_mfma_f32_16x16x32_bf16 v[84:87], v[12:15], v[136:139], v[84:87]
  v_mfma_f32_16x16x32_bf16 v[92:95], v[12:15], v[140:143], v[92:95]
  s_waitcnt vmcnt(10)
  s_barrier
  ds_read_b64_tr_b16 v[12:13], v6 offset:24576
  ds_read_b64_tr_b16 v[14:15], v6 offset:24832
  s_waitcnt lgkmcnt(8)
  v_mfma_f32_16x16x32_bf16 v[32:35], v[16:19], v[144:147], v[32:35]
  v_mfma_f32_16x16x32_bf16 v[40:43], v[16:19], v[148:151], v[40:43]
  ds_read_b64_tr_b16 v[16:17], v7 offset:24576
  ds_read_b64_tr_b16 v[18:19], v7 offset:24832
  s_waitcnt lgkmcnt(8)
  v_mfma_f32_16x16x32_bf16 v[36:39], v[20:23], v[144:147], v[36:39]
  v_mfma_f32_16x16x32_bf16 v[44:47], v[20:23], v[148:151], v[44:47]
  s_add_u32 s67, s34, 3
  s_and_b32 s67, s67, 7
  s_lshl_b32 s67, s67, 11
  s_add_u32 s67, s67, s44
  s_add_u32 s68, s67, 16384
  buffer_load_dwordx4 v[176:179], v2, s[24:27], s67 offen offset:0 sc1
  ds_read_b64_tr_b16 v[20:21], v6 offset:25088
  ds_read_b64_tr_b16 v[22:23], v6 offset:25344
  s_waitcnt lgkmcnt(8)
  v_mfma_f32_16x16x32_bf16 v[48:51], v[24:27], v[144:147], v[48:51]
  v_mfma_f32_16x16x32_bf16 v[56:59], v[24:27], v[148:151], v[56:59]
  buffer_load_dwordx4 v[180:183], v2, s[24:27], s68 offen offset:0 sc1
  ds_read_b64_tr_b16 v[24:25], v7 offset:25088
  ds_read_b64_tr_b16 v[26:27], v7 offset:25344
  s_waitcnt lgkmcnt(8)
  v_mfma_f32_16x16x32_bf16 v[52:55], v[28:31], v[144:147], v[52:55]
  v_mfma_f32_16x16x32_bf16 v[60:63], v[28:31], v[148:151], v[60:63]
  buffer_load_dwordx4 v[184:187], v2, s[24:27], s67 offen offset:1024 sc1
  ds_read_b64_tr_b16 v[28:29], v6 offset:20480
  ds_read_b64_tr_b16 v[30:31], v6 offset:20736
  s_waitcnt lgkmcnt(8)
  v_mfma_f32_16x16x32_bf16 v[64:67], v[12:15], v[144:147], v[64:67]
  v_mfma_f32_16x16x32_bf16 v[72:75], v[12:15], v[148:151], v[72:75]
  buffer_load_dwordx4 v[188:191], v2, s[24:27], s68 offen offset:1024 sc1
  ds_read_b64_tr_b16 v[12:13], v7 offset:20480
  ds_read_b64_tr_b16 v[14:15], v7 offset:20736
  s_waitcnt lgkmcnt(8)
  v_mfma_f32_16x16x32_bf16 v[68:71], v[16:19], v[144:147], v[68:71]
  v_mfma_f32_16x16x32_bf16 v[76:79], v[16:19], v[148:151], v[76:79]
  s_add_u32 s31, s34, 4
  s_and_b32 s31, s31, 7
  s_lshl_b32 s31, s31, 19
  s_add_u32 m0, s40, 0
  s_add_u32 s31, s31, s35
  buffer_load_dwordx4 v1, s[20:23], s31 offen lds
  ds_read_b64_tr_b16 v[16:17], v6 offset:20992
  ds_read_b64_tr_b16 v[18:19], v6 offset:21248
  s_waitcnt lgkmcnt(8)
  v_mfma_f32_16x16x32_bf16 v[80:83], v[20:23], v[144:147], v[80:83]
  v_mfma_f32_16x16x32_bf16 v[88:91], v[20:23], v[148:151], v[88:91]
  s_add_u32 s31, s34, 4
  s_and_b32 s31, s31, 7
  s_lshl_b32 s31, s31, 19
  s_add_u32 m0, s40, 8192
  s_add_u32 s31, s31, s35
  s_add_u32 s31, s31, 128
  buffer_load_dwordx4 v1, s[20:23], s31 offen lds
  ds_read_b64_tr_b16 v[20:21], v7 offset:20992
  ds_read_b64_tr_b16 v[22:23], v7 offset:21248
  s_waitcnt lgkmcnt(8)
  v_mfma_f32_16x16x32_bf16 v[84:87], v[24:27], v[144:147], v[84:87]
  v_mfma_f32_16x16x32_bf16 v[92:95], v[24:27], v[148:151], v[92:95]
  s_add_u32 s67, s34, 4
  s_and_b32 s67, s67, 7
  s_lshl_b32 s67, s67, 11
  s_add_u32 s67, s67, s44
  s_add_u32 s68, s67, 16384
  buffer_load_dwordx4 v[192:195], v2, s[24:27], s67 offen offset:0 sc1
  ds_read_b64_tr_b16 v[24:25], v6 offset:28672
  ds_read_b64_tr_b16 v[26:27], v6 offset:28928
  s_waitcnt lgkmcnt(8)
  v_mfma_f32_16x16x32_bf16 v[32:35], v[28:31], v[152:155], v[32:35]
  v_mfma_f32_16x16x32_bf16 v[40:43], v[28:31], v[156:159], v[40:43]
  buffer_load_dwordx4 v[196:199], v2, s[24:27], s68 offen offset:0 sc1
  ds_read_b64_tr_b16 v[28:29], v7 offset:28672
  ds_read_b64_tr_b16 v[30:31], v7 offset:28928
  s_waitcnt lgkmcnt(8)
  v_mfma_f32_16x16x32_bf16 v[36:39], v[12:15], v[152:155], v[36:39]
  v_mfma_f32_16x16x32_bf16 v[44:47], v[12:15], v[156:159], v[44:47]
  buffer_load_dwordx4 v[200:203], v2, s[24:27], s67 offen offset:1024 sc1
  ds_read_b64_tr_b16 v[12:13], v6 offset:29184
  ds_read_b64_tr_b16 v[14:15], v6 offset:29440
  s_waitcnt lgkmcnt(8)
  v_mfma_f32_16x16x32_bf16 v[48:51], v[16:19], v[152:155], v[48:51]
  v_mfma_f32_16x16x32_bf16 v[56:59], v[16:19], v[156:159], v[56:59]
  buffer_load_dwordx4 v[204:207], v2, s[24:27], s68 offen offset:1024 sc1
  ds_read_b64_tr_b16 v[16:17], v7 offset:29184
  ds_read_b64_tr_b16 v[18:19], v7 offset:29440
  s_waitcnt lgkmcnt(8)
  v_mfma_f32_16x16x32_bf16 v[52:55], v[20:23], v[152:155], v[52:55]
  v_mfma_f32_16x16x32_bf16 v[60:63], v[20:23], v[156:159], v[60:63]
  s_add_u32 s33, s37, 2048
  buffer_store_dwordx4 v[100:103], v9, s[24:27], s33 offen offset:0 sc1
  ds_read_b64_tr_b16 v[20:21], v6 offset:32768
  ds_read_b64_tr_b16 v[22:23], v6 offset:33024
  s_waitcnt lgkmcnt(8)
  v_mfma_f32_16x16x32_bf16 v[64:67], v[24:27], v[152:155], v[64:67]
  v_mfma_f32_16x16x32_bf16 v[72:75], v[24:27], v[156:159], v[72:75]
  s_add_u32 s33, s37, 2048
  buffer_store_dwordx4 v[108:111], v9, s[24:27], s33 offen offset:256 sc1
  ds_read_b64_tr_b16 v[24:25], v7 offset:32768
  ds_read_b64_tr_b16 v[26:27], v7 offset:33024
  s_waitcnt lgkmcnt(8)
  v_mfma_f32_16x16x32_bf16 v[68:71], v[28:31], v[152:155], v[68:71]
  v_mfma_f32_16x16x32_bf16 v[76:79], v[28:31], v[156:159], v[76:79]
  s_add_u32 s33, s37, 2048
  buffer_store_dwordx4 v[116:119], v9, s[24:27], s33 offen offset:1024 sc1
  ds_read_b64_tr_b16 v[28:29], v6 offset:33280
  ds_read_b64_tr_b16 v[30:31], v6 offset:33536
  s_waitcnt lgkmcnt(8)
  v_mfma_f32_16x16x32_bf16 v[80:83], v[12:15], v[152:155], v[80:83]
  v_mfma_f32_16x16x32_bf16 v[88:91], v[12:15], v[156:159], v[88:91]
  s_add_u32 s33, s37, 2048
  buffer_store_dwordx4 v[124:127], v9, s[24:27], s33 offen offset:1280 sc1
  ds_read_b64_tr_b16 v[12:13], v7 offset:33280
  ds_read_b64_tr_b16 v[14:15], v7 offset:33536
  s_waitcnt lgkmcnt(8)
  v_mfma_f32_16x16x32_bf16 v[84:87], v[16:19], v[152:155], v[84:87]
  v_mfma_f32_16x16x32_bf16 v[92:95], v[16:19], v[156:159], v[92:95]
  s_waitcnt vmcnt(18)
  s_barrier
  ds_read_b64_tr_b16 v[16:17], v6 offset:40960
  ds_read_b64_tr_b16 v[18:19], v6 offset:41216
  s_waitcnt lgkmcnt(8)
  v_mfma_f32_16x16x32_bf16 v[32:35], v[20:23], v[160:163], v[32:35]
  v_mfma_f32_16x16x32_bf16 v[40:43], v[20:23], v[164:167], v[40:43]
  ds_read_b64_tr_b16 v[20:21], v7 offset:40960
  ds_read_b64_tr_b16 v[22:23], v7 offset:41216
  s_waitcnt lgkmcnt(8)
  v_mfma_f32_16x16x32_bf16 v[36:39], v[24:27], v[160:163], v[36:39]
  v_mfma_f32_16x16x32_bf16 v[44:47], v[24:27], v[164:167], v[44:47]
  s_add_u32 s31, s34, 5
  s_and_b32 s31, s31, 7
  s_lshl_b32 s31, s31, 19
  s_add_u32 m0, s40, 16384
  s_add_u32 s31, s31, s35
  buffer_load_dwordx4 v1, s[20:23], s31 offen lds
  ds_read_b64_tr_b16 v[24:25], v6 offset:41472
  ds_read_b64_tr_b16 v[26:27], v6 offset:41728
  s_waitcnt lgkmcnt(8)
  v_mfma_f32_16x16x32_bf16 v[48:51], v[28:31], v[160:163], v[48:51]
  v_mfma_f32_16x16x32_bf16 v[56:59], v[28:31], v[164:167], v[56:59]
  s_add_u32 s31, s34, 5
  s_and_b32 s31, s31, 7
  s_lshl_b32 s31, s31, 19
  s_add_u32 m0, s40, 24576
  s_add_u32 s31, s31, s35
  s_add_u32 s31, s31, 128
  buffer_load_dwordx4 v1, s[20:23], s31 offen lds
  ds_read_b64_tr_b16 v[28:29], v7 offset:41472
  ds_read_b64_tr_b16 v[30:31], v7 offset:41728
  s_waitcnt lgkmcnt(8)
  v_mfma_f32_16x16x32_bf16 v[52:55], v[12:15], v[160:163], v[52:55]
  v_mfma_f32_16x16x32_bf16 v[60:63], v[12:15], v[164:167], v[60:63]
  s_add_u32 s67, s34, 5
  s_and_b32 s67, s67, 7
  s_lshl_b32 s67, s67, 11
  s_add_u32 s67, s67, s44
  s_add_u32 s68, s67, 16384
  buffer_load_dwordx4 v[208:211], v2, s[24:27], s67 offen offset:0 sc1
  ds_read_b64_tr_b16 v[12:13], v6 offset:36864
  ds_read_b64_tr_b16 v[14:15], v6 offset:37120
  s_waitcnt lgkmcnt(8)
  v_mfma_f32_16x16x32_bf16 v[64:67], v[16:19], v[160:163], v[64:67]
  v_mfma_f32_16x16x32_bf16 v[72:75], v[16:19], v[164:167], v[72:75]
  buffer_load_dwordx4 v[212:215], v2, s[24:27], s68 offen offset:0 sc1
  ds_read_b64_tr_b16 v[16:17], v7 offset:36864
  ds_read_b64_tr_b16 v[18:19], v7 offset:37120
  s_waitcnt lgkmcnt(8)
  v_mfma_f32_16x16x32_bf16 v[68:71], v[20:23], v[160:163], v[68:71]
  v_mfma_f32_16x16x32_bf16 v[76:79], v[20:23], v[164:167], v[76:79]
  buffer_load_dwordx4 v[216:219], v2, s[24:27], s67 offen offset:1024 sc1
  ds_read_b64_tr_b16 v[20:21], v6 offset:37376
  ds_read_b64_tr_b16 v[22:23], v6 offset:37632
  s_waitcnt lgkmcnt(8)
  v_mfma_f32_16x16x32_bf16 v[80:83], v[24:27], v[160:163], v[80:83]
  v_mfma_f32_16x16x32_bf16 v[88:91], v[24:27], v[164:167], v[88:91]
  buffer_load_dwordx4 v[220:223], v2, s[24:27], s68 offen offset:1024 sc1
  ds_read_b64_tr_b16 v[24:25], v7 offset:37376
  ds_read_b64_tr_b16 v[26:27], v7 offset:37632
  s_waitcnt lgkmcnt(8)
  v_mfma_f32_16x16x32_bf16 v[84:87], v[28:31], v[160:163], v[84:87]
  v_mfma_f32_16x16x32_bf16 v[92:95], v[28:31], v[164:167], v[92:95]
  ds_read_b64_tr_b16 v[28:29], v6 offset:45056
  ds_read_b64_tr_b16 v[30:31], v6 offset:45312
  s_waitcnt lgkmcnt(8)
  v_mfma_f32_16x16x32_bf16 v[32:35], v[12:15], v[168:171], v[32:35]
  v_mfma_f32_16x16x32_bf16 v[40:43], v[12:15], v[172:175], v[40:43]
  ds_read_b64_tr_b16 v[12:13], v7 offset:45056
  ds_read_b64_tr_b16 v[14:15], v7 offset:45312
  s_waitcnt lgkmcnt(8)
  v_mfma_f32_16x16x32_bf16 v[36:39], v[16:19], v[168:171], v[36:39]
  v_mfma_f32_16x16x32_bf16 v[44:47], v[16:19], v[172:175], v[44:47]
  ds_read_b64_tr_b16 v[16:17], v6 offset:45568
  ds_read_b64_tr_b16 v[18:19], v6 offset:45824
  s_waitcnt lgkmcnt(8)
  v_mfma_f32_16x16x32_bf16 v[48:51], v[20:23], v[168:171], v[48:51]
  v_mfma_f32_16x16x32_bf16 v[56:59], v[20:23], v[172:175], v[56:59]
  ds_read_b64_tr_b16 v[20:21], v7 offset:45568
  ds_read_b64_tr_b16 v[22:23], v7 offset:45824
  s_waitcnt lgkmcnt(8)
  v_mfma_f32_16x16x32_bf16 v[52:55], v[24:27], v[168:171], v[52:55]
  v_mfma_f32_16x16x32_bf16 v[60:63], v[24:27], v[172:175], v[60:63]
  s_waitcnt vmcnt(14)
  ds_read_b64_tr_b16 v[24:25], v6 offset:49152
  ds_read_b64_tr_b16 v[26:27], v6 offset:49408
  s_waitcnt lgkmcnt(8)
  v_mfma_f32_16x16x32_bf16 v[64:67], v[28:31], v[168:171], v[64:67]
  v_mfma_f32_16x16x32_bf16 v[72:75], v[28:31], v[172:175], v[72:75]
  ds_read_b64_tr_b16 v[28:29], v7 offset:49152
  ds_read_b64_tr_b16 v[30:31], v7 offset:49408
  s_waitcnt lgkmcnt(8)
  v_mfma_f32_16x16x32_bf16 v[68:71], v[12:15], v[168:171], v[68:71]
  v_mfma_f32_16x16x32_bf16 v[76:79], v[12:15], v[172:175], v[76:79]
  ds_read_b64_tr_b16 v[12:13], v6 offset:49664
  ds_read_b64_tr_b16 v[14:15], v6 offset:49920
  s_waitcnt lgkmcnt(8)
  v_mfma_f32_16x16x32_bf16 v[80:83], v[16:19], v[168:171], v[80:83]
  v_mfma_f32_16x16x32_bf16 v[88:91], v[16:19], v[172:175], v[88:91]
  ds_read_b64_tr_b16 v[16:17], v7 offset:49664
  ds_read_b64_tr_b16 v[18:19], v7 offset:49920
  s_waitcnt lgkmcnt(8)
  v_mfma_f32_16x16x32_bf16 v[84:87], v[20:23], v[168:171], v[84:87]
  v_mfma_f32_16x16x32_bf16 v[92:95], v[20:23], v[172:175], v[92:95]
  s_barrier
  ds_read_b64_tr_b16 v[20:21], v6 offset:57344
  ds_read_b64_tr_b16 v[22:23], v6 offset:57600
  s_waitcnt lgkmcnt(8)
  v_mfma_f32_16x16x32_bf16 v[32:35], v[24:27], v[176:179], v[32:35]
  v_mfma_f32_16x16x32_bf16 v[40:43], v[24:27], v[180:183], v[40:43]
  ds_read_b64_tr_b16 v[24:25], v7 offset:57344
  ds_read_b64_tr_b16 v[26:27], v7 offset:57600
  s_waitcnt lgkmcnt(8)
  v_mfma_f32_16x16x32_bf16 v[36:39], v[28:31], v[176:179], v[36:39]
  v_mfma_f32_16x16x32_bf16 v[44:47], v[28:31], v[180:183], v[44:47]
  s_add_u32 s31, s34, 6
  s_and_b32 s31, s31, 7
  s_lshl_b32 s31, s31, 19
  s_add_u32 m0, s40, 32768
  s_add_u32 s31, s31, s35
  buffer_load_dwordx4 v1, s[20:23], s31 offen lds
  ds_read_b64_tr_b16 v[28:29], v6 offset:57856
  ds_read_b64_tr_b16 v[30:31], v6 offset:58112
  s_waitcnt lgkmcnt(8)
  v_mfma_f32_16x16x32_bf16 v[48:51], v[12:15], v[176:179], v[48:51]
  v_mfma_f32_16x16x32_bf16 v[56:59], v[12:15], v[180:183], v[56:59]
  s_add_u32 s31, s34, 6
  s_and_b32 s31, s31, 7
  s_lshl_b32 s31, s31, 19
  s_add_u32 m0, s40, 40960
  s_add_u32 s31, s31, s35
  s_add_u32 s31, s31, 128
  buffer_load_dwordx4 v1, s[20:23], s31 offen lds
  ds_read_b64_tr_b16 v[12:13], v7 offset:57856
  ds_read_b64_tr_b16 v[14:15], v7 offset:58112
  s_waitcnt lgkmcnt(8)
  v_mfma_f32_16x16x32_bf16 v[52:55], v[16:19], v[176:179], v[52:55]
  v_mfma_f32_16x16x32_bf16 v[60:63], v[16:19], v[180:183], v[60:63]
  s_add_u32 s67, s34, 6
  s_and_b32 s67, s67, 7
  s_lshl_b32 s67, s67, 11
  s_add_u32 s67, s67, s44
  s_add_u32 s68, s67, 16384
  buffer_load_dwordx4 v[224:227], v2, s[24:27], s67 offen offset:0 sc1
  ds_read_b64_tr_b16 v[16:17], v6 offset:53248
  ds_read_b64_tr_b16 v[18:19], v6 offset:53504
  s_waitcnt lgkmcnt(8)
  v_mfma_f32_16x16x32_bf16 v[64:67], v[20:23], v[176:179], v[64:67]
  v_mfma_f32_16x16x32_bf16 v[72:75], v[20:23], v[180:183], v[72:75]
  buffer_load_dwordx4 v[228:231], v2, s[24:27], s68 offen offset:0 sc1
  ds_read_b64_tr_b16 v[20:21], v7 offset:53248
  ds_read_b64_tr_b16 v[22:23], v7 offset:53504
  s_waitcnt lgkmcnt(8)
  v_mfma_f32_16x16x32_bf16 v[68:71], v[24:27], v[176:179], v[68:71]
  v_mfma_f32_16x16x32_bf16 v[76:79], v[24:27], v[180:183], v[76:79]
  buffer_load_dwordx4 v[232:235], v2, s[24:27], s67 offen offset:1024 sc1
  ds_read_b64_tr_b16 v[24:25], v6 offset:53760
  ds_read_b64_tr_b16 v[26:27], v6 offset:54016
  s_waitcnt lgkmcnt(8)
  v_mfma_f32_16x16x32_bf16 v[80:83], v[28:31], v[176:179], v[80:83]
  v_mfma_f32_16x16x32_bf16 v[88:91], v[28:31], v[180:183], v[88:91]
  buffer_load_dwordx4 v[236:239], v2, s[24:27], s68 offen offset:1024 sc1
  ds_read_b64_tr_b16 v[28:29], v7 offset:53760
  ds_read_b64_tr_b16 v[30:31], v7 offset:54016
  s_waitcnt lgkmcnt(8)
  v_mfma_f32_16x16x32_bf16 v[84:87], v[12:15], v[176:179], v[84:87]
  v_mfma_f32_16x16x32_bf16 v[92:95], v[12:15], v[180:183], v[92:95]
  ds_read_b64_tr_b16 v[12:13], v6 offset:61440
  ds_read_b64_tr_b16 v[14:15], v6 offset:61696
  s_waitcnt lgkmcnt(8)
  v_mfma_f32_16x16x32_bf16 v[32:35], v[16:19], v[184:187], v[32:35]
  v_mfma_f32_16x16x32_bf16 v[40:43], v[16:19], v[188:191], v[40:43]
  ds_read_b64_tr_b16 v[16:17], v7 offset:61440
  ds_read_b64_tr_b16 v[18:19], v7 offset:61696
  s_waitcnt lgkmcnt(8)
  v_mfma_f32_16x16x32_bf16 v[36:39], v[20:23], v[184:187], v[36:39]
  v_mfma_f32_16x16x32_bf16 v[44:47], v[20:23], v[188:191], v[44:47]
  ds_read_b64_tr_b16 v[20:21], v6 offset:61952
  ds_read_b64_tr_b16 v[22:23], v6 offset:62208
  s_waitcnt lgkmcnt(8)
  v_mfma_f32_16x16x32_bf16 v[48:51], v[24:27], v[184:187], v[48:51]
  v_mfma_f32_16x16x32_bf16 v[56:59], v[24:27], v[188:191], v[56:59]
  ds_read_b64_tr_b16 v[24:25], v7 offset:61952
  ds_read_b64_tr_b16 v[26:27], v7 offset:62208
  s_waitcnt lgkmcnt(8)
  v_mfma_f32_16x16x32_bf16 v[52:55], v[28:31], v[184:187], v[52:55]
  v_mfma_f32_16x16x32_bf16 v[60:63], v[28:31], v[188:191], v[60:63]
  s_waitcnt vmcnt(10)
  ds_read_b64_tr_b16 v[28:29], v4 offset:0
  ds_read_b64_tr_b16 v[30:31], v4 offset:256
  s_waitcnt lgkmcnt(8)
  v_mfma_f32_16x16x32_bf16 v[64:67], v[12:15], v[184:187], v[64:67]
  v_mfma_f32_16x16x32_bf16 v[72:75], v[12:15], v[188:191], v[72:75]
  ds_read_b64_tr_b16 v[12:13], v5 offset:0
  ds_read_b64_tr_b16 v[14:15], v5 offset:256
  s_waitcnt lgkmcnt(8)
  v_mfma_f32_16x16x32_bf16 v[68:71], v[16:19], v[184:187], v[68:71]
  v_mfma_f32_16x16x32_bf16 v[76:79], v[16:19], v[188:191], v[76:79]
  ds_read_b64_tr_b16 v[16:17], v4 offset:512
  ds_read_b64_tr_b16 v[18:19], v4 offset:768
  s_waitcnt lgkmcnt(8)
  v_mfma_f32_16x16x32_bf16 v[80:83], v[20:23], v[184:187], v[80:83]
  v_mfma_f32_16x16x32_bf16 v[88:91], v[20:23], v[188:191], v[88:91]
  ds_read_b64_tr_b16 v[20:21], v5 offset:512
  ds_read_b64_tr_b16 v[22:23], v5 offset:768
  s_waitcnt lgkmcnt(8)
  v_mfma_f32_16x16x32_bf16 v[84:87], v[24:27], v[184:187], v[84:87]
  v_mfma_f32_16x16x32_bf16 v[92:95], v[24:27], v[188:191], v[92:95]
  s_barrier
  ds_read_b64_tr_b16 v[24:25], v4 offset:8192
  ds_read_b64_tr_b16 v[26:27], v4 offset:8448
  s_waitcnt lgkmcnt(8)
  v_mfma_f32_16x16x32_bf16 v[32:35], v[28:31], v[192:195], v[32:35]
  v_mfma_f32_16x16x32_bf16 v[40:43], v[28:31], v[196:199], v[40:43]
  ds_read_b64_tr_b16 v[28:29], v5 offset:8192
  ds_read_b64_tr_b16 v[30:31], v5 offset:8448
  s_waitcnt lgkmcnt(8)
  v_mfma_f32_16x16x32_bf16 v[36:39], v[12:15], v[192:195], v[36:39]
  v_mfma_f32_16x16x32_bf16 v[44:47], v[12:15], v[196:199], v[44:47]
  s_add_u32 s31, s34, 7
  s_and_b32 s31, s31, 7
  s_lshl_b32 s31, s31, 19
  s_add_u32 m0, s40, 49152
  s_add_u32 s31, s31, s35
  buffer_load_dwordx4 v1, s[20:23], s31 offen lds
  ds_read_b64_tr_b16 v[12:13], v4 offset:8704
  ds_read_b64_tr_b16 v[14:15], v4 offset:8960
  s_waitcnt lgkmcnt(8)
  v_mfma_f32_16x16x32_bf16 v[48:51], v[16:19], v[192:195], v[48:51]
  v_mfma_f32_16x16x32_bf16 v[56:59], v[16:19], v[196:199], v[56:59]
  s_add_u32 s31, s34, 7
  s_and_b32 s31, s31, 7
  s_lshl_b32 s31, s31, 19
  s_add_u32 m0, s40, 57344
  s_add_u32 s31, s31, s35
  s_add_u32 s31, s31, 128
  buffer_load_dwordx4 v1, s[20:23], s31 offen lds
  ds_read_b64_tr_b16 v[16:17], v5 offset:8704
  ds_read_b64_tr_b16 v[18:19], v5 offset:8960
  s_waitcnt lgkmcnt(8)
  v_mfma_f32_16x16x32_bf16 v[52:55], v[20:23], v[192:195], v[52:55]
  v_mfma_f32_16x16x32_bf16 v[60:63], v[20:23], v[196:199], v[60:63]
  s_add_u32 s67, s34, 7
  s_and_b32 s67, s67, 7
  s_lshl_b32 s67, s67, 11
  s_add_u32 s67, s67, s44
  s_add_u32 s68, s67, 16384
  buffer_load_dwordx4 v[240:243], v2, s[24:27], s67 offen offset:0 sc1
  ds_read_b64_tr_b16 v[20:21], v4 offset:4096
  ds_read_b64_tr_b16 v[22:23], v4 offset:4352
  s_waitcnt lgkmcnt(8)
  v_mfma_f32_16x16x32_bf16 v[64:67], v[24:27], v[192:195], v[64:67]
  v_mfma_f32_16x16x32_bf16 v[72:75], v[24:27], v[196:199], v[72:75]
  buffer_load_dwordx4 v[244:247], v2, s[24:27], s68 offen offset:0 sc1
  ds_read_b64_tr_b16 v[24:25], v5 offset:4096
  ds_read_b64_tr_b16 v[26:27], v5 offset:4352
  s_waitcnt lgkmcnt(8)
  v_mfma_f32_16x16x32_bf16 v[68:71], v[28:31], v[192:195], v[68:71]
  v_mfma_f32_16x16x32_bf16 v[76:79], v[28:31], v[196:199], v[76:79]
  buffer_load_dwordx4 v[248:251], v2, s[24:27], s67 offen offset:1024 sc1
  ds_read_b64_tr_b16 v[28:29], v4 offset:4608
  ds_read_b64_tr_b16 v[30:31], v4 offset:4864
  s_waitcnt lgkmcnt(8)
  v_mfma_f32_16x16x32_bf16 v[80:83], v[12:15], v[192:195], v[80:83]
  v_mfma_f32_16x16x32_bf16 v[88:91], v[12:15], v[196:199], v[88:91]
  buffer_load_dwordx4 v[252:255], v2, s[24:27], s68 offen offset:1024 sc1
  ds_read_b64_tr_b16 v[12:13], v5 offset:4608
  ds_read_b64_tr_b16 v[14:15], v5 offset:4864
  s_waitcnt lgkmcnt(8)
  v_mfma_f32_16x16x32_bf16 v[84:87], v[16:19], v[192:195], v[84:87]
  v_mfma_f32_16x16x32_bf16 v[92:95], v[16:19], v[196:199], v[92:95]
  s_cmp_lg_u32 s30, 0
  s_cbranch_scc1 Lw1_7
  s_lshl_b32 s69, s2, 7
  s_add_u32 s69, s69, 0x5200000
  v_mov_b32 v11, 1
  s_mov_b64 exec, 1
  buffer_store_dword v11, off, s[24:27], s69 sc1
  s_mov_b64 exec, -1
Lw1_7:
  ds_read_b64_tr_b16 v[16:17], v4 offset:12288
  ds_read_b64_tr_b16 v[18:19], v4 offset:12544
  s_waitcnt lgkmcnt(8)
  v_mfma_f32_16x16x32_bf16 v[32:35], v[20:23], v[200:203], v[32:35]
  v_mfma_f32_16x16x32_bf16 v[40:43], v[20:23], v[204:207], v[40:43]
  ds_read_b64_tr_b16 v[20:21], v5 offset:12288
  ds_read_b64_tr_b16 v[22:23], v5 offset:12544
  s_waitcnt lgkmcnt(8)
  v_mfma_f32_16x16x32_bf16 v[36:39], v[24:27], v[200:203], v[36:39]
  v_mfma_f32_16x16x32_bf16 v[44:47], v[24:27], v[204:207], v[44:47]
  ds_read_b64_tr_b16 v[24:25], v4 offset:12800
  ds_read_b64_tr_b16 v[26:27], v4 offset:13056
  s_waitcnt lgkmcnt(8)
  v_mfma_f32_16x16x32_bf16 v[48:51], v[28:31], v[200:203], v[48:51]
  v_mfma_f32_16x16x32_bf16 v[56:59], v[28:31], v[204:207], v[56:59]
  ds_read_b64_tr_b16 v[28:29], v5 offset:12800
  ds_read_b64_tr_b16 v[30:31], v5 offset:13056
  s_waitcnt lgkmcnt(8)
  v_mfma_f32_16x16x32_bf16 v[52:55], v[12:15], v[200:203], v[52:55]
  v_mfma_f32_16x16x32_bf16 v[60:63], v[12:15], v[204:207], v[60:63]
  s_waitcnt vmcnt(10)
  ds_read_b64_tr_b16 v[12:13], v4 offset:16384
  ds_read_b64_tr_b16 v[14:15], v4 offset:16640
  s_waitcnt lgkmcnt(8)
  v_mfma_f32_16x16x32_bf16 v[64:67], v[16:19], v[200:203], v[64:67]
  v_mfma_f32_16x16x32_bf16 v[72:75], v[16:19], v[204:207], v[72:75]
  ds_read_b64_tr_b16 v[16:17], v5 offset:16384
  ds_read_b64_tr_b16 v[18:19], v5 offset:16640
  s_waitcnt lgkmcnt(8)
  v_mfma_f32_16x16x32_bf16 v[68:71], v[20:23], v[200:203], v[68:71]
  v_mfma_f32_16x16x32_bf16 v[76:79], v[20:23], v[204:207], v[76:79]
  ds_read_b64_tr_b16 v[20:21], v4 offset:16896
  ds_read_b64_tr_b16 v[22:23], v4 offset:17152
  s_waitcnt lgkmcnt(8)
  v_mfma_f32_16x16x32_bf16 v[80:83], v[24:27], v[200:203], v[80:83]
  v_mfma_f32_16x16x32_bf16 v[88:91], v[24:27], v[204:207], v[88:91]
  ds_read_b64_tr_b16 v[24:25], v5 offset:16896
  ds_read_b64_tr_b16 v[26:27], v5 offset:17152
  s_waitcnt lgkmcnt(8)
  v_mfma_f32_16x16x32_bf16 v[84:87], v[28:31], v[200:203], v[84:87]
  v_mfma_f32_16x16x32_bf16 v[92:95], v[28:31], v[204:207], v[92:95]
  s_barrier
  ds_read_b64_tr_b16 v[28:29], v4 offset:24576
  ds_read_b64_tr_b16 v[30:31], v4 offset:24832
  s_waitcnt lgkmcnt(8)
  v_mfma_f32_16x16x32_bf16 v[32:35], v[12:15], v[208:211], v[32:35]
  v_mfma_f32_16x16x32_bf16 v[40:43], v[12:15], v[212:215], v[40:43]
  ds_read_b64_tr_b16 v[12:13], v5 offset:24576
  ds_read_b64_tr_b16 v[14:15], v5 offset:24832
  s_waitcnt lgkmcnt(8)
  v_mfma_f32_16x16x32_bf16 v[36:39], v[16:19], v[208:211], v[36:39]
  v_mfma_f32_16x16x32_bf16 v[44:47], v[16:19], v[212:215], v[44:47]
  s_cmp_lg_u32 s30, 4
  s_cbranch_scc1 Lw1_8
  v_and_b32 v11, 7, v0
  v_lshlrev_b32 v11, 12, v11
  s_lshl_b32 s69, s28, 7
  s_add_u32 s69, s69, 0x5200000
  buffer_load_dword v10, v11, s[24:27], s69 offen sc1
Lw1_8:
  ds_read_b64_tr_b16 v[16:17], v4 offset:25088
  ds_read_b64_tr_b16 v[18:19], v4 offset:25344
  s_waitcnt lgkmcnt(8)
  v_mfma_f32_16x16x32_bf16 v[48:51], v[20:23], v[208:211], v[48:51]
  v_mfma_f32_16x16x32_bf16 v[56:59], v[20:23], v[212:215], v[56:59]
  ds_read_b64_tr_b16 v[20:21], v5 offset:25088
  ds_read_b64_tr_b16 v[22:23], v5 offset:25344
  s_waitcnt lgkmcnt(8)
  v_mfma_f32_16x16x32_bf16 v[52:55], v[24:27], v[208:211], v[52:55]
  v_mfma_f32_16x16x32_bf16 v[60:63], v[24:27], v[212:215], v[60:63]
  ds_read_b64_tr_b16 v[24:25], v4 offset:20480
  ds_read_b64_tr_b16 v[26:27], v4 offset:20736
  s_waitcnt lgkmcnt(8)
  v_mfma_f32_16x16x32_bf16 v[64:67], v[28:31], v[208:211], v[64:67]
  v_mfma_f32_16x16x32_bf16 v[72:75], v[28:31], v[212:215], v[72:75]
  ds_read_b64_tr_b16 v[28:29], v5 offset:20480
  ds_read_b64_tr_b16 v[30:31], v5 offset:20736
  s_waitcnt lgkmcnt(8)
  v_mfma_f32_16x16x32_bf16 v[68:71], v[12:15], v[208:211], v[68:71]
  v_mfma_f32_16x16x32_bf16 v[76:79], v[12:15], v[212:215], v[76:79]
  ds_read_b64_tr_b16 v[12:13], v4 offset:20992
  ds_read_b64_tr_b16 v[14:15], v4 offset:21248
  s_waitcnt lgkmcnt(8)
  v_mfma_f32_16x16x32_bf16 v[80:83], v[16:19], v[208:211], v[80:83]
  v_mfma_f32_16x16x32_bf16 v[88:91], v[16:19], v[212:215], v[88:91]
  ds_read_b64_tr_b16 v[16:17], v5 offset:20992
  ds_read_b64_tr_b16 v[18:19], v5 offset:21248
  s_waitcnt lgkmcnt(8)
  v_mfma_f32_16x16x32_bf16 v[84:87], v[20:23], v[208:211], v[84:87]
  v_mfma_f32_16x16x32_bf16 v[92:95], v[20:23], v[212:215], v[92:95]
  ds_read_b64_tr_b16 v[20:21], v4 offset:28672
  ds_read_b64_tr_b16 v[22:23], v4 offset:28928
  s_waitcnt lgkmcnt(8)
  v_mfma_f32_16x16x32_bf16 v[32:35], v[24:27], v[216:219], v[32:35]
  v_mfma_f32_16x16x32_bf16 v[40:43], v[24:27], v[220:223], v[40:43]
  ds_read_b64_tr_b16 v[24:25], v5 offset:28672
  ds_read_b64_tr_b16 v[26:27], v5 offset:28928
  s_waitcnt lgkmcnt(8)
  v_mfma_f32_16x16x32_bf16 v[36:39], v[28:31], v[216:219], v[36:39]
  v_mfma_f32_16x16x32_bf16 v[44:47], v[28:31], v[220:223], v[44:47]
  ds_read_b64_tr_b16 v[28:29], v4 offset:29184
  ds_read_b64_tr_b16 v[30:31], v4 offset:29440
  s_waitcnt lgkmcnt(8)
  v_mfma_f32_16x16x32_bf16 v[48:51], v[12:15], v[216:219], v[48:51]
  v_mfma_f32_16x16x32_bf16 v[56:59], v[12:15], v[220:223], v[56:59]
  ds_read_b64_tr_b16 v[12:13], v5 offset:29184
  ds_read_b64_tr_b16 v[14:15], v5 offset:29440
  s_waitcnt lgkmcnt(8)
  v_mfma_f32_16x16x32_bf16 v[52:55], v[16:19], v[216:219], v[52:55]
  v_mfma_f32_16x16x32_bf16 v[60:63], v[16:19], v[220:223], v[60:63]
  s_waitcnt vmcnt(4)
  ds_read_b64_tr_b16 v[16:17], v4 offset:32768
  ds_read_b64_tr_b16 v[18:19], v4 offset:33024
  s_waitcnt lgkmcnt(8)
  v_mfma_f32_16x16x32_bf16 v[64:67], v[20:23], v[216:219], v[64:67]
  v_mfma_f32_16x16x32_bf16 v[72:75], v[20:23], v[220:223], v[72:75]
  ds_read_b64_tr_b16 v[20:21], v5 offset:32768
  ds_read_b64_tr_b16 v[22:23], v5 offset:33024
  s_waitcnt lgkmcnt(8)
  v_mfma_f32_16x16x32_bf16 v[68:71], v[24:27], v[216:219], v[68:71]
  v_mfma_f32_16x16x32_bf16 v[76:79], v[24:27], v[220:223], v[76:79]
  ds_read_b64_tr_b16 v[24:25], v4 offset:33280
  ds_read_b64_tr_b16 v[26:27], v4 offset:33536
  s_waitcnt lgkmcnt(8)
  v_mfma_f32_16x16x32_bf16 v[80:83], v[28:31], v[216:219], v[80:83]
  v_mfma_f32_16x16x32_bf16 v[88:91], v[28:31], v[220:223], v[88:91]
  ds_read_b64_tr_b16 v[28:29], v5 offset:33280
  ds_read_b64_tr_b16 v[30:31], v5 offset:33536
  s_waitcnt lgkmcnt(8)
  v_mfma_f32_16x16x32_bf16 v[84:87], v[12:15], v[216:219], v[84:87]
  v_mfma_f32_16x16x32_bf16 v[92:95], v[12:15], v[220:223], v[92:95]
  s_cmp_lg_u32 s30, 4
  s_cbranch_scc1 Lw1_9
  s_waitcnt vmcnt(0)
  v_cmp_eq_u32 vcc, 1, v10
  s_nop 3
  s_cmp_eq_u64 vcc, -1
  s_cbranch_scc1 Lfok_10
  s_mov_b32 s65, 0x20000
Lfsp_11:
  s_sleep 8
  buffer_load_dword v10, v11, s[24:27], s69 offen sc1
  s_waitcnt vmcnt(0)
  v_cmp_eq_u32 vcc, 1, v10
  s_nop 3
  s_cmp_eq_u64 vcc, -1
  s_cbranch_scc1 Lfok_10
  s_sub_u32 s65, s65, 1
  s_cbranch_scc0 Lfsp_11
Lfok_10:
Lw1_9:
  s_barrier
  ds_read_b64_tr_b16 v[12:13], v4 offset:40960
  ds_read_b64_tr_b16 v[14:15], v4 offset:41216
  s_waitcnt lgkmcnt(8)
  v_mfma_f32_16x16x32_bf16 v[32:35], v[16:19], v[224:227], v[32:35]
  v_mfma_f32_16x16x32_bf16 v[40:43], v[16:19], v[228:231], v[40:43]
  ds_read_b64_tr_b16 v[16:17], v5 offset:40960
  ds_read_b64_tr_b16 v[18:19], v5 offset:41216
  s_waitcnt lgkmcnt(8)
  v_mfma_f32_16x16x32_bf16 v[36:39], v[20:23], v[224:227], v[36:39]
  v_mfma_f32_16x16x32_bf16 v[44:47], v[20:23], v[228:231], v[44:47]
  s_cmp_eq_u32 s57, 0
  s_cbranch_scc1 LnA_12
  s_add_u32 s51, s64, 0x0
  s_add_u32 s52, s64, 0x1200000
  s_lshl_b32 s58, s53, 12
  s_add_u32 s58, s58, 131072
  s_add_u32 m0, s58, 0
  s_nop 0
  buffer_load_dwordx4 v2, s[24:27], s51 offen offset:0 sc1 lds
  buffer_load_dwordx4 v2, s[24:27], s51 offen offset:1024 sc1 lds
  buffer_load_dwordx4 v2, s[24:27], s51 offen offset:2048 sc1 lds
  buffer_load_dwordx4 v2, s[24:27], s51 offen offset:3072 sc1 lds
LnA_12:
  ds_read_b64_tr_b16 v[20:21], v4 offset:41472
  ds_read_b64_tr_b16 v[22:23], v4 offset:41728
  s_waitcnt lgkmcnt(8)
  v_mfma_f32_16x16x32_bf16 v[48:51], v[24:27], v[224:227], v[48:51]
  v_mfma_f32_16x16x32_bf16 v[56:59], v[24:27], v[228:231], v[56:59]
  ds_read_b64_tr_b16 v[24:25], v5 offset:41472
  ds_read_b64_tr_b16 v[26:27], v5 offset:41728
  s_waitcnt lgkmcnt(8)
  v_mfma_f32_16x16x32_bf16 v[52:55], v[28:31], v[224:227], v[52:55]
  v_mfma_f32_16x16x32_bf16 v[60:63], v[28:31], v[228:231], v[60:63]
  s_cmp_eq_u32 s57, 0
  s_cbranch_scc1 LnA_13
  s_add_u32 s51, s64, 0x4000
  s_add_u32 s52, s64, 0x1200000
  s_lshl_b32 s58, s53, 12
  s_add_u32 s58, s58, 65536
  s_add_u32 m0, s58, 0
  s_nop 0
  buffer_load_dwordx4 v2, s[24:27], s51 offen offset:0 sc1 lds
  buffer_load_dwordx4 v2, s[24:27], s51 offen offset:1024 sc1 lds
  buffer_load_dwordx4 v2, s[24:27], s51 offen offset:2048 sc1 lds
  buffer_load_dwordx4 v2, s[24:27], s51 offen offset:3072 sc1 lds
LnA_13:
  ds_read_b64_tr_b16 v[28:29], v4 offset:36864
  ds_read_b64_tr_b16 v[30:31], v4 offset:37120
  s_waitcnt lgkmcnt(8)
  v_mfma_f32_16x16x32_bf16 v[64:67], v[12:15], v[224:227], v[64:67]
  v_mfma_f32_16x16x32_bf16 v[72:75], v[12:15], v[228:231], v[72:75]
  ds_read_b64_tr_b16 v[12:13], v5 offset:36864
  ds_read_b64_tr_b16 v[14:15], v5 offset:37120
  s_waitcnt lgkmcnt(8)
  v_mfma_f32_16x16x32_bf16 v[68:71], v[16:19], v[224:227], v[68:71]
  v_mfma_f32_16x16x32_bf16 v[76:79], v[16:19], v[228:231], v[76:79]
  s_cmp_eq_u32 s57, 0
  s_cbranch_scc1 LnA_14
  s_add_u32 s51, s64, 0x4000
  s_add_u32 s52, s64, 0x1200000
  s_lshl_b32 s58, s53, 12
  s_add_u32 s58, s58, 65536
  s_add_u32 m0, s58, 16384
  s_nop 0
  buffer_load_dwordx4 v2, s[24:27], s52 offen offset:0 sc1 lds
  buffer_load_dwordx4 v2, s[24:27], s52 offen offset:1024 sc1 lds
  buffer_load_dwordx4 v2, s[24:27], s52 offen offset:2048 sc1 lds
  buffer_load_dwordx4 v2, s[24:27], s52 offen offset:3072 sc1 lds
LnA_14:
  ds_read_b64_tr_b16 v[16:17], v4 offset:37376
  ds_read_b64_tr_b16 v[18:19], v4 offset:37632
  s_waitcnt lgkmcnt(8)
  v_mfma_f32_16x16x32_bf16 v[80:83], v[20:23], v[224:227], v[80:83]
  v_mfma_f32_16x16x32_bf16 v[88:91], v[20:23], v[228:231], v[88:91]
  ds_read_b64_tr_b16 v[20:21], v5 offset:37376
  ds_read_b64_tr_b16 v[22:23], v5 offset:37632
  s_waitcnt lgkmcnt(8)
  v_mfma_f32_16x16x32_bf16 v[84:87], v[24:27], v[224:227], v[84:87]
  v_mfma_f32_16x16x32_bf16 v[92:95], v[24:27], v[228:231], v[92:95]
  s_cmp_eq_u32 s57, 0
  s_cbranch_scc1 LnA_15
  s_add_u32 s51, s64, 0x8000
  s_add_u32 s52, s64, 0x1204000
  s_lshl_b32 s58, s53, 12
  s_add_u32 s58, s58, 98304
  s_add_u32 m0, s58, 0
  s_nop 0
  buffer_load_dwordx4 v2, s[24:27], s51 offen offset:0 sc1 lds
  buffer_load_dwordx4 v2, s[24:27], s51 offen offset:1024 sc1 lds
  buffer_load_dwordx4 v2, s[24:27], s51 offen offset:2048 sc1 lds
  buffer_load_dwordx4 v2, s[24:27], s51 offen offset:3072 sc1 lds
LnA_15:
  ds_read_b64_tr_b16 v[24:25], v4 offset:45056
  ds_read_b64_tr_b16 v[26:27], v4 offset:45312
  s_waitcnt lgkmcnt(8)
  v_mfma_f32_16x16x32_bf16 v[32:35], v[28:31], v[232:235], v[32:35]
  v_mfma_f32_16x16x32_bf16 v[40:43], v[28:31], v[236:239], v[40:43]
  ds_read_b64_tr_b16 v[28:29], v5 offset:45056
  ds_read_b64_tr_b16 v[30:31], v5 offset:45312
  s_waitcnt lgkmcnt(8)
  v_mfma_f32_16x16x32_bf16 v[36:39], v[12:15], v[232:235], v[36:39]
  v_mfma_f32_16x16x32_bf16 v[44:47], v[12:15], v[236:239], v[44:47]
  s_cmp_eq_u32 s57, 0
  s_cbranch_scc1 LnA_16
  s_add_u32 s51, s64, 0x8000
  s_add_u32 s52, s64, 0x1204000
  s_lshl_b32 s58, s53, 12
  s_add_u32 s58, s58, 98304
  s_add_u32 m0, s58, 16384
  s_nop 0
  buffer_load_dwordx4 v2, s[24:27], s52 offen offset:0 sc1 lds
  buffer_load_dwordx4 v2, s[24:27], s52 offen offset:1024 sc1 lds
  buffer_load_dwordx4 v2, s[24:27], s52 offen offset:2048 sc1 lds
  buffer_load_dwordx4 v2, s[24:27], s52 offen offset:3072 sc1 lds
LnA_16:
  ds_read_b64_tr_b16 v[12:13], v4 offset:45568
  ds_read_b64_tr_b16 v[14:15], v4 offset:45824
  s_waitcnt lgkmcnt(8)
  v_mfma_f32_16x16x32_bf16 v[48:51], v[16:19], v[232:235], v[48:51]
  v_mfma_f32_16x16x32_bf16 v[56:59], v[16:19], v[236:239], v[56:59]
  ds_read_b64_tr_b16 v[16:17], v5 offset:45568
  ds_read_b64_tr_b16 v[18:19], v5 offset:45824
  s_waitcnt lgkmcnt(8)
  v_mfma_f32_16x16x32_bf16 v[52:55], v[20:23], v[232:235], v[52:55]
  v_mfma_f32_16x16x32_bf16 v[60:63], v[20:23], v[236:239], v[60:63]
  s_cmp_eq_u32 s57, 0
  s_cbranch_scc1 Lw_17
  s_waitcnt vmcnt(20)
  s_branch Lw_18
Lw_17:
  s_waitcnt vmcnt(0)
Lw_18:
  ds_read_b64_tr_b16 v[20:21], v4 offset:49152
  ds_read_b64_tr_b16 v[22:23], v4 offset:49408
  s_waitcnt lgkmcnt(8)
  v_mfma_f32_16x16x32_bf16 v[64:67], v[24:27], v[232:235], v[64:67]
  v_mfma_f32_16x16x32_bf16 v[72:75], v[24:27], v[236:239], v[72:75]
  ds_read_b64_tr_b16 v[24:25], v5 offset:49152
  ds_read_b64_tr_b16 v[26:27], v5 offset:49408
  s_waitcnt lgkmcnt(8)
  v_mfma_f32_16x16x32_bf16 v[68:71], v[28:31], v[232:235], v[68:71]
  v_mfma_f32_16x16x32_bf16 v[76:79], v[28:31], v[236:239], v[76:79]
  ds_read_b64_tr_b16 v[28:29], v4 offset:49664
  ds_read_b64_tr_b16 v[30:31], v4 offset:49920
  s_waitcnt lgkmcnt(8)
  v_mfma_f32_16x16x32_bf16 v[80:83], v[12:15], v[232:235], v[80:83]
  v_mfma_f32_16x16x32_bf16 v[88:91], v[12:15], v[236:239], v[88:91]
  ds_read_b64_tr_b16 v[12:13], v5 offset:49664
  ds_read_b64_tr_b16 v[14:15], v5 offset:49920
  s_waitcnt lgkmcnt(8)
  v_mfma_f32_16x16x32_bf16 v[84:87], v[16:19], v[232:235], v[84:87]
  v_mfma_f32_16x16x32_bf16 v[92:95], v[16:19], v[236:239], v[92:95]
  s_barrier
  ds_read_b64_tr_b16 v[16:17], v4 offset:57344
  ds_read_b64_tr_b16 v[18:19], v4 offset:57600
  s_waitcnt lgkmcnt(8)
  v_mfma_f32_16x16x32_bf16 v[32:35], v[20:23], v[240:243], v[32:35]
  v_mfma_f32_16x16x32_bf16 v[40:43], v[20:23], v[244:247], v[40:43]
  ds_read_b64_tr_b16 v[20:21], v5 offset:57344
  ds_read_b64_tr_b16 v[22:23], v5 offset:57600
  s_waitcnt lgkmcnt(8)
  v_mfma_f32_16x16x32_bf16 v[36:39], v[24:27], v[240:243], v[36:39]
  v_mfma_f32_16x16x32_bf16 v[44:47], v[24:27], v[244:247], v[44:47]
  s_cmp_eq_u32 s57, 0
  s_cbranch_scc1 LnA_19
  s_add_u32 s51, s64, 0xc000
  s_add_u32 s52, s64, 0x1208000
  s_lshl_b32 s58, s53, 12
  s_add_u32 s58, s58, 0
  s_add_u32 m0, s58, 0
  s_nop 0
  buffer_load_dwordx4 v2, s[24:27], s51 offen offset:0 sc1 lds
  buffer_load_dwordx4 v2, s[24:27], s51 offen offset:1024 sc1 lds
  buffer_load_dwordx4 v2, s[24:27], s51 offen offset:2048 sc1 lds
  buffer_load_dwordx4 v2, s[24:27], s51 offen offset:3072 sc1 lds
LnA_19:
  ds_read_b64_tr_b16 v[24:25], v4 offset:57856
  ds_read_b64_tr_b16 v[26:27], v4 offset:58112
  s_waitcnt lgkmcnt(8)
  v_mfma_f32_16x16x32_bf16 v[48:51], v[28:31], v[240:243], v[48:51]
  v_mfma_f32_16x16x32_bf16 v[56:59], v[28:31], v[244:247], v[56:59]
  s_cmp_eq_u32 s57, 0
  s_cbranch_scc1 LnA_20
  s_add_u32 s51, s64, 0xc000
  s_add_u32 s52, s64, 0x1208000
  s_lshl_b32 s58, s53, 12
  s_add_u32 s58, s58, 0
  s_add_u32 m0, s58, 16384
  s_nop 0
  buffer_load_dwordx4 v2, s[24:27], s52 offen offset:0 sc1 lds
  buffer_load_dwordx4 v2, s[24:27], s52 offen offset:1024 sc1 lds
  buffer_load_dwordx4 v2, s[24:27], s52 offen offset:2048 sc1 lds
  buffer_load_dwordx4 v2, s[24:27], s52 offen offset:3072 sc1 lds
LnA_20:
  ds_read_b64_tr_b16 v[28:29], v5 offset:57856
  ds_read_b64_tr_b16 v[30:31], v5 offset:58112
  s_waitcnt lgkmcnt(8)
  v_mfma_f32_16x16x32_bf16 v[52:55], v[12:15], v[240:243], v[52:55]
  v_mfma_f32_16x16x32_bf16 v[60:63], v[12:15], v[244:247], v[60:63]
  ds_read_b64_tr_b16 v[12:13], v4 offset:53248
  ds_read_b64_tr_b16 v[14:15], v4 offset:53504
  s_waitcnt lgkmcnt(8)
  v_mfma_f32_16x16x32_bf16 v[64:67], v[16:19], v[240:243], v[64:67]
  v_mfma_f32_16x16x32_bf16 v[72:75], v[16:19], v[244:247], v[72:75]
  ds_read_b64_tr_b16 v[16:17], v5 offset:53248
  ds_read_b64_tr_b16 v[18:19], v5 offset:53504
  s_waitcnt lgkmcnt(8)
  v_mfma_f32_16x16x32_bf16 v[68:71], v[20:23], v[240:243], v[68:71]
  v_mfma_f32_16x16x32_bf16 v[76:79], v[20:23], v[244:247], v[76:79]
  ds_read_b64_tr_b16 v[20:21], v4 offset:53760
  ds_read_b64_tr_b16 v[22:23], v4 offset:54016
  s_waitcnt lgkmcnt(8)
  v_mfma_f32_16x16x32_bf16 v[80:83], v[24:27], v[240:243], v[80:83]
  v_mfma_f32_16x16x32_bf16 v[88:91], v[24:27], v[244:247], v[88:91]
  ds_read_b64_tr_b16 v[24:25], v5 offset:53760
  ds_read_b64_tr_b16 v[26:27], v5 offset:54016
  s_waitcnt lgkmcnt(8)
  v_mfma_f32_16x16x32_bf16 v[84:87], v[28:31], v[240:243], v[84:87]
  v_mfma_f32_16x16x32_bf16 v[92:95], v[28:31], v[244:247], v[92:95]
  ds_read_b64_tr_b16 v[28:29], v4 offset:61440
  ds_read_b64_tr_b16 v[30:31], v4 offset:61696
  s_waitcnt lgkmcnt(8)
  v_mfma_f32_16x16x32_bf16 v[32:35], v[12:15], v[248:251], v[32:35]
  v_mfma_f32_16x16x32_bf16 v[40:43], v[12:15], v[252:255], v[40:43]
  ds_read_b64_tr_b16 v[12:13], v5 offset:61440
  ds_read_b64_tr_b16 v[14:15], v5 offset:61696
  s_waitcnt lgkmcnt(8)
  v_mfma_f32_16x16x32_bf16 v[36:39], v[16:19], v[248:251], v[36:39]
  v_mfma_f32_16x16x32_bf16 v[44:47], v[16:19], v[252:255], v[44:47]
  ds_read_b64_tr_b16 v[16:17], v4 offset:61952
  ds_read_b64_tr_b16 v[18:19], v4 offset:62208
  s_waitcnt lgkmcnt(8)
  v_mfma_f32_16x16x32_bf16 v[48:51], v[20:23], v[248:251], v[48:51]
  v_mfma_f32_16x16x32_bf16 v[56:59], v[20:23], v[252:255], v[56:59]
  ds_read_b64_tr_b16 v[20:21], v5 offset:61952
  ds_read_b64_tr_b16 v[22:23], v5 offset:62208
  s_waitcnt lgkmcnt(8)
  v_mfma_f32_16x16x32_bf16 v[52:55], v[24:27], v[248:251], v[52:55]
  v_mfma_f32_16x16x32_bf16 v[60:63], v[24:27], v[252:255], v[60:63]
  s_waitcnt lgkmcnt(6)
  v_mfma_f32_16x16x32_bf16 v[64:67], v[28:31], v[248:251], v[64:67]
  v_mfma_f32_16x16x32_bf16 v[72:75], v[28:31], v[252:255], v[72:75]
  s_waitcnt lgkmcnt(4)
  v_mfma_f32_16x16x32_bf16 v[68:71], v[12:15], v[248:251], v[68:71]
  v_mfma_f32_16x16x32_bf16 v[76:79], v[12:15], v[252:255], v[76:79]
  s_waitcnt lgkmcnt(2)
  v_mfma_f32_16x16x32_bf16 v[80:83], v[16:19], v[248:251], v[80:83]
  v_mfma_f32_16x16x32_bf16 v[88:91], v[16:19], v[252:255], v[88:91]
  s_waitcnt lgkmcnt(0)
  v_mfma_f32_16x16x32_bf16 v[84:87], v[20:23], v[248:251], v[84:87]
  v_mfma_f32_16x16x32_bf16 v[92:95], v[20:23], v[252:255], v[92:95]
  s_nop 7
  v_cvt_pk_bf16_f32 v96, v32, v33
  v_cvt_pk_bf16_f32 v97, v34, v35
  v_cvt_pk_bf16_f32 v98, v36, v37
  v_cvt_pk_bf16_f32 v99, v38, v39
  v_cvt_pk_bf16_f32 v100, v40, v41
  v_cvt_pk_bf16_f32 v101, v42, v43
  v_cvt_pk_bf16_f32 v102, v44, v45
  v_cvt_pk_bf16_f32 v103, v46, v47
  v_cvt_pk_bf16_f32 v104, v48, v49
  v_cvt_pk_bf16_f32 v105, v50, v51
  v_cvt_pk_bf16_f32 v106, v52, v53
  v_cvt_pk_bf16_f32 v107, v54, v55
  v_cvt_pk_bf16_f32 v108, v56, v57
  v_cvt_pk_bf16_f32 v109, v58, v59
  v_cvt_pk_bf16_f32 v110, v60, v61
  v_cvt_pk_bf16_f32 v111, v62, v63
  v_cvt_pk_bf16_f32 v112, v64, v65
  v_cvt_pk_bf16_f32 v113, v66, v67
  v_cvt_pk_bf16_f32 v114, v68, v69
  v_cvt_pk_bf16_f32 v115, v70, v71
  v_cvt_pk_bf16_f32 v116, v72, v73
  v_cvt_pk_bf16_f32 v117, v74, v75
  v_cvt_pk_bf16_f32 v118, v76, v77
  v_cvt_pk_bf16_f32 v119, v78, v79
  v_cvt_pk_bf16_f32 v120, v80, v81
  v_cvt_pk_bf16_f32 v121, v82, v83
  v_cvt_pk_bf16_f32 v122, v84, v85
  v_cvt_pk_bf16_f32 v123, v86, v87
  v_cvt_pk_bf16_f32 v124, v88, v89
  v_cvt_pk_bf16_f32 v125, v90, v91
  v_cvt_pk_bf16_f32 v126, v92, v93
  v_cvt_pk_bf16_f32 v127, v94, v95
  s_nop 1
  v_permlane16_swap_b32 v96, v100
  v_permlane16_swap_b32 v97, v101
  v_permlane16_swap_b32 v98, v102
  v_permlane16_swap_b32 v99, v103
  v_permlane16_swap_b32 v104, v108
  v_permlane16_swap_b32 v105, v109
  v_permlane16_swap_b32 v106, v110
  v_permlane16_swap_b32 v107, v111
  v_permlane16_swap_b32 v112, v116
  v_permlane16_swap_b32 v113, v117
  v_permlane16_swap_b32 v114, v118
  v_permlane16_swap_b32 v115, v119
  v_permlane16_swap_b32 v120, v124
  v_permlane16_swap_b32 v121, v125
  v_permlane16_swap_b32 v122, v126
  v_permlane16_swap_b32 v123, v127
  s_waitcnt vmcnt(16)
  s_barrier
  v_mov_b32 v86, 0
  v_mov_b32 v88, 0xff800000
  s_mov_b32 s48, 65536
  v_add_u32 v8, 65536, v2
  s_mov_b32 s50, 3
  s_mov_b32 s59, 32768
  v_add_u32 v9, 131072, v2
  s_cmp_lg_u32 s57, 0
  s_cbranch_scc1 sequential_preLN__compressed_kv_cla__dense_activation_squared_relu__prompt_kernel_roleA
  ds_read_b128 v[12:15], v9 offset:0
  ds_read_b128 v[16:19], v9 offset:1024
  ds_read_b128 v[20:23], v9 offset:2048
  ds_read_b128 v[24:27], v9 offset:3072
  ds_read_b128 v[28:31], v9 offset:4096
  ds_read_b128 v[32:35], v9 offset:5120
  ds_read_b128 v[36:39], v9 offset:6144
  ds_read_b128 v[40:43], v9 offset:7168
  ds_read_b128 v[44:47], v9 offset:8192
  ds_read_b128 v[48:51], v9 offset:9216
  ds_read_b128 v[52:55], v9 offset:10240
  ds_read_b128 v[56:59], v9 offset:11264
  s_waitcnt lgkmcnt(8)
  v_mfma_f32_32x32x16_bf16 v[160:175], v[12:15], v[96:99], 0
  ds_read_b128 v[60:63], v9 offset:12288
  v_mov_b32 v192, 0
  v_mov_b32 v193, 0
  v_mov_b32 v194, 0
  v_mov_b32 v195, 0
  v_mov_b32 v196, 0
  v_mfma_f32_32x32x16_bf16 v[160:175], v[16:19], v[100:103], v[160:175]
  ds_read_b128 v[64:67], v9 offset:13312
  v_mov_b32 v197, 0
  v_mov_b32 v198, 0
  v_mov_b32 v199, 0
  v_mov_b32 v200, 0
  v_mov_b32 v201, 0
  v_mfma_f32_32x32x16_bf16 v[160:175], v[20:23], v[104:107], v[160:175]
  ds_read_b128 v[68:71], v9 offset:14336
  v_mov_b32 v202, 0
  v_mov_b32 v203, 0
  v_mov_b32 v204, 0
  v_mov_b32 v205, 0
  v_mov_b32 v206, 0
  v_mfma_f32_32x32x16_bf16 v[160:175], v[24:27], v[108:111], v[160:175]
  ds_read_b128 v[72:75], v9 offset:15360
  v_mov_b32 v207, 0
  v_mov_b32 v208, 0
  v_mov_b32 v209, 0
  v_mov_b32 v210, 0
  v_mov_b32 v211, 0
  s_waitcnt lgkmcnt(8)
  v_mfma_f32_32x32x16_bf16 v[160:175], v[28:31], v[112:115], v[160:175]
  v_mov_b32 v212, 0
  v_mov_b32 v213, 0
  v_mov_b32 v214, 0
  v_mov_b32 v215, 0
  v_mov_b32 v216, 0
  v_mfma_f32_32x32x16_bf16 v[160:175], v[32:35], v[116:119], v[160:175]
  v_mov_b32 v217, 0
  v_mov_b32 v218, 0
  v_mov_b32 v219, 0
  v_mov_b32 v220, 0
  v_mov_b32 v221, 0
  v_mfma_f32_32x32x16_bf16 v[160:175], v[36:39], v[120:123], v[160:175]
  v_mov_b32 v222, 0
  v_mov_b32 v223, 0
  v_mov_b32 v224, 0
  v_mov_b32 v225, 0
  v_mov_b32 v226, 0
  v_mfma_f32_32x32x16_bf16 v[160:175], v[40:43], v[124:127], v[160:175]
  v_mov_b32 v227, 0
  v_mov_b32 v228, 0
  v_mov_b32 v229, 0
  v_mov_b32 v230, 0
  v_mov_b32 v231, 0
  v_mov_b32 v232, 0
  v_mov_b32 v233, 0
  v_mov_b32 v234, 0
  v_mov_b32 v235, 0
  v_mov_b32 v236, 0
  v_mov_b32 v237, 0
  v_mov_b32 v238, 0
  v_mov_b32 v239, 0
  v_mov_b32 v240, 0
  v_mov_b32 v241, 0
  v_mov_b32 v242, 0
  v_mov_b32 v243, 0
  v_mov_b32 v244, 0
  v_mov_b32 v245, 0
  v_mov_b32 v246, 0
  v_mov_b32 v247, 0
  v_mov_b32 v248, 0
  v_mov_b32 v249, 0
  v_mov_b32 v250, 0
  v_mov_b32 v251, 0
  v_mov_b32 v252, 0
  v_mov_b32 v253, 0
  v_mov_b32 v254, 0
  v_mov_b32 v255, 0
  s_cmp_lg_u32 s45, 1
  s_cbranch_scc1 Lpm_21
  s_mov_b32 s47, -1
  s_add_u32 s56, s47, 1
  s_lshl_b32 s56, s56, 6
  s_add_u32 s56, s56, 0
  v_subrev_u32 v87, s56, v3
  v_cmp_le_i32 s[8:9], 0, v87
  v_cmp_le_i32 s[10:11], 1, v87
  v_cmp_le_i32 s[12:13], 2, v87
  v_cmp_le_i32 s[14:15], 3, v87
  s_nop 1
  v_cndmask_b32 v160, v88, v160, s[8:9]
  v_cndmask_b32 v161, v88, v161, s[10:11]
  v_cndmask_b32 v162, v88, v162, s[12:13]
  v_cndmask_b32 v163, v88, v163, s[14:15]
  v_cmp_le_i32 s[8:9], 16, v87
  v_cmp_le_i32 s[10:11], 17, v87
  v_cmp_le_i32 s[12:13], 18, v87
  v_cmp_le_i32 s[14:15], 19, v87
  s_nop 1
  v_cndmask_b32 v164, v88, v164, s[8:9]
  v_cndmask_b32 v165, v88, v165, s[10:11]
  v_cndmask_b32 v166, v88, v166, s[12:13]
  v_cndmask_b32 v167, v88, v167, s[14:15]
  v_cmp_le_i32 s[8:9], 8, v87
  v_cmp_le_i32 s[10:11], 9, v87
  v_cmp_le_i32 s[12:13], 10, v87
  v_cmp_le_i32 s[14:15], 11, v87
  s_nop 1
  v_cndmask_b32 v168, v88, v168, s[8:9]
  v_cndmask_b32 v169, v88, v169, s[10:11]
  v_cndmask_b32 v170, v88, v170, s[12:13]
  v_cndmask_b32 v171, v88, v171, s[14:15]
  v_cmp_le_i32 s[8:9], 24, v87
  v_cmp_le_i32 s[10:11], 25, v87
  v_cmp_le_i32 s[12:13], 26, v87
  v_cmp_le_i32 s[14:15], 27, v87
  s_nop 1
  v_cndmask_b32 v172, v88, v172, s[8:9]
  v_cndmask_b32 v173, v88, v173, s[10:11]
  v_cndmask_b32 v174, v88, v174, s[12:13]
  v_cndmask_b32 v175, v88, v175, s[14:15]
Lpm_21:
  v_max3_f32 v89, v160, v161, v162
  v_max3_f32 v89, v89, v163, v164
  v_max3_f32 v89, v89, v165, v166
  v_max3_f32 v89, v89, v167, v168
  v_max3_f32 v89, v89, v169, v170
  v_max3_f32 v89, v89, v171, v172
  v_max3_f32 v89, v89, v173, v174
  v_max_f32 v89, v89, v175
  v_mov_b32 v90, v89
  s_nop 1
  v_permlane32_swap_b32 v89, v90
  s_nop 1
  v_max_f32 v89, v89, v90
  v_sub_f32 v128, 0, v89
  v_sub_f32 v129, 0, v89
  v_sub_f32 v130, 0, v89
  v_sub_f32 v131, 0, v89
  v_sub_f32 v132, 0, v89
  v_sub_f32 v133, 0, v89
  v_sub_f32 v134, 0, v89
  v_sub_f32 v135, 0, v89
  v_sub_f32 v136, 0, v89
  v_sub_f32 v137, 0, v89
  v_sub_f32 v138, 0, v89
  v_sub_f32 v139, 0, v89
  v_sub_f32 v140, 0, v89
  v_sub_f32 v141, 0, v89
  v_sub_f32 v142, 0, v89
  v_sub_f32 v143, 0, v89
  v_sub_f32 v160, v160, v89
  v_sub_f32 v161, v161, v89
  v_sub_f32 v162, v162, v89
  v_sub_f32 v163, v163, v89
  v_sub_f32 v164, v164, v89
  v_sub_f32 v165, v165, v89
  v_sub_f32 v166, v166, v89
  v_sub_f32 v167, v167, v89
  v_sub_f32 v168, v168, v89
  v_sub_f32 v169, v169, v89
  v_sub_f32 v170, v170, v89
  v_sub_f32 v171, v171, v89
  v_sub_f32 v172, v172, v89
  v_sub_f32 v173, v173, v89
  v_sub_f32 v174, v174, v89
  v_sub_f32 v175, v175, v89
  s_waitcnt lgkmcnt(0)
  v_mfma_f32_32x32x16_bf16 v[176:191], v[44:47], v[96:99], v[128:143]
  v_exp_f32 v80, v160
  v_exp_f32 v81, v161
  v_exp_f32 v82, v162
  v_add_f32 v84, v80, v81
  v_cvt_pk_bf16_f32 v144, v80, v81
  v_mfma_f32_32x32x16_bf16 v[176:191], v[48:51], v[100:103], v[176:191]
  v_exp_f32 v83, v163
  v_add_f32 v84, v84, v82
  v_exp_f32 v80, v164
  v_add_f32 v84, v84, v83
  v_cvt_pk_bf16_f32 v145, v82, v83
  v_mfma_f32_32x32x16_bf16 v[176:191], v[52:55], v[104:107], v[176:191]
  v_exp_f32 v81, v165
  v_add_f32 v84, v84, v80
  v_exp_f32 v82, v166
  v_add_f32 v84, v84, v81
  v_cvt_pk_bf16_f32 v146, v80, v81
  v_mfma_f32_32x32x16_bf16 v[176:191], v[56:59], v[108:111], v[176:191]
  v_exp_f32 v83, v167
  v_add_f32 v84, v84, v82
  v_exp_f32 v80, v168
  v_add_f32 v84, v84, v83
  v_cvt_pk_bf16_f32 v147, v82, v83
  v_mfma_f32_32x32x16_bf16 v[176:191], v[60:63], v[112:115], v[176:191]
  v_exp_f32 v81, v169
  v_add_f32 v84, v84, v80
  v_exp_f32 v82, v170
  v_add_f32 v84, v84, v81
  v_cvt_pk_bf16_f32 v148, v80, v81
  v_mfma_f32_32x32x16_bf16 v[176:191], v[64:67], v[116:119], v[176:191]
  v_exp_f32 v83, v171
  v_add_f32 v84, v84, v82
  v_exp_f32 v80, v172
  v_add_f32 v84, v84, v83
  v_cvt_pk_bf16_f32 v149, v82, v83
  v_mfma_f32_32x32x16_bf16 v[176:191], v[68:71], v[120:123], v[176:191]
  v_exp_f32 v81, v173
  v_add_f32 v84, v84, v80
  v_exp_f32 v82, v174
  v_add_f32 v84, v84, v81
  v_cvt_pk_bf16_f32 v150, v80, v81
  v_mfma_f32_32x32x16_bf16 v[176:191], v[72:75], v[124:127], v[176:191]
  v_exp_f32 v83, v175
  v_add_f32 v84, v84, v82
  v_add_f32 v84, v84, v83
  v_cvt_pk_bf16_f32 v151, v82, v83
  ds_read_b128 v[12:15], v8 offset:0
  ds_read_b128 v[16:19], v8 offset:1024
  ds_read_b128 v[20:23], v8 offset:2048
  ds_read_b128 v[24:27], v8 offset:3072
  ds_read_b128 v[28:31], v8 offset:4096
  ds_read_b128 v[32:35], v8 offset:5120
  ds_read_b128 v[36:39], v8 offset:6144
  ds_read_b128 v[40:43], v8 offset:7168
  ds_read_b128 v[44:47], v8 offset:16384
  ds_read_b128 v[48:51], v8 offset:17408
  ds_read_b128 v[52:55], v8 offset:18432
  ds_read_b128 v[56:59], v8 offset:19456
  s_cmp_lg_u32 s45, 1
  s_cbranch_scc1 Lpm_22
  s_add_u32 s56, s47, 1
  s_lshl_b32 s56, s56, 6
  s_add_u32 s56, s56, 32
  v_subrev_u32 v87, s56, v3
  v_cmp_le_i32 s[8:9], 0, v87
  v_cmp_le_i32 s[10:11], 1, v87
  v_cmp_le_i32 s[12:13], 2, v87
  v_cmp_le_i32 s[14:15], 3, v87
  s_nop 1
  v_cndmask_b32 v176, v88, v176, s[8:9]
  v_cndmask_b32 v177, v88, v177, s[10:11]
  v_cndmask_b32 v178, v88, v178, s[12:13]
  v_cndmask_b32 v179, v88, v179, s[14:15]
  v_cmp_le_i32 s[8:9], 16, v87
  v_cmp_le_i32 s[10:11], 17, v87
  v_cmp_le_i32 s[12:13], 18, v87
  v_cmp_le_i32 s[14:15], 19, v87
  s_nop 1
  v_cndmask_b32 v180, v88, v180, s[8:9]
  v_cndmask_b32 v181, v88, v181, s[10:11]
  v_cndmask_b32 v182, v88, v182, s[12:13]
  v_cndmask_b32 v183, v88, v183, s[14:15]
  v_cmp_le_i32 s[8:9], 8, v87
  v_cmp_le_i32 s[10:11], 9, v87
  v_cmp_le_i32 s[12:13], 10, v87
  v_cmp_le_i32 s[14:15], 11, v87
  s_nop 1
  v_cndmask_b32 v184, v88, v184, s[8:9]
  v_cndmask_b32 v185, v88, v185, s[10:11]
  v_cndmask_b32 v186, v88, v186, s[12:13]
  v_cndmask_b32 v187, v88, v187, s[14:15]
  v_cmp_le_i32 s[8:9], 24, v87
  v_cmp_le_i32 s[10:11], 25, v87
  v_cmp_le_i32 s[12:13], 26, v87
  v_cmp_le_i32 s[14:15], 27, v87
  s_nop 1
  v_cndmask_b32 v188, v88, v188, s[8:9]
  v_cndmask_b32 v189, v88, v189, s[10:11]
  v_cndmask_b32 v190, v88, v190, s[12:13]
  v_cndmask_b32 v191, v88, v191, s[14:15]
Lpm_22:
  v_exp_f32 v80, v176
  v_exp_f32 v81, v177
  v_exp_f32 v82, v178
  v_add_f32 v85, v80, v81
  v_cvt_pk_bf16_f32 v152, v80, v81
  v_exp_f32 v83, v179
  v_add_f32 v85, v85, v82
  s_nop 0
  s_waitcnt lgkmcnt(0)
  s_cmp_lt_u32 s45, 2
  s_cbranch_scc1 Lend_24
  s_cmp_lt_u32 s45, 3
  s_cbranch_scc1 Lsk_23
  s_sub_u32 s66, s45, 3
.p2align 3
sequential_preLN__compressed_kv_cla__dense_activation_squared_relu__prompt_kernel_loopB:
  v_mfma_f32_32x32x16_bf16 v[160:175], v[12:15], v[96:99], v[128:143]
  ds_read_b128 v[60:63], v8 offset:20480
  v_exp_f32 v80, v180
  v_add_f32 v85, v85, v83
  v_cvt_pk_bf16_f32 v153, v82, v83
  v_mfma_f32_32x32x16_bf16 v[160:175], v[16:19], v[100:103], v[160:175]
  ds_read_b128 v[64:67], v8 offset:21504
  v_exp_f32 v81, v181
  v_add_f32 v85, v85, v80
  s_waitcnt lgkmcnt(4)
  v_mfma_f32_32x32x16_bf16 v[160:175], v[20:23], v[104:107], v[160:175]
  ds_read_b128 v[68:71], v8 offset:22528
  v_exp_f32 v82, v182
  v_add_f32 v85, v85, v81
  v_cvt_pk_bf16_f32 v154, v80, v81
  v_mfma_f32_32x32x16_bf16 v[160:175], v[24:27], v[108:111], v[160:175]
  ds_read_b128 v[72:75], v8 offset:23552
  v_exp_f32 v83, v183
  v_add_f32 v85, v85, v82
  v_add_f32 v86, v86, v84
  v_mfma_f32_32x32x16_bf16 v[160:175], v[28:31], v[112:115], v[160:175]
  ds_read_b128 v[12:15], v8 offset:8192
  v_exp_f32 v80, v184
  v_add_f32 v85, v85, v83
  v_cvt_pk_bf16_f32 v155, v82, v83
  v_mfma_f32_32x32x16_bf16 v[160:175], v[32:35], v[116:119], v[160:175]
  ds_read_b128 v[16:19], v8 offset:9216
  v_exp_f32 v81, v185
  v_add_f32 v85, v85, v80
  s_add_u32 s48, s48, 32768
  v_mfma_f32_32x32x16_bf16 v[160:175], v[36:39], v[120:123], v[160:175]
  ds_read_b128 v[20:23], v8 offset:10240
  v_exp_f32 v82, v186
  v_add_f32 v85, v85, v81
  v_cvt_pk_bf16_f32 v156, v80, v81
  v_mfma_f32_32x32x16_bf16 v[160:175], v[40:43], v[124:127], v[160:175]
  ds_read_b128 v[24:27], v8 offset:11264
  v_exp_f32 v83, v187
  v_add_f32 v85, v85, v82
  s_and_b32 s48, s48, 131071
  v_mfma_f32_32x32x16_bf16 v[192:207], v[44:47], v[144:147], v[192:207]
  ds_read_b128 v[28:31], v8 offset:12288
  v_exp_f32 v80, v188
  v_add_f32 v85, v85, v83
  v_cvt_pk_bf16_f32 v157, v82, v83
  v_mfma_f32_32x32x16_bf16 v[208:223], v[48:51], v[144:147], v[208:223]
  ds_read_b128 v[32:35], v8 offset:13312
  v_exp_f32 v81, v189
  v_add_f32 v85, v85, v80
  s_waitcnt lgkmcnt(4)
  v_mfma_f32_32x32x16_bf16 v[224:239], v[52:55], v[144:147], v[224:239]
  ds_read_b128 v[36:39], v8 offset:14336
  v_exp_f32 v82, v190
  v_add_f32 v85, v85, v81
  v_cvt_pk_bf16_f32 v158, v80, v81
  v_mfma_f32_32x32x16_bf16 v[240:255], v[56:59], v[144:147], v[240:255]
  ds_read_b128 v[40:43], v8 offset:15360
  v_exp_f32 v83, v191
  v_add_f32 v85, v85, v82
  v_mfma_f32_32x32x16_bf16 v[192:207], v[60:63], v[148:151], v[192:207]
  ds_read_b128 v[44:47], v8 offset:24576
  v_exp_f32 v80, v160
  v_add_f32 v85, v85, v83
  v_cvt_pk_bf16_f32 v159, v82, v83
  v_mfma_f32_32x32x16_bf16 v[208:223], v[64:67], v[148:151], v[208:223]
  ds_read_b128 v[48:51], v8 offset:25600
  v_exp_f32 v81, v161
  v_cmp_lt_f32 vcc, s60, v85
  s_barrier
  v_mfma_f32_32x32x16_bf16 v[224:239], v[68:71], v[148:151], v[224:239]
  ds_read_b128 v[52:55], v8 offset:26624
  v_exp_f32 v82, v162
  v_add_f32 v84, v80, v81
  v_cvt_pk_bf16_f32 v144, v80, v81
  v_mfma_f32_32x32x16_bf16 v[240:255], v[72:75], v[148:151], v[240:255]
  ds_read_b128 v[56:59], v8 offset:27648
  v_exp_f32 v83, v163
  v_add_f32 v84, v84, v82
  s_cbranch_vccnz sequential_preLN__compressed_kv_cla__dense_activation_squared_relu__prompt_kernel_chk1_B
sequential_preLN__compressed_kv_cla__dense_activation_squared_relu__prompt_kernel_chk1_B_ret:
  v_mfma_f32_32x32x16_bf16 v[176:191], v[12:15], v[96:99], v[128:143]
  ds_read_b128 v[60:63], v8 offset:28672
  v_exp_f32 v80, v164
  v_add_f32 v84, v84, v83
  v_cvt_pk_bf16_f32 v145, v82, v83
  v_mfma_f32_32x32x16_bf16 v[176:191], v[16:19], v[100:103], v[176:191]
  ds_read_b128 v[64:67], v8 offset:29696
  v_exp_f32 v81, v165
  v_add_f32 v84, v84, v80
  s_waitcnt lgkmcnt(4)
  v_mfma_f32_32x32x16_bf16 v[176:191], v[20:23], v[104:107], v[176:191]
  ds_read_b128 v[68:71], v8 offset:30720
  v_exp_f32 v82, v166
  v_add_f32 v84, v84, v81
  v_cvt_pk_bf16_f32 v146, v80, v81
  v_mfma_f32_32x32x16_bf16 v[176:191], v[24:27], v[108:111], v[176:191]
  ds_read_b128 v[72:75], v8 offset:31744
  v_exp_f32 v83, v167
  v_add_f32 v84, v84, v82
  v_add_u32 v8, s48, v2
  v_mfma_f32_32x32x16_bf16 v[176:191], v[28:31], v[112:115], v[176:191]
  ds_read_b128 v[12:15], v8 offset:0
  v_exp_f32 v80, v168
  v_add_f32 v84, v84, v83
  v_cvt_pk_bf16_f32 v147, v82, v83
  v_mfma_f32_32x32x16_bf16 v[176:191], v[32:35], v[116:119], v[176:191]
  ds_read_b128 v[16:19], v8 offset:1024
  v_exp_f32 v81, v169
  v_add_f32 v84, v84, v80
  v_add_f32 v86, v86, v85
  v_mfma_f32_32x32x16_bf16 v[176:191], v[36:39], v[120:123], v[176:191]
  ds_read_b128 v[20:23], v8 offset:2048
  v_exp_f32 v82, v170
  v_add_f32 v84, v84, v81
  v_cvt_pk_bf16_f32 v148, v80, v81
  v_mfma_f32_32x32x16_bf16 v[176:191], v[40:43], v[124:127], v[176:191]
  ds_read_b128 v[24:27], v8 offset:3072
  v_exp_f32 v83, v171
  v_add_f32 v84, v84, v82
  v_mfma_f32_32x32x16_bf16 v[192:207], v[44:47], v[152:155], v[192:207]
  ds_read_b128 v[28:31], v8 offset:4096
  v_exp_f32 v80, v172
  v_add_f32 v84, v84, v83
  v_cvt_pk_bf16_f32 v149, v82, v83
  v_mfma_f32_32x32x16_bf16 v[208:223], v[48:51], v[152:155], v[208:223]
  ds_read_b128 v[32:35], v8 offset:5120
  v_exp_f32 v81, v173
  v_add_f32 v84, v84, v80
  s_waitcnt lgkmcnt(4)
  v_mfma_f32_32x32x16_bf16 v[224:239], v[52:55], v[152:155], v[224:239]
  ds_read_b128 v[36:39], v8 offset:6144
  v_exp_f32 v82, v174
  v_add_f32 v84, v84, v81
  v_cvt_pk_bf16_f32 v150, v80, v81
  v_mfma_f32_32x32x16_bf16 v[240:255], v[56:59], v[152:155], v[240:255]
  ds_read_b128 v[40:43], v8 offset:7168
  v_exp_f32 v83, v175
  v_add_f32 v84, v84, v82
  v_mfma_f32_32x32x16_bf16 v[192:207], v[60:63], v[156:159], v[192:207]
  ds_read_b128 v[44:47], v8 offset:16384
  v_exp_f32 v80, v176
  v_add_f32 v84, v84, v83
  v_cvt_pk_bf16_f32 v151, v82, v83
  v_mfma_f32_32x32x16_bf16 v[208:223], v[64:67], v[156:159], v[208:223]
  ds_read_b128 v[48:51], v8 offset:17408
  v_exp_f32 v81, v177
  v_cmp_lt_f32 vcc, s60, v84
  v_mfma_f32_32x32x16_bf16 v[224:239], v[68:71], v[156:159], v[224:239]
  ds_read_b128 v[52:55], v8 offset:18432
  v_exp_f32 v82, v178
  v_add_f32 v85, v80, v81
  v_cvt_pk_bf16_f32 v152, v80, v81
  v_mfma_f32_32x32x16_bf16 v[240:255], v[72:75], v[156:159], v[240:255]
  ds_read_b128 v[56:59], v8 offset:19456
  v_exp_f32 v83, v179
  v_add_f32 v85, v85, v82
  s_cbranch_vccnz sequential_preLN__compressed_kv_cla__dense_activation_squared_relu__prompt_kernel_chk0_B
sequential_preLN__compressed_kv_cla__dense_activation_squared_relu__prompt_kernel_chk0_B_ret:
  s_sub_u32 s66, s66, 1
  s_cbranch_scc0 sequential_preLN__compressed_kv_cla__dense_activation_squared_relu__prompt_kernel_loopB
Lsk_23:
  s_sub_u32 s47, s45, 2
  s_mov_b32 s66, 0
  s_bitcmp0_b32 s54, 0
  s_cbranch_scc1 Lev_25
.p2align 3
sequential_preLN__compressed_kv_cla__dense_activation_squared_relu__prompt_kernel_loopBm:
  v_mfma_f32_32x32x16_bf16 v[160:175], v[12:15], v[96:99], v[128:143]
  ds_read_b128 v[60:63], v8 offset:20480
  v_exp_f32 v80, v180
  v_add_f32 v85, v85, v83
  v_cvt_pk_bf16_f32 v153, v82, v83
  v_mfma_f32_32x32x16_bf16 v[160:175], v[16:19], v[100:103], v[160:175]
  ds_read_b128 v[64:67], v8 offset:21504
  v_exp_f32 v81, v181
  v_add_f32 v85, v85, v80
  s_waitcnt lgkmcnt(4)
  v_mfma_f32_32x32x16_bf16 v[160:175], v[20:23], v[104:107], v[160:175]
  ds_read_b128 v[68:71], v8 offset:22528
  v_exp_f32 v82, v182
  v_add_f32 v85, v85, v81
  v_cvt_pk_bf16_f32 v154, v80, v81
  v_mfma_f32_32x32x16_bf16 v[160:175], v[24:27], v[108:111], v[160:175]
  ds_read_b128 v[72:75], v8 offset:23552
  v_exp_f32 v83, v183
  v_add_f32 v85, v85, v82
  v_add_f32 v86, v86, v84
  v_mfma_f32_32x32x16_bf16 v[160:175], v[28:31], v[112:115], v[160:175]
  ds_read_b128 v[12:15], v8 offset:8192
  v_exp_f32 v80, v184
  v_add_f32 v85, v85, v83
  v_cvt_pk_bf16_f32 v155, v82, v83
  v_mfma_f32_32x32x16_bf16 v[160:175], v[32:35], v[116:119], v[160:175]
  ds_read_b128 v[16:19], v8 offset:9216
  v_exp_f32 v81, v185
  v_add_f32 v85, v85, v80
  s_add_u32 s48, s48, 32768
  v_mfma_f32_32x32x16_bf16 v[160:175], v[36:39], v[120:123], v[160:175]
  ds_read_b128 v[20:23], v8 offset:10240
  v_exp_f32 v82, v186
  v_add_f32 v85, v85, v81
  v_cvt_pk_bf16_f32 v156, v80, v81
  v_mfma_f32_32x32x16_bf16 v[160:175], v[40:43], v[124:127], v[160:175]
  ds_read_b128 v[24:27], v8 offset:11264
  v_exp_f32 v83, v187
  v_add_f32 v85, v85, v82
  s_and_b32 s48, s48, 131071
  v_mfma_f32_32x32x16_bf16 v[192:207], v[44:47], v[144:147], v[192:207]
  ds_read_b128 v[28:31], v8 offset:12288
  v_exp_f32 v80, v188
  v_add_f32 v85, v85, v83
  v_cvt_pk_bf16_f32 v157, v82, v83
  v_mfma_f32_32x32x16_bf16 v[208:223], v[48:51], v[144:147], v[208:223]
  ds_read_b128 v[32:35], v8 offset:13312
  v_exp_f32 v81, v189
  v_add_f32 v85, v85, v80
  s_waitcnt lgkmcnt(4)
  v_mfma_f32_32x32x16_bf16 v[224:239], v[52:55], v[144:147], v[224:239]
  ds_read_b128 v[36:39], v8 offset:14336
  v_exp_f32 v82, v190
  v_add_f32 v85, v85, v81
  v_cvt_pk_bf16_f32 v158, v80, v81
  v_mfma_f32_32x32x16_bf16 v[240:255], v[56:59], v[144:147], v[240:255]
  ds_read_b128 v[40:43], v8 offset:15360
  v_exp_f32 v83, v191
  v_add_f32 v85, v85, v82
  v_mfma_f32_32x32x16_bf16 v[192:207], v[60:63], v[148:151], v[192:207]
  ds_read_b128 v[44:47], v8 offset:24576
  s_add_u32 s56, s47, 1
  s_lshl_b32 s56, s56, 6
  s_add_u32 s56, s56, 0
  v_subrev_u32 v87, s56, v3
  v_cmp_le_i32 s[8:9], 0, v87
  v_cmp_le_i32 s[10:11], 1, v87
  v_cmp_le_i32 s[12:13], 2, v87
  v_cmp_le_i32 s[14:15], 3, v87
  s_nop 1
  v_cndmask_b32 v160, v88, v160, s[8:9]
  v_cndmask_b32 v161, v88, v161, s[10:11]
  v_cndmask_b32 v162, v88, v162, s[12:13]
  v_cndmask_b32 v163, v88, v163, s[14:15]
  v_cmp_le_i32 s[8:9], 16, v87
  v_cmp_le_i32 s[10:11], 17, v87
  v_cmp_le_i32 s[12:13], 18, v87
  v_cmp_le_i32 s[14:15], 19, v87
  s_nop 1
  v_cndmask_b32 v164, v88, v164, s[8:9]
  v_cndmask_b32 v165, v88, v165, s[10:11]
  v_cndmask_b32 v166, v88, v166, s[12:13]
  v_cndmask_b32 v167, v88, v167, s[14:15]
  v_cmp_le_i32 s[8:9], 8, v87
  v_cmp_le_i32 s[10:11], 9, v87
  v_cmp_le_i32 s[12:13], 10, v87
  v_cmp_le_i32 s[14:15], 11, v87
  s_nop 1
  v_cndmask_b32 v168, v88, v168, s[8:9]
  v_cndmask_b32 v169, v88, v169, s[10:11]
  v_cndmask_b32 v170, v88, v170, s[12:13]
  v_cndmask_b32 v171, v88, v171, s[14:15]
  v_cmp_le_i32 s[8:9], 24, v87
  v_cmp_le_i32 s[10:11], 25, v87
  v_cmp_le_i32 s[12:13], 26, v87
  v_cmp_le_i32 s[14:15], 27, v87
  s_nop 1
  v_cndmask_b32 v172, v88, v172, s[8:9]
  v_cndmask_b32 v173, v88, v173, s[10:11]
  v_cndmask_b32 v174, v88, v174, s[12:13]
  v_cndmask_b32 v175, v88, v175, s[14:15]
  v_exp_f32 v80, v160
  v_add_f32 v85, v85, v83
  v_cvt_pk_bf16_f32 v159, v82, v83
  v_mfma_f32_32x32x16_bf16 v[208:223], v[64:67], v[148:151], v[208:223]
  ds_read_b128 v[48:51], v8 offset:25600
  v_exp_f32 v81, v161
  v_cmp_lt_f32 vcc, s60, v85
  s_barrier
  v_mfma_f32_32x32x16_bf16 v[224:239], v[68:71], v[148:151], v[224:239]
  ds_read_b128 v[52:55], v8 offset:26624
  v_exp_f32 v82, v162
  v_add_f32 v84, v80, v81
  v_cvt_pk_bf16_f32 v144, v80, v81
  v_mfma_f32_32x32x16_bf16 v[240:255], v[72:75], v[148:151], v[240:255]
  ds_read_b128 v[56:59], v8 offset:27648
  v_exp_f32 v83, v163
  v_add_f32 v84, v84, v82
  s_cbranch_vccnz sequential_preLN__compressed_kv_cla__dense_activation_squared_relu__prompt_kernel_chk1_Bm
sequential_preLN__compressed_kv_cla__dense_activation_squared_relu__prompt_kernel_chk1_Bm_ret:
  v_mfma_f32_32x32x16_bf16 v[176:191], v[12:15], v[96:99], v[128:143]
  ds_read_b128 v[60:63], v8 offset:28672
  v_exp_f32 v80, v164
  v_add_f32 v84, v84, v83
  v_cvt_pk_bf16_f32 v145, v82, v83
  v_mfma_f32_32x32x16_bf16 v[176:191], v[16:19], v[100:103], v[176:191]
  ds_read_b128 v[64:67], v8 offset:29696
  v_exp_f32 v81, v165
  v_add_f32 v84, v84, v80
  s_waitcnt lgkmcnt(4)
  v_mfma_f32_32x32x16_bf16 v[176:191], v[20:23], v[104:107], v[176:191]
  ds_read_b128 v[68:71], v8 offset:30720
  v_exp_f32 v82, v166
  v_add_f32 v84, v84, v81
  v_cvt_pk_bf16_f32 v146, v80, v81
  v_mfma_f32_32x32x16_bf16 v[176:191], v[24:27], v[108:111], v[176:191]
  ds_read_b128 v[72:75], v8 offset:31744
  v_exp_f32 v83, v167
  v_add_f32 v84, v84, v82
  v_add_u32 v8, s48, v2
  v_mfma_f32_32x32x16_bf16 v[176:191], v[28:31], v[112:115], v[176:191]
  ds_read_b128 v[12:15], v8 offset:0
  v_exp_f32 v80, v168
  v_add_f32 v84, v84, v83
  v_cvt_pk_bf16_f32 v147, v82, v83
  v_mfma_f32_32x32x16_bf16 v[176:191], v[32:35], v[116:119], v[176:191]
  ds_read_b128 v[16:19], v8 offset:1024
  v_exp_f32 v81, v169
  v_add_f32 v84, v84, v80
  v_add_f32 v86, v86, v85
  v_mfma_f32_32x32x16_bf16 v[176:191], v[36:39], v[120:123], v[176:191]
  ds_read_b128 v[20:23], v8 offset:2048
  v_exp_f32 v82, v170
  v_add_f32 v84, v84, v81
  v_cvt_pk_bf16_f32 v148, v80, v81
  v_mfma_f32_32x32x16_bf16 v[176:191], v[40:43], v[124:127], v[176:191]
  ds_read_b128 v[24:27], v8 offset:3072
  v_exp_f32 v83, v171
  v_add_f32 v84, v84, v82
  s_add_u32 s47, s47, 1
  v_mfma_f32_32x32x16_bf16 v[192:207], v[44:47], v[152:155], v[192:207]
  ds_read_b128 v[28:31], v8 offset:4096
  v_exp_f32 v80, v172
  v_add_f32 v84, v84, v83
  v_cvt_pk_bf16_f32 v149, v82, v83
  v_mfma_f32_32x32x16_bf16 v[208:223], v[48:51], v[152:155], v[208:223]
  ds_read_b128 v[32:35], v8 offset:5120
  v_exp_f32 v81, v173
  v_add_f32 v84, v84, v80
  s_waitcnt lgkmcnt(4)
  v_mfma_f32_32x32x16_bf16 v[224:239], v[52:55], v[152:155], v[224:239]
  ds_read_b128 v[36:39], v8 offset:6144
  v_exp_f32 v82, v174
  v_add_f32 v84, v84, v81
  v_cvt_pk_bf16_f32 v150, v80, v81
  v_mfma_f32_32x32x16_bf16 v[240:255], v[56:59], v[152:155], v[240:255]
  ds_read_b128 v[40:43], v8 offset:7168
  v_exp_f32 v83, v175
  v_add_f32 v84, v84, v82
  v_mfma_f32_32x32x16_bf16 v[192:207], v[60:63], v[156:159], v[192:207]
  ds_read_b128 v[44:47], v8 offset:16384
  s_add_u32 s56, s47, 0
  s_lshl_b32 s56, s56, 6
  s_add_u32 s56, s56, 32
  v_subrev_u32 v87, s56, v3
  v_cmp_le_i32 s[8:9], 0, v87
  v_cmp_le_i32 s[10:11], 1, v87
  v_cmp_le_i32 s[12:13], 2, v87
  v_cmp_le_i32 s[14:15], 3, v87
  s_nop 1
  v_cndmask_b32 v176, v88, v176, s[8:9]
  v_cndmask_b32 v177, v88, v177, s[10:11]
  v_cndmask_b32 v178, v88, v178, s[12:13]
  v_cndmask_b32 v179, v88, v179, s[14:15]
  v_cmp_le_i32 s[8:9], 16, v87
  v_cmp_le_i32 s[10:11], 17, v87
  v_cmp_le_i32 s[12:13], 18, v87
  v_cmp_le_i32 s[14:15], 19, v87
  s_nop 1
  v_cndmask_b32 v180, v88, v180, s[8:9]
  v_cndmask_b32 v181, v88, v181, s[10:11]
  v_cndmask_b32 v182, v88, v182, s[12:13]
  v_cndmask_b32 v183, v88, v183, s[14:15]
  v_cmp_le_i32 s[8:9], 8, v87
  v_cmp_le_i32 s[10:11], 9, v87
  v_cmp_le_i32 s[12:13], 10, v87
  v_cmp_le_i32 s[14:15], 11, v87
  s_nop 1
  v_cndmask_b32 v184, v88, v184, s[8:9]
  v_cndmask_b32 v185, v88, v185, s[10:11]
  v_cndmask_b32 v186, v88, v186, s[12:13]
  v_cndmask_b32 v187, v88, v187, s[14:15]
  v_cmp_le_i32 s[8:9], 24, v87
  v_cmp_le_i32 s[10:11], 25, v87
  v_cmp_le_i32 s[12:13], 26, v87
  v_cmp_le_i32 s[14:15], 27, v87
  s_nop 1
  v_cndmask_b32 v188, v88, v188, s[8:9]
  v_cndmask_b32 v189, v88, v189, s[10:11]
  v_cndmask_b32 v190, v88, v190, s[12:13]
  v_cndmask_b32 v191, v88, v191, s[14:15]
  v_exp_f32 v80, v176
  v_add_f32 v84, v84, v83
  v_cvt_pk_bf16_f32 v151, v82, v83
  v_mfma_f32_32x32x16_bf16 v[208:223], v[64:67], v[156:159], v[208:223]
  ds_read_b128 v[48:51], v8 offset:17408
  v_exp_f32 v81, v177
  v_cmp_lt_f32 vcc, s60, v84
  v_mfma_f32_32x32x16_bf16 v[224:239], v[68:71], v[156:159], v[224:239]
  ds_read_b128 v[52:55], v8 offset:18432
  v_exp_f32 v82, v178
  v_add_f32 v85, v80, v81
  v_cvt_pk_bf16_f32 v152, v80, v81
  v_mfma_f32_32x32x16_bf16 v[240:255], v[72:75], v[156:159], v[240:255]
  ds_read_b128 v[56:59], v8 offset:19456
  v_exp_f32 v83, v179
  v_add_f32 v85, v85, v82
  s_cbranch_vccnz sequential_preLN__compressed_kv_cla__dense_activation_squared_relu__prompt_kernel_chk0_Bm
sequential_preLN__compressed_kv_cla__dense_activation_squared_relu__prompt_kernel_chk0_Bm_ret:
  s_sub_u32 s66, s66, 1
  s_cbranch_scc0 sequential_preLN__compressed_kv_cla__dense_activation_squared_relu__prompt_kernel_loopBm
  s_branch Lend_24
Lev_25:
.p2align 3
sequential_preLN__compressed_kv_cla__dense_activation_squared_relu__prompt_kernel_loopBme:
  v_mfma_f32_32x32x16_bf16 v[160:175], v[12:15], v[96:99], v[128:143]
  ds_read_b128 v[60:63], v8 offset:20480
  v_exp_f32 v80, v180
  v_add_f32 v85, v85, v83
  v_cvt_pk_bf16_f32 v153, v82, v83
  v_mfma_f32_32x32x16_bf16 v[160:175], v[16:19], v[100:103], v[160:175]
  ds_read_b128 v[64:67], v8 offset:21504
  v_exp_f32 v81, v181
  v_add_f32 v85, v85, v80
  s_waitcnt lgkmcnt(4)
  v_mfma_f32_32x32x16_bf16 v[160:175], v[20:23], v[104:107], v[160:175]
  ds_read_b128 v[68:71], v8 offset:22528
  v_exp_f32 v82, v182
  v_add_f32 v85, v85, v81
  v_cvt_pk_bf16_f32 v154, v80, v81
  v_mfma_f32_32x32x16_bf16 v[160:175], v[24:27], v[108:111], v[160:175]
  ds_read_b128 v[72:75], v8 offset:23552
  v_exp_f32 v83, v183
  v_add_f32 v85, v85, v82
  v_add_f32 v86, v86, v84
  v_mfma_f32_32x32x16_bf16 v[160:175], v[28:31], v[112:115], v[160:175]
  ds_read_b128 v[12:15], v8 offset:8192
  v_exp_f32 v80, v184
  v_add_f32 v85, v85, v83
  v_cvt_pk_bf16_f32 v155, v82, v83
  v_mfma_f32_32x32x16_bf16 v[160:175], v[32:35], v[116:119], v[160:175]
  ds_read_b128 v[16:19], v8 offset:9216
  v_exp_f32 v81, v185
  v_add_f32 v85, v85, v80
  s_add_u32 s48, s48, 32768
  v_mfma_f32_32x32x16_bf16 v[160:175], v[36:39], v[120:123], v[160:175]
  ds_read_b128 v[20:23], v8 offset:10240
  v_exp_f32 v82, v186
  v_add_f32 v85, v85, v81
  v_cvt_pk_bf16_f32 v156, v80, v81
  v_mfma_f32_32x32x16_bf16 v[160:175], v[40:43], v[124:127], v[160:175]
  ds_read_b128 v[24:27], v8 offset:11264
  v_exp_f32 v83, v187
  v_add_f32 v85, v85, v82
  s_and_b32 s48, s48, 131071
  v_mfma_f32_32x32x16_bf16 v[192:207], v[44:47], v[144:147], v[192:207]
  ds_read_b128 v[28:31], v8 offset:12288
  v_exp_f32 v80, v188
  v_add_f32 v85, v85, v83
  v_cvt_pk_bf16_f32 v157, v82, v83
  v_mfma_f32_32x32x16_bf16 v[208:223], v[48:51], v[144:147], v[208:223]
  ds_read_b128 v[32:35], v8 offset:13312
  v_exp_f32 v81, v189
  v_add_f32 v85, v85, v80
  s_waitcnt lgkmcnt(4)
  v_mfma_f32_32x32x16_bf16 v[224:239], v[52:55], v[144:147], v[224:239]
  ds_read_b128 v[36:39], v8 offset:14336
  v_exp_f32 v82, v190
  v_add_f32 v85, v85, v81
  v_cvt_pk_bf16_f32 v158, v80, v81
  v_mfma_f32_32x32x16_bf16 v[240:255], v[56:59], v[144:147], v[240:255]
  ds_read_b128 v[40:43], v8 offset:15360
  v_exp_f32 v83, v191
  v_add_f32 v85, v85, v82
  v_mfma_f32_32x32x16_bf16 v[192:207], v[60:63], v[148:151], v[192:207]
  ds_read_b128 v[44:47], v8 offset:24576
  s_add_u32 s56, s47, 1
  s_lshl_b32 s56, s56, 6
  s_add_u32 s56, s56, 0
  v_subrev_u32 v87, s56, v3
  v_cmp_le_i32 s[8:9], 0, v87
  v_cmp_le_i32 s[10:11], 1, v87
  v_cmp_le_i32 s[12:13], 2, v87
  v_cmp_le_i32 s[14:15], 3, v87
  s_nop 1
  v_cndmask_b32 v160, v88, v160, s[8:9]
  v_cndmask_b32 v161, v88, v161, s[10:11]
  v_cndmask_b32 v162, v88, v162, s[12:13]
  v_cndmask_b32 v163, v88, v163, s[14:15]
  v_cmp_le_i32 s[8:9], 16, v87
  v_cmp_le_i32 s[10:11], 17, v87
  v_cmp_le_i32 s[12:13], 18, v87
  v_cmp_le_i32 s[14:15], 19, v87
  s_nop 1
  v_cndmask_b32 v164, v88, v164, s[8:9]
  v_cndmask_b32 v165, v88, v165, s[10:11]
  v_cndmask_b32 v166, v88, v166, s[12:13]
  v_cndmask_b32 v167, v88, v167, s[14:15]
  v_cmp_le_i32 s[8:9], 8, v87
  v_cmp_le_i32 s[10:11], 9, v87
  v_cmp_le_i32 s[12:13], 10, v87
  v_cmp_le_i32 s[14:15], 11, v87
  s_nop 1
  v_cndmask_b32 v168, v88, v168, s[8:9]
  v_cndmask_b32 v169, v88, v169, s[10:11]
  v_cndmask_b32 v170, v88, v170, s[12:13]
  v_cndmask_b32 v171, v88, v171, s[14:15]
  v_cmp_le_i32 s[8:9], 24, v87
  v_cmp_le_i32 s[10:11], 25, v87
  v_cmp_le_i32 s[12:13], 26, v87
  v_cmp_le_i32 s[14:15], 27, v87
  s_nop 1
  v_cndmask_b32 v172, v88, v172, s[8:9]
  v_cndmask_b32 v173, v88, v173, s[10:11]
  v_cndmask_b32 v174, v88, v174, s[12:13]
  v_cndmask_b32 v175, v88, v175, s[14:15]
  v_exp_f32 v80, v160
  v_add_f32 v85, v85, v83
  v_cvt_pk_bf16_f32 v159, v82, v83
  v_mfma_f32_32x32x16_bf16 v[208:223], v[64:67], v[148:151], v[208:223]
  ds_read_b128 v[48:51], v8 offset:25600
  v_exp_f32 v81, v161
  v_cmp_lt_f32 vcc, s60, v85
  s_barrier
  v_mfma_f32_32x32x16_bf16 v[224:239], v[68:71], v[148:151], v[224:239]
  ds_read_b128 v[52:55], v8 offset:26624
  v_exp_f32 v82, v162
  v_add_f32 v84, v80, v81
  v_cvt_pk_bf16_f32 v144, v80, v81
  v_mfma_f32_32x32x16_bf16 v[240:255], v[72:75], v[148:151], v[240:255]
  ds_read_b128 v[56:59], v8 offset:27648
  v_exp_f32 v83, v163
  v_add_f32 v84, v84, v82
  s_cbranch_vccnz sequential_preLN__compressed_kv_cla__dense_activation_squared_relu__prompt_kernel_chk1_Bme
sequential_preLN__compressed_kv_cla__dense_activation_squared_relu__prompt_kernel_chk1_Bme_ret:
  ds_read_b128 v[60:63], v8 offset:28672
  v_exp_f32 v80, v164
  v_add_f32 v84, v84, v83
  v_cvt_pk_bf16_f32 v145, v82, v83
  ds_read_b128 v[64:67], v8 offset:29696
  v_exp_f32 v81, v165
  v_add_f32 v84, v84, v80
  s_waitcnt lgkmcnt(4)
  ds_read_b128 v[68:71], v8 offset:30720
  v_exp_f32 v82, v166
  v_add_f32 v84, v84, v81
  v_cvt_pk_bf16_f32 v146, v80, v81
  ds_read_b128 v[72:75], v8 offset:31744
  v_exp_f32 v83, v167
  v_add_f32 v84, v84, v82
  v_add_u32 v8, s48, v2
  ds_read_b128 v[12:15], v8 offset:0
  v_exp_f32 v80, v168
  v_add_f32 v84, v84, v83
  v_cvt_pk_bf16_f32 v147, v82, v83
  ds_read_b128 v[16:19], v8 offset:1024
  v_exp_f32 v81, v169
  v_add_f32 v84, v84, v80
  v_add_f32 v86, v86, v85
  ds_read_b128 v[20:23], v8 offset:2048
  v_exp_f32 v82, v170
  v_add_f32 v84, v84, v81
  v_cvt_pk_bf16_f32 v148, v80, v81
  ds_read_b128 v[24:27], v8 offset:3072
  v_exp_f32 v83, v171
  v_add_f32 v84, v84, v82
  s_add_u32 s47, s47, 1
  v_mfma_f32_32x32x16_bf16 v[192:207], v[44:47], v[152:155], v[192:207]
  ds_read_b128 v[28:31], v8 offset:4096
  v_exp_f32 v80, v172
  v_add_f32 v84, v84, v83
  v_cvt_pk_bf16_f32 v149, v82, v83
  v_mfma_f32_32x32x16_bf16 v[208:223], v[48:51], v[152:155], v[208:223]
  ds_read_b128 v[32:35], v8 offset:5120
  v_exp_f32 v81, v173
  v_add_f32 v84, v84, v80
  s_waitcnt lgkmcnt(4)
  v_mfma_f32_32x32x16_bf16 v[224:239], v[52:55], v[152:155], v[224:239]
  ds_read_b128 v[36:39], v8 offset:6144
  v_exp_f32 v82, v174
  v_add_f32 v84, v84, v81
  v_cvt_pk_bf16_f32 v150, v80, v81
  v_mfma_f32_32x32x16_bf16 v[240:255], v[56:59], v[152:155], v[240:255]
  ds_read_b128 v[40:43], v8 offset:7168
  v_exp_f32 v83, v175
  v_add_f32 v84, v84, v82
  v_mfma_f32_32x32x16_bf16 v[192:207], v[60:63], v[156:159], v[192:207]
  ds_read_b128 v[44:47], v8 offset:16384
  v_add_f32 v84, v84, v83
  v_cvt_pk_bf16_f32 v151, v82, v83
  v_mfma_f32_32x32x16_bf16 v[208:223], v[64:67], v[156:159], v[208:223]
  ds_read_b128 v[48:51], v8 offset:17408
  v_cmp_lt_f32 vcc, s60, v84
  v_mfma_f32_32x32x16_bf16 v[224:239], v[68:71], v[156:159], v[224:239]
  ds_read_b128 v[52:55], v8 offset:18432
  v_mfma_f32_32x32x16_bf16 v[240:255], v[72:75], v[156:159], v[240:255]
  ds_read_b128 v[56:59], v8 offset:19456
  s_cbranch_vccnz sequential_preLN__compressed_kv_cla__dense_activation_squared_relu__prompt_kernel_chk0_Bme
sequential_preLN__compressed_kv_cla__dense_activation_squared_relu__prompt_kernel_chk0_Bme_ret:
  s_sub_u32 s66, s66, 1
  s_cbranch_scc0 sequential_preLN__compressed_kv_cla__dense_activation_squared_relu__prompt_kernel_loopBme
Lend_24:
  s_waitcnt lgkmcnt(0)
  s_cmp_eq_u32 s45, s46
  s_cbranch_scc1 Lnb_26
  s_barrier
Lnb_26:
  s_bitcmp0_b32 s54, 0
  s_cbranch_scc1 Lfe_27
  ds_read_b128 v[12:15], v8 offset:16384
  ds_read_b128 v[16:19], v8 offset:17408
  ds_read_b128 v[20:23], v8 offset:18432
  ds_read_b128 v[24:27], v8 offset:19456
  ds_read_b128 v[28:31], v8 offset:20480
  ds_read_b128 v[32:35], v8 offset:21504
  ds_read_b128 v[36:39], v8 offset:22528
  ds_read_b128 v[40:43], v8 offset:23552
  ds_read_b128 v[44:47], v8 offset:24576
  ds_read_b128 v[48:51], v8 offset:28672
  ds_read_b128 v[52:55], v8 offset:25600
  ds_read_b128 v[56:59], v8 offset:29696
  v_add_f32 v86, v86, v84
  s_waitcnt lgkmcnt(8)
  v_mfma_f32_32x32x16_bf16 v[192:207], v[12:15], v[144:147], v[192:207]
  ds_read_b128 v[60:63], v8 offset:26624
  v_exp_f32 v80, v180
  v_add_f32 v85, v85, v83
  v_cvt_pk_bf16_f32 v153, v82, v83
  v_exp_f32 v81, v181
  v_mfma_f32_32x32x16_bf16 v[208:223], v[16:19], v[144:147], v[208:223]
  ds_read_b128 v[64:67], v8 offset:30720
  v_add_f32 v85, v85, v80
  v_exp_f32 v82, v182
  v_add_f32 v85, v85, v81
  v_cvt_pk_bf16_f32 v154, v80, v81
  v_mfma_f32_32x32x16_bf16 v[224:239], v[20:23], v[144:147], v[224:239]
  ds_read_b128 v[68:71], v8 offset:27648
  v_exp_f32 v83, v183
  v_add_f32 v85, v85, v82
  v_exp_f32 v80, v184
  v_add_f32 v85, v85, v83
  v_mfma_f32_32x32x16_bf16 v[240:255], v[24:27], v[144:147], v[240:255]
  ds_read_b128 v[72:75], v8 offset:31744
  v_cvt_pk_bf16_f32 v155, v82, v83
  v_exp_f32 v81, v185
  v_add_f32 v85, v85, v80
  v_exp_f32 v82, v186
  s_waitcnt lgkmcnt(8)
  v_mfma_f32_32x32x16_bf16 v[192:207], v[28:31], v[148:151], v[192:207]
  v_add_f32 v85, v85, v81
  v_cvt_pk_bf16_f32 v156, v80, v81
  v_exp_f32 v83, v187
  v_add_f32 v85, v85, v82
  v_mfma_f32_32x32x16_bf16 v[208:223], v[32:35], v[148:151], v[208:223]
  v_exp_f32 v80, v188
  v_add_f32 v85, v85, v83
  v_cvt_pk_bf16_f32 v157, v82, v83
  v_exp_f32 v81, v189
  v_mfma_f32_32x32x16_bf16 v[224:239], v[36:39], v[148:151], v[224:239]
  v_add_f32 v85, v85, v80
  v_exp_f32 v82, v190
  v_add_f32 v85, v85, v81
  v_cvt_pk_bf16_f32 v158, v80, v81
  v_mfma_f32_32x32x16_bf16 v[240:255], v[40:43], v[148:151], v[240:255]
  v_exp_f32 v83, v191
  v_add_f32 v85, v85, v82
  v_add_f32 v85, v85, v83
  v_cvt_pk_bf16_f32 v159, v82, v83
  v_cmp_lt_f32 vcc, s60, v85
  s_nop 1
  s_cbranch_vccnz sequential_preLN__compressed_kv_cla__dense_activation_squared_relu__prompt_kernel_chk1_finB
sequential_preLN__compressed_kv_cla__dense_activation_squared_relu__prompt_kernel_chk1_finB_ret:
  v_add_f32 v86, v86, v85
  v_mov_b32 v90, v86
  s_lshl_b32 s31, s54, 5
  s_add_u32 s31, s31, s28
  v_permlane32_swap_b32 v86, v90
  s_lshl_b32 s31, s31, 13
  s_add_u32 s31, s31, 0x2400000
  v_add_f32 v86, v86, v90
  v_rcp_f32 v86, v86
  s_add_u32 s32, s31, 4096
  s_waitcnt lgkmcnt(0)
  v_mfma_f32_32x32x16_bf16 v[192:207], v[44:47], v[152:155], v[192:207]
  s_nop 3
  v_mfma_f32_32x32x16_bf16 v[192:207], v[48:51], v[156:159], v[192:207]
  s_nop 3
  v_mfma_f32_32x32x16_bf16 v[208:223], v[52:55], v[152:155], v[208:223]
  s_nop 3
  v_mfma_f32_32x32x16_bf16 v[208:223], v[56:59], v[156:159], v[208:223]
  s_nop 3
  v_mfma_f32_32x32x16_bf16 v[224:239], v[60:63], v[152:155], v[224:239]
  v_mul_f32 v192, v192, v86
  v_mul_f32 v193, v193, v86
  v_mul_f32 v194, v194, v86
  v_mul_f32 v195, v195, v86
  v_mul_f32 v196, v196, v86
  v_mul_f32 v197, v197, v86
  v_mul_f32 v198, v198, v86
  v_mul_f32 v199, v199, v86
  v_cvt_pk_bf16_f32 v192, v192, v193
  v_cvt_pk_bf16_f32 v193, v194, v195
  v_cvt_pk_bf16_f32 v194, v196, v197
  v_cvt_pk_bf16_f32 v195, v198, v199
  buffer_store_dwordx4 v[192:195], v2, s[24:27], s31 offen offset:0 sc1
  v_mfma_f32_32x32x16_bf16 v[224:239], v[64:67], v[156:159], v[224:239]
  v_mul_f32 v200, v200, v86
  v_mul_f32 v201, v201, v86
  v_mul_f32 v202, v202, v86
  v_mul_f32 v203, v203, v86
  v_mul_f32 v204, v204, v86
  v_mul_f32 v205, v205, v86
  v_mul_f32 v206, v206, v86
  v_mul_f32 v207, v207, v86
  v_cvt_pk_bf16_f32 v200, v200, v201
  v_cvt_pk_bf16_f32 v201, v202, v203
  v_cvt_pk_bf16_f32 v202, v204, v205
  v_cvt_pk_bf16_f32 v203, v206, v207
  buffer_store_dwordx4 v[200:203], v2, s[24:27], s31 offen offset:1024 sc1
  v_mfma_f32_32x32x16_bf16 v[240:255], v[68:71], v[152:155], v[240:255]
  v_mul_f32 v208, v208, v86
  v_mul_f32 v209, v209, v86
  v_mul_f32 v210, v210, v86
  v_mul_f32 v211, v211, v86
  v_mul_f32 v212, v212, v86
  v_mul_f32 v213, v213, v86
  v_mul_f32 v214, v214, v86
  v_mul_f32 v215, v215, v86
  v_cvt_pk_bf16_f32 v208, v208, v209
  v_cvt_pk_bf16_f32 v209, v210, v211
  v_cvt_pk_bf16_f32 v210, v212, v213
  v_cvt_pk_bf16_f32 v211, v214, v215
  buffer_store_dwordx4 v[208:211], v2, s[24:27], s31 offen offset:2048 sc1
  v_mfma_f32_32x32x16_bf16 v[240:255], v[72:75], v[156:159], v[240:255]
  v_mul_f32 v216, v216, v86
  v_mul_f32 v217, v217, v86
  v_mul_f32 v218, v218, v86
  v_mul_f32 v219, v219, v86
  v_mul_f32 v220, v220, v86
  v_mul_f32 v221, v221, v86
  v_mul_f32 v222, v222, v86
  v_mul_f32 v223, v223, v86
  v_cvt_pk_bf16_f32 v216, v216, v217
  v_cvt_pk_bf16_f32 v217, v218, v219
  v_cvt_pk_bf16_f32 v218, v220, v221
  v_cvt_pk_bf16_f32 v219, v222, v223
  buffer_store_dwordx4 v[216:219], v2, s[24:27], s31 offen offset:3072 sc1
  s_nop 7
  s_nop 3
  v_mul_f32 v224, v224, v86
  v_mul_f32 v225, v225, v86
  v_mul_f32 v226, v226, v86
  v_mul_f32 v227, v227, v86
  v_mul_f32 v228, v228, v86
  v_mul_f32 v229, v229, v86
  v_mul_f32 v230, v230, v86
  v_mul_f32 v231, v231, v86
  v_cvt_pk_bf16_f32 v224, v224, v225
  v_cvt_pk_bf16_f32 v225, v226, v227
  v_cvt_pk_bf16_f32 v226, v228, v229
  v_cvt_pk_bf16_f32 v227, v230, v231
  buffer_store_dwordx4 v[224:227], v2, s[24:27], s32 offen offset:0 sc1
  v_mul_f32 v232, v232, v86
  v_mul_f32 v233, v233, v86
  v_mul_f32 v234, v234, v86
  v_mul_f32 v235, v235, v86
  v_mul_f32 v236, v236, v86
  v_mul_f32 v237, v237, v86
  v_mul_f32 v238, v238, v86
  v_mul_f32 v239, v239, v86
  v_cvt_pk_bf16_f32 v232, v232, v233
  v_cvt_pk_bf16_f32 v233, v234, v235
  v_cvt_pk_bf16_f32 v234, v236, v237
  v_cvt_pk_bf16_f32 v235, v238, v239
  buffer_store_dwordx4 v[232:235], v2, s[24:27], s32 offen offset:1024 sc1
  v_mul_f32 v240, v240, v86
  v_mul_f32 v241, v241, v86
  v_mul_f32 v242, v242, v86
  v_mul_f32 v243, v243, v86
  v_mul_f32 v244, v244, v86
  v_mul_f32 v245, v245, v86
  v_mul_f32 v246, v246, v86
  v_mul_f32 v247, v247, v86
  v_cvt_pk_bf16_f32 v240, v240, v241
  v_cvt_pk_bf16_f32 v241, v242, v243
  v_cvt_pk_bf16_f32 v242, v244, v245
  v_cvt_pk_bf16_f32 v243, v246, v247
  buffer_store_dwordx4 v[240:243], v2, s[24:27], s32 offen offset:2048 sc1
  v_mul_f32 v248, v248, v86
  v_mul_f32 v249, v249, v86
  v_mul_f32 v250, v250, v86
  v_mul_f32 v251, v251, v86
  v_mul_f32 v252, v252, v86
  v_mul_f32 v253, v253, v86
  v_mul_f32 v254, v254, v86
  v_mul_f32 v255, v255, v86
  v_cvt_pk_bf16_f32 v248, v248, v249
  v_cvt_pk_bf16_f32 v249, v250, v251
  v_cvt_pk_bf16_f32 v250, v252, v253
  v_cvt_pk_bf16_f32 v251, v254, v255
  buffer_store_dwordx4 v[248:251], v2, s[24:27], s32 offen offset:3072 sc1
  s_branch Lff_28
Lfe_27:
  ds_read_b128 v[12:15], v8 offset:16384
  ds_read_b128 v[16:19], v8 offset:17408
  ds_read_b128 v[20:23], v8 offset:18432
  ds_read_b128 v[24:27], v8 offset:19456
  ds_read_b128 v[28:31], v8 offset:20480
  ds_read_b128 v[32:35], v8 offset:21504
  ds_read_b128 v[36:39], v8 offset:22528
  ds_read_b128 v[40:43], v8 offset:23552
  ds_read_b128 v[44:47], v8 offset:24576
  ds_read_b128 v[48:51], v8 offset:28672
  ds_read_b128 v[52:55], v8 offset:25600
  ds_read_b128 v[56:59], v8 offset:29696
  v_add_f32 v86, v86, v84
  s_waitcnt lgkmcnt(8)
  v_mfma_f32_32x32x16_bf16 v[192:207], v[12:15], v[144:147], v[192:207]
  ds_read_b128 v[60:63], v8 offset:26624
  v_mfma_f32_32x32x16_bf16 v[208:223], v[16:19], v[144:147], v[208:223]
  ds_read_b128 v[64:67], v8 offset:30720
  v_mfma_f32_32x32x16_bf16 v[224:239], v[20:23], v[144:147], v[224:239]
  ds_read_b128 v[68:71], v8 offset:27648
  v_mfma_f32_32x32x16_bf16 v[240:255], v[24:27], v[144:147], v[240:255]
  ds_read_b128 v[72:75], v8 offset:31744
  s_waitcnt lgkmcnt(8)
  v_mfma_f32_32x32x16_bf16 v[192:207], v[28:31], v[148:151], v[192:207]
  v_mfma_f32_32x32x16_bf16 v[208:223], v[32:35], v[148:151], v[208:223]
  v_mfma_f32_32x32x16_bf16 v[224:239], v[36:39], v[148:151], v[224:239]
  v_mfma_f32_32x32x16_bf16 v[240:255], v[40:43], v[148:151], v[240:255]
  v_mov_b32 v90, v86
  s_lshl_b32 s31, s54, 5
  s_add_u32 s31, s31, s28
  v_permlane32_swap_b32 v86, v90
  s_lshl_b32 s31, s31, 13
  s_add_u32 s31, s31, 0x2400000
  v_add_f32 v86, v86, v90
  v_rcp_f32 v86, v86
  s_add_u32 s32, s31, 4096
  s_waitcnt lgkmcnt(0)
  s_nop 7
  v_mul_f32 v192, v192, v86
  v_mul_f32 v193, v193, v86
  v_mul_f32 v194, v194, v86
  v_mul_f32 v195, v195, v86
  v_mul_f32 v196, v196, v86
  v_mul_f32 v197, v197, v86
  v_mul_f32 v198, v198, v86
  v_mul_f32 v199, v199, v86
  v_cvt_pk_bf16_f32 v192, v192, v193
  v_cvt_pk_bf16_f32 v193, v194, v195
  v_cvt_pk_bf16_f32 v194, v196, v197
  v_cvt_pk_bf16_f32 v195, v198, v199
  buffer_store_dwordx4 v[192:195], v2, s[24:27], s31 offen offset:0 sc1
  v_mul_f32 v200, v200, v86
  v_mul_f32 v201, v201, v86
  v_mul_f32 v202, v202, v86
  v_mul_f32 v203, v203, v86
  v_mul_f32 v204, v204, v86
  v_mul_f32 v205, v205, v86
  v_mul_f32 v206, v206, v86
  v_mul_f32 v207, v207, v86
  v_cvt_pk_bf16_f32 v200, v200, v201
  v_cvt_pk_bf16_f32 v201, v202, v203
  v_cvt_pk_bf16_f32 v202, v204, v205
  v_cvt_pk_bf16_f32 v203, v206, v207
  buffer_store_dwordx4 v[200:203], v2, s[24:27], s31 offen offset:1024 sc1
  v_mul_f32 v208, v208, v86
  v_mul_f32 v209, v209, v86
  v_mul_f32 v210, v210, v86
  v_mul_f32 v211, v211, v86
  v_mul_f32 v212, v212, v86
  v_mul_f32 v213, v213, v86
  v_mul_f32 v214, v214, v86
  v_mul_f32 v215, v215, v86
  v_cvt_pk_bf16_f32 v208, v208, v209
  v_cvt_pk_bf16_f32 v209, v210, v211
  v_cvt_pk_bf16_f32 v210, v212, v213
  v_cvt_pk_bf16_f32 v211, v214, v215
  buffer_store_dwordx4 v[208:211], v2, s[24:27], s31 offen offset:2048 sc1
  v_mul_f32 v216, v216, v86
  v_mul_f32 v217, v217, v86
  v_mul_f32 v218, v218, v86
  v_mul_f32 v219, v219, v86
  v_mul_f32 v220, v220, v86
  v_mul_f32 v221, v221, v86
  v_mul_f32 v222, v222, v86
  v_mul_f32 v223, v223, v86
  v_cvt_pk_bf16_f32 v216, v216, v217
  v_cvt_pk_bf16_f32 v217, v218, v219
  v_cvt_pk_bf16_f32 v218, v220, v221
  v_cvt_pk_bf16_f32 v219, v222, v223
  buffer_store_dwordx4 v[216:219], v2, s[24:27], s31 offen offset:3072 sc1
  v_mul_f32 v224, v224, v86
  v_mul_f32 v225, v225, v86
  v_mul_f32 v226, v226, v86
  v_mul_f32 v227, v227, v86
  v_mul_f32 v228, v228, v86
  v_mul_f32 v229, v229, v86
  v_mul_f32 v230, v230, v86
  v_mul_f32 v231, v231, v86
  v_cvt_pk_bf16_f32 v224, v224, v225
  v_cvt_pk_bf16_f32 v225, v226, v227
  v_cvt_pk_bf16_f32 v226, v228, v229
  v_cvt_pk_bf16_f32 v227, v230, v231
  buffer_store_dwordx4 v[224:227], v2, s[24:27], s32 offen offset:0 sc1
  v_mul_f32 v232, v232, v86
  v_mul_f32 v233, v233, v86
  v_mul_f32 v234, v234, v86
  v_mul_f32 v235, v235, v86
  v_mul_f32 v236, v236, v86
  v_mul_f32 v237, v237, v86
  v_mul_f32 v238, v238, v86
  v_mul_f32 v239, v239, v86
  v_cvt_pk_bf16_f32 v232, v232, v233
  v_cvt_pk_bf16_f32 v233, v234, v235
  v_cvt_pk_bf16_f32 v234, v236, v237
  v_cvt_pk_bf16_f32 v235, v238, v239
  buffer_store_dwordx4 v[232:235], v2, s[24:27], s32 offen offset:1024 sc1
  v_mul_f32 v240, v240, v86
  v_mul_f32 v241, v241, v86
  v_mul_f32 v242, v242, v86
  v_mul_f32 v243, v243, v86
  v_mul_f32 v244, v244, v86
  v_mul_f32 v245, v245, v86
  v_mul_f32 v246, v246, v86
  v_mul_f32 v247, v247, v86
  v_cvt_pk_bf16_f32 v240, v240, v241
  v_cvt_pk_bf16_f32 v241, v242, v243
  v_cvt_pk_bf16_f32 v242, v244, v245
  v_cvt_pk_bf16_f32 v243, v246, v247
  buffer_store_dwordx4 v[240:243], v2, s[24:27], s32 offen offset:2048 sc1
  v_mul_f32 v248, v248, v86
  v_mul_f32 v249, v249, v86
  v_mul_f32 v250, v250, v86
  v_mul_f32 v251, v251, v86
  v_mul_f32 v252, v252, v86
  v_mul_f32 v253, v253, v86
  v_mul_f32 v254, v254, v86
  v_mul_f32 v255, v255, v86
  v_cvt_pk_bf16_f32 v248, v248, v249
  v_cvt_pk_bf16_f32 v249, v250, v251
  v_cvt_pk_bf16_f32 v250, v252, v253
  v_cvt_pk_bf16_f32 v251, v254, v255
  buffer_store_dwordx4 v[248:251], v2, s[24:27], s32 offen offset:3072 sc1
Lff_28:
  s_waitcnt vmcnt(0)
  s_branch sequential_preLN__compressed_kv_cla__dense_activation_squared_relu__prompt_kernel_ta
sequential_preLN__compressed_kv_cla__dense_activation_squared_relu__prompt_kernel_roleA:
  ds_read_b128 v[12:15], v9 offset:0
  ds_read_b128 v[16:19], v9 offset:1024
  ds_read_b128 v[20:23], v9 offset:2048
  ds_read_b128 v[24:27], v9 offset:3072
  ds_read_b128 v[28:31], v9 offset:4096
  ds_read_b128 v[32:35], v9 offset:5120
  ds_read_b128 v[36:39], v9 offset:6144
  ds_read_b128 v[40:43], v9 offset:7168
  ds_read_b128 v[44:47], v9 offset:8192
  ds_read_b128 v[48:51], v9 offset:9216
  ds_read_b128 v[52:55], v9 offset:10240
  ds_read_b128 v[56:59], v9 offset:11264
  s_waitcnt lgkmcnt(8)
  v_mfma_f32_32x32x16_bf16 v[160:175], v[12:15], v[96:99], 0
  ds_read_b128 v[60:63], v9 offset:12288
  v_mov_b32 v192, 0
  v_mov_b32 v193, 0
  v_mov_b32 v194, 0
  v_mov_b32 v195, 0
  v_mov_b32 v196, 0
  v_mfma_f32_32x32x16_bf16 v[160:175], v[16:19], v[100:103], v[160:175]
  ds_read_b128 v[64:67], v9 offset:13312
  v_mov_b32 v197, 0
  v_mov_b32 v198, 0
  v_mov_b32 v199, 0
  v_mov_b32 v200, 0
  v_mov_b32 v201, 0
  v_mfma_f32_32x32x16_bf16 v[160:175], v[20:23], v[104:107], v[160:175]
  ds_read_b128 v[68:71], v9 offset:14336
  v_mov_b32 v202, 0
  v_mov_b32 v203, 0
  v_mov_b32 v204, 0
  v_mov_b32 v205, 0
  v_mov_b32 v206, 0
  v_mfma_f32_32x32x16_bf16 v[160:175], v[24:27], v[108:111], v[160:175]
  ds_read_b128 v[72:75], v9 offset:15360
  v_mov_b32 v207, 0
  v_mov_b32 v208, 0
  v_mov_b32 v209, 0
  v_mov_b32 v210, 0
  v_mov_b32 v211, 0
  s_waitcnt lgkmcnt(8)
  v_mfma_f32_32x32x16_bf16 v[160:175], v[28:31], v[112:115], v[160:175]
  v_mov_b32 v212, 0
  v_mov_b32 v213, 0
  v_mov_b32 v214, 0
  v_mov_b32 v215, 0
  v_mov_b32 v216, 0
  v_mfma_f32_32x32x16_bf16 v[160:175], v[32:35], v[116:119], v[160:175]
  v_mov_b32 v217, 0
  v_mov_b32 v218, 0
  v_mov_b32 v219, 0
  v_mov_b32 v220, 0
  v_mov_b32 v221, 0
  v_mfma_f32_32x32x16_bf16 v[160:175], v[36:39], v[120:123], v[160:175]
  v_mov_b32 v222, 0
  v_mov_b32 v223, 0
  v_mov_b32 v224, 0
  v_mov_b32 v225, 0
  v_mov_b32 v226, 0
  v_mfma_f32_32x32x16_bf16 v[160:175], v[40:43], v[124:127], v[160:175]
  v_mov_b32 v227, 0
  v_mov_b32 v228, 0
  v_mov_b32 v229, 0
  v_mov_b32 v230, 0
  v_mov_b32 v231, 0
  v_mov_b32 v232, 0
  v_mov_b32 v233, 0
  v_mov_b32 v234, 0
  v_mov_b32 v235, 0
  v_mov_b32 v236, 0
  v_mov_b32 v237, 0
  v_mov_b32 v238, 0
  v_mov_b32 v239, 0
  v_mov_b32 v240, 0
  v_mov_b32 v241, 0
  v_mov_b32 v242, 0
  v_mov_b32 v243, 0
  v_mov_b32 v244, 0
  v_mov_b32 v245, 0
  v_mov_b32 v246, 0
  v_mov_b32 v247, 0
  v_mov_b32 v248, 0
  v_mov_b32 v249, 0
  v_mov_b32 v250, 0
  v_mov_b32 v251, 0
  v_mov_b32 v252, 0
  v_mov_b32 v253, 0
  v_mov_b32 v254, 0
  v_mov_b32 v255, 0
  s_cmp_lg_u32 s45, 1
  s_cbranch_scc1 Lpm_29
  s_mov_b32 s47, -1
  s_add_u32 s56, s47, 1
  s_lshl_b32 s56, s56, 6
  s_add_u32 s56, s56, 0
  v_subrev_u32 v87, s56, v3
  v_cmp_le_i32 s[8:9], 0, v87
  v_cmp_le_i32 s[10:11], 1, v87
  v_cmp_le_i32 s[12:13], 2, v87
  v_cmp_le_i32 s[14:15], 3, v87
  s_nop 1
  v_cndmask_b32 v160, v88, v160, s[8:9]
  v_cndmask_b32 v161, v88, v161, s[10:11]
  v_cndmask_b32 v162, v88, v162, s[12:13]
  v_cndmask_b32 v163, v88, v163, s[14:15]
  v_cmp_le_i32 s[8:9], 16, v87
  v_cmp_le_i32 s[10:11], 17, v87
  v_cmp_le_i32 s[12:13], 18, v87
  v_cmp_le_i32 s[14:15], 19, v87
  s_nop 1
  v_cndmask_b32 v164, v88, v164, s[8:9]
  v_cndmask_b32 v165, v88, v165, s[10:11]
  v_cndmask_b32 v166, v88, v166, s[12:13]
  v_cndmask_b32 v167, v88, v167, s[14:15]
  v_cmp_le_i32 s[8:9], 8, v87
  v_cmp_le_i32 s[10:11], 9, v87
  v_cmp_le_i32 s[12:13], 10, v87
  v_cmp_le_i32 s[14:15], 11, v87
  s_nop 1
  v_cndmask_b32 v168, v88, v168, s[8:9]
  v_cndmask_b32 v169, v88, v169, s[10:11]
  v_cndmask_b32 v170, v88, v170, s[12:13]
  v_cndmask_b32 v171, v88, v171, s[14:15]
  v_cmp_le_i32 s[8:9], 24, v87
  v_cmp_le_i32 s[10:11], 25, v87
  v_cmp_le_i32 s[12:13], 26, v87
  v_cmp_le_i32 s[14:15], 27, v87
  s_nop 1
  v_cndmask_b32 v172, v88, v172, s[8:9]
  v_cndmask_b32 v173, v88, v173, s[10:11]
  v_cndmask_b32 v174, v88, v174, s[12:13]
  v_cndmask_b32 v175, v88, v175, s[14:15]
Lpm_29:
  v_max3_f32 v89, v160, v161, v162
  v_max3_f32 v89, v89, v163, v164
  v_max3_f32 v89, v89, v165, v166
  v_max3_f32 v89, v89, v167, v168
  v_max3_f32 v89, v89, v169, v170
  v_max3_f32 v89, v89, v171, v172
  v_max3_f32 v89, v89, v173, v174
  v_max_f32 v89, v89, v175
  v_mov_b32 v90, v89
  s_nop 1
  v_permlane32_swap_b32 v89, v90
  s_nop 1
  v_max_f32 v89, v89, v90
  v_sub_f32 v128, 0, v89
  v_sub_f32 v129, 0, v89
  v_sub_f32 v130, 0, v89
  v_sub_f32 v131, 0, v89
  v_sub_f32 v132, 0, v89
  v_sub_f32 v133, 0, v89
  v_sub_f32 v134, 0, v89
  v_sub_f32 v135, 0, v89
  v_sub_f32 v136, 0, v89
  v_sub_f32 v137, 0, v89
  v_sub_f32 v138, 0, v89
  v_sub_f32 v139, 0, v89
  v_sub_f32 v140, 0, v89
  v_sub_f32 v141, 0, v89
  v_sub_f32 v142, 0, v89
  v_sub_f32 v143, 0, v89
  v_sub_f32 v160, v160, v89
  v_sub_f32 v161, v161, v89
  v_sub_f32 v162, v162, v89
  v_sub_f32 v163, v163, v89
  v_sub_f32 v164, v164, v89
  v_sub_f32 v165, v165, v89
  v_sub_f32 v166, v166, v89
  v_sub_f32 v167, v167, v89
  v_sub_f32 v168, v168, v89
  v_sub_f32 v169, v169, v89
  v_sub_f32 v170, v170, v89
  v_sub_f32 v171, v171, v89
  v_sub_f32 v172, v172, v89
  v_sub_f32 v173, v173, v89
  v_sub_f32 v174, v174, v89
  v_sub_f32 v175, v175, v89
  s_waitcnt lgkmcnt(0)
  v_mfma_f32_32x32x16_bf16 v[176:191], v[44:47], v[96:99], v[128:143]
  v_exp_f32 v80, v160
  v_exp_f32 v81, v161
  v_exp_f32 v82, v162
  v_add_f32 v84, v80, v81
  v_cvt_pk_bf16_f32 v144, v80, v81
  v_mfma_f32_32x32x16_bf16 v[176:191], v[48:51], v[100:103], v[176:191]
  v_exp_f32 v83, v163
  v_add_f32 v84, v84, v82
  v_exp_f32 v80, v164
  v_add_f32 v84, v84, v83
  v_cvt_pk_bf16_f32 v145, v82, v83
  v_mfma_f32_32x32x16_bf16 v[176:191], v[52:55], v[104:107], v[176:191]
  v_exp_f32 v81, v165
  v_add_f32 v84, v84, v80
  v_exp_f32 v82, v166
  v_add_f32 v84, v84, v81
  v_cvt_pk_bf16_f32 v146, v80, v81
  v_mfma_f32_32x32x16_bf16 v[176:191], v[56:59], v[108:111], v[176:191]
  v_exp_f32 v83, v167
  v_add_f32 v84, v84, v82
  v_exp_f32 v80, v168
  v_add_f32 v84, v84, v83
  v_cvt_pk_bf16_f32 v147, v82, v83
  v_mfma_f32_32x32x16_bf16 v[176:191], v[60:63], v[112:115], v[176:191]
  v_exp_f32 v81, v169
  v_add_f32 v84, v84, v80
  v_exp_f32 v82, v170
  v_add_f32 v84, v84, v81
  v_cvt_pk_bf16_f32 v148, v80, v81
  v_mfma_f32_32x32x16_bf16 v[176:191], v[64:67], v[116:119], v[176:191]
  v_exp_f32 v83, v171
  v_add_f32 v84, v84, v82
  v_exp_f32 v80, v172
  v_add_f32 v84, v84, v83
  v_cvt_pk_bf16_f32 v149, v82, v83
  v_mfma_f32_32x32x16_bf16 v[176:191], v[68:71], v[120:123], v[176:191]
  v_exp_f32 v81, v173
  v_add_f32 v84, v84, v80
  v_exp_f32 v82, v174
  v_add_f32 v84, v84, v81
  v_cvt_pk_bf16_f32 v150, v80, v81
  v_mfma_f32_32x32x16_bf16 v[176:191], v[72:75], v[124:127], v[176:191]
  v_exp_f32 v83, v175
  v_add_f32 v84, v84, v82
  v_add_f32 v84, v84, v83
  v_cvt_pk_bf16_f32 v151, v82, v83
  ds_read_b128 v[12:15], v8 offset:0
  ds_read_b128 v[16:19], v8 offset:1024
  ds_read_b128 v[20:23], v8 offset:2048
  ds_read_b128 v[24:27], v8 offset:3072
  ds_read_b128 v[28:31], v8 offset:4096
  ds_read_b128 v[32:35], v8 offset:5120
  ds_read_b128 v[36:39], v8 offset:6144
  ds_read_b128 v[40:43], v8 offset:7168
  ds_read_b128 v[44:47], v8 offset:16384
  ds_read_b128 v[48:51], v8 offset:17408
  ds_read_b128 v[52:55], v8 offset:18432
  ds_read_b128 v[56:59], v8 offset:19456
  s_cmp_lg_u32 s45, 1
  s_cbranch_scc1 Lpm_30
  s_add_u32 s56, s47, 1
  s_lshl_b32 s56, s56, 6
  s_add_u32 s56, s56, 32
  v_subrev_u32 v87, s56, v3
  v_cmp_le_i32 s[8:9], 0, v87
  v_cmp_le_i32 s[10:11], 1, v87
  v_cmp_le_i32 s[12:13], 2, v87
  v_cmp_le_i32 s[14:15], 3, v87
  s_nop 1
  v_cndmask_b32 v176, v88, v176, s[8:9]
  v_cndmask_b32 v177, v88, v177, s[10:11]
  v_cndmask_b32 v178, v88, v178, s[12:13]
  v_cndmask_b32 v179, v88, v179, s[14:15]
  v_cmp_le_i32 s[8:9], 16, v87
  v_cmp_le_i32 s[10:11], 17, v87
  v_cmp_le_i32 s[12:13], 18, v87
  v_cmp_le_i32 s[14:15], 19, v87
  s_nop 1
  v_cndmask_b32 v180, v88, v180, s[8:9]
  v_cndmask_b32 v181, v88, v181, s[10:11]
  v_cndmask_b32 v182, v88, v182, s[12:13]
  v_cndmask_b32 v183, v88, v183, s[14:15]
  v_cmp_le_i32 s[8:9], 8, v87
  v_cmp_le_i32 s[10:11], 9, v87
  v_cmp_le_i32 s[12:13], 10, v87
  v_cmp_le_i32 s[14:15], 11, v87
  s_nop 1
  v_cndmask_b32 v184, v88, v184, s[8:9]
  v_cndmask_b32 v185, v88, v185, s[10:11]
  v_cndmask_b32 v186, v88, v186, s[12:13]
  v_cndmask_b32 v187, v88, v187, s[14:15]
  v_cmp_le_i32 s[8:9], 24, v87
  v_cmp_le_i32 s[10:11], 25, v87
  v_cmp_le_i32 s[12:13], 26, v87
  v_cmp_le_i32 s[14:15], 27, v87
  s_nop 1
  v_cndmask_b32 v188, v88, v188, s[8:9]
  v_cndmask_b32 v189, v88, v189, s[10:11]
  v_cndmask_b32 v190, v88, v190, s[12:13]
  v_cndmask_b32 v191, v88, v191, s[14:15]
Lpm_30:
  v_exp_f32 v80, v176
  v_exp_f32 v81, v177
  v_exp_f32 v82, v178
  v_add_f32 v85, v80, v81
  v_cvt_pk_bf16_f32 v152, v80, v81
  v_exp_f32 v83, v179
  v_add_f32 v85, v85, v82
  s_nop 0
  s_waitcnt lgkmcnt(0)
  s_cmp_lt_u32 s45, 2
  s_cbranch_scc1 Lend_32
  s_cmp_lt_u32 s45, 3
  s_cbranch_scc1 Lsk_31
  s_sub_u32 s66, s45, 3
.p2align 3
sequential_preLN__compressed_kv_cla__dense_activation_squared_relu__prompt_kernel_loopA:
  v_mfma_f32_32x32x16_bf16 v[160:175], v[12:15], v[96:99], v[128:143]
  ds_read_b128 v[60:63], v8 offset:20480
  v_exp_f32 v80, v180
  v_add_f32 v85, v85, v83
  v_cvt_pk_bf16_f32 v153, v82, v83
  v_mfma_f32_32x32x16_bf16 v[160:175], v[16:19], v[100:103], v[160:175]
  ds_read_b128 v[64:67], v8 offset:21504
  v_exp_f32 v81, v181
  v_add_f32 v85, v85, v80
  s_waitcnt lgkmcnt(4)
  v_mfma_f32_32x32x16_bf16 v[160:175], v[20:23], v[104:107], v[160:175]
  ds_read_b128 v[68:71], v8 offset:22528
  v_exp_f32 v82, v182
  v_add_f32 v85, v85, v81
  v_cvt_pk_bf16_f32 v154, v80, v81
  v_mfma_f32_32x32x16_bf16 v[160:175], v[24:27], v[108:111], v[160:175]
  ds_read_b128 v[72:75], v8 offset:23552
  v_exp_f32 v83, v183
  v_add_f32 v85, v85, v82
  v_add_f32 v86, v86, v84
  v_mfma_f32_32x32x16_bf16 v[160:175], v[28:31], v[112:115], v[160:175]
  ds_read_b128 v[12:15], v8 offset:8192
  v_exp_f32 v80, v184
  v_add_f32 v85, v85, v83
  v_cvt_pk_bf16_f32 v155, v82, v83
  v_mfma_f32_32x32x16_bf16 v[160:175], v[32:35], v[116:119], v[160:175]
  ds_read_b128 v[16:19], v8 offset:9216
  v_exp_f32 v81, v185
  v_add_f32 v85, v85, v80
  s_add_u32 s48, s48, 32768
  v_mfma_f32_32x32x16_bf16 v[160:175], v[36:39], v[120:123], v[160:175]
  ds_read_b128 v[20:23], v8 offset:10240
  v_exp_f32 v82, v186
  v_add_f32 v85, v85, v81
  v_cvt_pk_bf16_f32 v156, v80, v81
  v_mfma_f32_32x32x16_bf16 v[160:175], v[40:43], v[124:127], v[160:175]
  ds_read_b128 v[24:27], v8 offset:11264
  v_exp_f32 v83, v187
  v_add_f32 v85, v85, v82
  s_and_b32 s48, s48, 131071
  v_mfma_f32_32x32x16_bf16 v[192:207], v[44:47], v[144:147], v[192:207]
  ds_read_b128 v[28:31], v8 offset:12288
  v_exp_f32 v80, v188
  v_add_f32 v85, v85, v83
  v_cvt_pk_bf16_f32 v157, v82, v83
  v_mfma_f32_32x32x16_bf16 v[208:223], v[48:51], v[144:147], v[208:223]
  ds_read_b128 v[32:35], v8 offset:13312
  v_exp_f32 v81, v189
  v_add_f32 v85, v85, v80
  s_waitcnt lgkmcnt(4)
  v_mfma_f32_32x32x16_bf16 v[224:239], v[52:55], v[144:147], v[224:239]
  ds_read_b128 v[36:39], v8 offset:14336
  v_exp_f32 v82, v190
  v_add_f32 v85, v85, v81
  v_cvt_pk_bf16_f32 v158, v80, v81
  v_mfma_f32_32x32x16_bf16 v[240:255], v[56:59], v[144:147], v[240:255]
  ds_read_b128 v[40:43], v8 offset:15360
  v_exp_f32 v83, v191
  v_add_f32 v85, v85, v82
  v_mfma_f32_32x32x16_bf16 v[192:207], v[60:63], v[148:151], v[192:207]
  ds_read_b128 v[44:47], v8 offset:24576
  v_exp_f32 v80, v160
  v_add_f32 v85, v85, v83
  v_cvt_pk_bf16_f32 v159, v82, v83
  v_mfma_f32_32x32x16_bf16 v[208:223], v[64:67], v[148:151], v[208:223]
  ds_read_b128 v[48:51], v8 offset:25600
  v_exp_f32 v81, v161
  v_cmp_lt_f32 vcc, s60, v85
  s_waitcnt vmcnt(8)
  s_barrier
  v_mfma_f32_32x32x16_bf16 v[224:239], v[68:71], v[148:151], v[224:239]
  ds_read_b128 v[52:55], v8 offset:26624
  v_exp_f32 v82, v162
  v_add_f32 v84, v80, v81
  v_cvt_pk_bf16_f32 v144, v80, v81
  s_lshl_b32 s31, s50, 14
  s_add_u32 s31, s31, s64
  s_add_u32 s51, s31, 0x4000
  s_add_u32 s52, s31, 0x1200000
  s_cmp_lt_u32 s50, s46
  v_mfma_f32_32x32x16_bf16 v[240:255], v[72:75], v[148:151], v[240:255]
  ds_read_b128 v[56:59], v8 offset:27648
  v_exp_f32 v83, v163
  v_add_f32 v84, v84, v82
  s_cbranch_vccnz sequential_preLN__compressed_kv_cla__dense_activation_squared_relu__prompt_kernel_chk1_A
sequential_preLN__compressed_kv_cla__dense_activation_squared_relu__prompt_kernel_chk1_A_ret:
  v_mfma_f32_32x32x16_bf16 v[176:191], v[12:15], v[96:99], v[128:143]
  ds_read_b128 v[60:63], v8 offset:28672
  v_exp_f32 v80, v164
  v_add_f32 v84, v84, v83
  v_cvt_pk_bf16_f32 v145, v82, v83
  s_cselect_b32 s51, s51, s61
  s_cselect_b32 s52, s52, s61
  s_lshl_b32 s58, s53, 12
  s_add_u32 s58, s58, s59
  v_mfma_f32_32x32x16_bf16 v[176:191], v[16:19], v[100:103], v[176:191]
  ds_read_b128 v[64:67], v8 offset:29696
  v_exp_f32 v81, v165
  v_add_f32 v84, v84, v80
  s_waitcnt lgkmcnt(4)
  v_mfma_f32_32x32x16_bf16 v[176:191], v[20:23], v[104:107], v[176:191]
  ds_read_b128 v[68:71], v8 offset:30720
  v_exp_f32 v82, v166
  v_add_f32 v84, v84, v81
  v_cvt_pk_bf16_f32 v146, v80, v81
  s_add_u32 m0, s58, 0
  s_nop 0
  buffer_load_dwordx4 v2, s[24:27], s51 offen offset:0 sc1 lds
  v_mfma_f32_32x32x16_bf16 v[176:191], v[24:27], v[108:111], v[176:191]
  ds_read_b128 v[72:75], v8 offset:31744
  v_exp_f32 v83, v167
  v_add_f32 v84, v84, v82
  v_add_u32 v8, s48, v2
  v_mfma_f32_32x32x16_bf16 v[176:191], v[28:31], v[112:115], v[176:191]
  ds_read_b128 v[12:15], v8 offset:0
  v_exp_f32 v80, v168
  v_add_f32 v84, v84, v83
  v_cvt_pk_bf16_f32 v147, v82, v83
  buffer_load_dwordx4 v2, s[24:27], s51 offen offset:1024 sc1 lds
  v_mfma_f32_32x32x16_bf16 v[176:191], v[32:35], v[116:119], v[176:191]
  ds_read_b128 v[16:19], v8 offset:1024
  v_exp_f32 v81, v169
  v_add_f32 v84, v84, v80
  v_add_f32 v86, v86, v85
  v_mfma_f32_32x32x16_bf16 v[176:191], v[36:39], v[120:123], v[176:191]
  ds_read_b128 v[20:23], v8 offset:2048
  v_exp_f32 v82, v170
  v_add_f32 v84, v84, v81
  v_cvt_pk_bf16_f32 v148, v80, v81
  buffer_load_dwordx4 v2, s[24:27], s51 offen offset:2048 sc1 lds
  v_mfma_f32_32x32x16_bf16 v[176:191], v[40:43], v[124:127], v[176:191]
  ds_read_b128 v[24:27], v8 offset:3072
  v_exp_f32 v83, v171
  v_add_f32 v84, v84, v82
  buffer_load_dwordx4 v2, s[24:27], s51 offen offset:3072 sc1 lds
  v_mfma_f32_32x32x16_bf16 v[192:207], v[44:47], v[152:155], v[192:207]
  ds_read_b128 v[28:31], v8 offset:4096
  v_exp_f32 v80, v172
  v_add_f32 v84, v84, v83
  v_cvt_pk_bf16_f32 v149, v82, v83
  s_add_u32 m0, s58, 16384
  s_nop 0
  buffer_load_dwordx4 v2, s[24:27], s52 offen offset:0 sc1 lds
  v_mfma_f32_32x32x16_bf16 v[208:223], v[48:51], v[152:155], v[208:223]
  ds_read_b128 v[32:35], v8 offset:5120
  v_exp_f32 v81, v173
  v_add_f32 v84, v84, v80
  s_waitcnt lgkmcnt(4)
  v_mfma_f32_32x32x16_bf16 v[224:239], v[52:55], v[152:155], v[224:239]
  ds_read_b128 v[36:39], v8 offset:6144
  v_exp_f32 v82, v174
  v_add_f32 v84, v84, v81
  v_cvt_pk_bf16_f32 v150, v80, v81
  buffer_load_dwordx4 v2, s[24:27], s52 offen offset:1024 sc1 lds
  v_mfma_f32_32x32x16_bf16 v[240:255], v[56:59], v[152:155], v[240:255]
  ds_read_b128 v[40:43], v8 offset:7168
  v_exp_f32 v83, v175
  v_add_f32 v84, v84, v82
  buffer_load_dwordx4 v2, s[24:27], s52 offen offset:2048 sc1 lds
  v_mfma_f32_32x32x16_bf16 v[192:207], v[60:63], v[156:159], v[192:207]
  ds_read_b128 v[44:47], v8 offset:16384
  v_exp_f32 v80, v176
  v_add_f32 v84, v84, v83
  v_cvt_pk_bf16_f32 v151, v82, v83
  buffer_load_dwordx4 v2, s[24:27], s52 offen offset:3072 sc1 lds
  v_mfma_f32_32x32x16_bf16 v[208:223], v[64:67], v[156:159], v[208:223]
  ds_read_b128 v[48:51], v8 offset:17408
  v_exp_f32 v81, v177
  v_cmp_lt_f32 vcc, s60, v84
  s_add_u32 s50, s50, 1
  s_add_u32 s59, s59, 32768
  s_and_b32 s59, s59, 131071
  v_mfma_f32_32x32x16_bf16 v[224:239], v[68:71], v[156:159], v[224:239]
  ds_read_b128 v[52:55], v8 offset:18432
  v_exp_f32 v82, v178
  v_add_f32 v85, v80, v81
  v_cvt_pk_bf16_f32 v152, v80, v81
  v_mfma_f32_32x32x16_bf16 v[240:255], v[72:75], v[156:159], v[240:255]
  ds_read_b128 v[56:59], v8 offset:19456
  v_exp_f32 v83, v179
  v_add_f32 v85, v85, v82
  s_cbranch_vccnz sequential_preLN__compressed_kv_cla__dense_activation_squared_relu__prompt_kernel_chk0_A
sequential_preLN__compressed_kv_cla__dense_activation_squared_relu__prompt_kernel_chk0_A_ret:
  s_sub_u32 s66, s66, 1
  s_cbranch_scc0 sequential_preLN__compressed_kv_cla__dense_activation_squared_relu__prompt_kernel_loopA
Lsk_31:
  s_sub_u32 s47, s45, 2
  s_mov_b32 s66, 0
  s_bitcmp0_b32 s54, 0
  s_cbranch_scc1 Lev_33
.p2align 3
sequential_preLN__compressed_kv_cla__dense_activation_squared_relu__prompt_kernel_loopAm:
  v_mfma_f32_32x32x16_bf16 v[160:175], v[12:15], v[96:99], v[128:143]
  ds_read_b128 v[60:63], v8 offset:20480
  v_exp_f32 v80, v180
  v_add_f32 v85, v85, v83
  v_cvt_pk_bf16_f32 v153, v82, v83
  v_mfma_f32_32x32x16_bf16 v[160:175], v[16:19], v[100:103], v[160:175]
  ds_read_b128 v[64:67], v8 offset:21504
  v_exp_f32 v81, v181
  v_add_f32 v85, v85, v80
  s_waitcnt lgkmcnt(4)
  v_mfma_f32_32x32x16_bf16 v[160:175], v[20:23], v[104:107], v[160:175]
  ds_read_b128 v[68:71], v8 offset:22528
  v_exp_f32 v82, v182
  v_add_f32 v85, v85, v81
  v_cvt_pk_bf16_f32 v154, v80, v81
  v_mfma_f32_32x32x16_bf16 v[160:175], v[24:27], v[108:111], v[160:175]
  ds_read_b128 v[72:75], v8 offset:23552
  v_exp_f32 v83, v183
  v_add_f32 v85, v85, v82
  v_add_f32 v86, v86, v84
  v_mfma_f32_32x32x16_bf16 v[160:175], v[28:31], v[112:115], v[160:175]
  ds_read_b128 v[12:15], v8 offset:8192
  v_exp_f32 v80, v184
  v_add_f32 v85, v85, v83
  v_cvt_pk_bf16_f32 v155, v82, v83
  v_mfma_f32_32x32x16_bf16 v[160:175], v[32:35], v[116:119], v[160:175]
  ds_read_b128 v[16:19], v8 offset:9216
  v_exp_f32 v81, v185
  v_add_f32 v85, v85, v80
  s_add_u32 s48, s48, 32768
  v_mfma_f32_32x32x16_bf16 v[160:175], v[36:39], v[120:123], v[160:175]
  ds_read_b128 v[20:23], v8 offset:10240
  v_exp_f32 v82, v186
  v_add_f32 v85, v85, v81
  v_cvt_pk_bf16_f32 v156, v80, v81
  v_mfma_f32_32x32x16_bf16 v[160:175], v[40:43], v[124:127], v[160:175]
  ds_read_b128 v[24:27], v8 offset:11264
  v_exp_f32 v83, v187
  v_add_f32 v85, v85, v82
  s_and_b32 s48, s48, 131071
  v_mfma_f32_32x32x16_bf16 v[192:207], v[44:47], v[144:147], v[192:207]
  ds_read_b128 v[28:31], v8 offset:12288
  v_exp_f32 v80, v188
  v_add_f32 v85, v85, v83
  v_cvt_pk_bf16_f32 v157, v82, v83
  v_mfma_f32_32x32x16_bf16 v[208:223], v[48:51], v[144:147], v[208:223]
  ds_read_b128 v[32:35], v8 offset:13312
  v_exp_f32 v81, v189
  v_add_f32 v85, v85, v80
  s_waitcnt lgkmcnt(4)
  v_mfma_f32_32x32x16_bf16 v[224:239], v[52:55], v[144:147], v[224:239]
  ds_read_b128 v[36:39], v8 offset:14336
  v_exp_f32 v82, v190
  v_add_f32 v85, v85, v81
  v_cvt_pk_bf16_f32 v158, v80, v81
  v_mfma_f32_32x32x16_bf16 v[240:255], v[56:59], v[144:147], v[240:255]
  ds_read_b128 v[40:43], v8 offset:15360
  v_exp_f32 v83, v191
  v_add_f32 v85, v85, v82
  v_mfma_f32_32x32x16_bf16 v[192:207], v[60:63], v[148:151], v[192:207]
  ds_read_b128 v[44:47], v8 offset:24576
  s_add_u32 s56, s47, 1
  s_lshl_b32 s56, s56, 6
  s_add_u32 s56, s56, 0
  v_subrev_u32 v87, s56, v3
  v_cmp_le_i32 s[8:9], 0, v87
  v_cmp_le_i32 s[10:11], 1, v87
  v_cmp_le_i32 s[12:13], 2, v87
  v_cmp_le_i32 s[14:15], 3, v87
  s_nop 1
  v_cndmask_b32 v160, v88, v160, s[8:9]
  v_cndmask_b32 v161, v88, v161, s[10:11]
  v_cndmask_b32 v162, v88, v162, s[12:13]
  v_cndmask_b32 v163, v88, v163, s[14:15]
  v_cmp_le_i32 s[8:9], 16, v87
  v_cmp_le_i32 s[10:11], 17, v87
  v_cmp_le_i32 s[12:13], 18, v87
  v_cmp_le_i32 s[14:15], 19, v87
  s_nop 1
  v_cndmask_b32 v164, v88, v164, s[8:9]
  v_cndmask_b32 v165, v88, v165, s[10:11]
  v_cndmask_b32 v166, v88, v166, s[12:13]
  v_cndmask_b32 v167, v88, v167, s[14:15]
  v_cmp_le_i32 s[8:9], 8, v87
  v_cmp_le_i32 s[10:11], 9, v87
  v_cmp_le_i32 s[12:13], 10, v87
  v_cmp_le_i32 s[14:15], 11, v87
  s_nop 1
  v_cndmask_b32 v168, v88, v168, s[8:9]
  v_cndmask_b32 v169, v88, v169, s[10:11]
  v_cndmask_b32 v170, v88, v170, s[12:13]
  v_cndmask_b32 v171, v88, v171, s[14:15]
  v_cmp_le_i32 s[8:9], 24, v87
  v_cmp_le_i32 s[10:11], 25, v87
  v_cmp_le_i32 s[12:13], 26, v87
  v_cmp_le_i32 s[14:15], 27, v87
  s_nop 1
  v_cndmask_b32 v172, v88, v172, s[8:9]
  v_cndmask_b32 v173, v88, v173, s[10:11]
  v_cndmask_b32 v174, v88, v174, s[12:13]
  v_cndmask_b32 v175, v88, v175, s[14:15]
  v_exp_f32 v80, v160
  v_add_f32 v85, v85, v83
  v_cvt_pk_bf16_f32 v159, v82, v83
  v_mfma_f32_32x32x16_bf16 v[208:223], v[64:67], v[148:151], v[208:223]
  ds_read_b128 v[48:51], v8 offset:25600
  v_exp_f32 v81, v161
  v_cmp_lt_f32 vcc, s60, v85
  s_waitcnt vmcnt(8)
  s_barrier
  v_mfma_f32_32x32x16_bf16 v[224:239], v[68:71], v[148:151], v[224:239]
  ds_read_b128 v[52:55], v8 offset:26624
  v_exp_f32 v82, v162
  v_add_f32 v84, v80, v81
  v_cvt_pk_bf16_f32 v144, v80, v81
  s_lshl_b32 s31, s50, 14
  s_add_u32 s31, s31, s64
  s_add_u32 s51, s31, 0x4000
  s_add_u32 s52, s31, 0x1200000
  s_cmp_lt_u32 s50, s46
  v_mfma_f32_32x32x16_bf16 v[240:255], v[72:75], v[148:151], v[240:255]
  ds_read_b128 v[56:59], v8 offset:27648
  v_exp_f32 v83, v163
  v_add_f32 v84, v84, v82
  s_cbranch_vccnz sequential_preLN__compressed_kv_cla__dense_activation_squared_relu__prompt_kernel_chk1_Am
sequential_preLN__compressed_kv_cla__dense_activation_squared_relu__prompt_kernel_chk1_Am_ret:
  v_mfma_f32_32x32x16_bf16 v[176:191], v[12:15], v[96:99], v[128:143]
  ds_read_b128 v[60:63], v8 offset:28672
  v_exp_f32 v80, v164
  v_add_f32 v84, v84, v83
  v_cvt_pk_bf16_f32 v145, v82, v83
  s_cselect_b32 s51, s51, s61
  s_cselect_b32 s52, s52, s61
  s_lshl_b32 s58, s53, 12
  s_add_u32 s58, s58, s59
  v_mfma_f32_32x32x16_bf16 v[176:191], v[16:19], v[100:103], v[176:191]
  ds_read_b128 v[64:67], v8 offset:29696
  v_exp_f32 v81, v165
  v_add_f32 v84, v84, v80
  s_waitcnt lgkmcnt(4)
  v_mfma_f32_32x32x16_bf16 v[176:191], v[20:23], v[104:107], v[176:191]
  ds_read_b128 v[68:71], v8 offset:30720
  v_exp_f32 v82, v166
  v_add_f32 v84, v84, v81
  v_cvt_pk_bf16_f32 v146, v80, v81
  s_add_u32 m0, s58, 0
  s_nop 0
  buffer_load_dwordx4 v2, s[24:27], s51 offen offset:0 sc1 lds
  v_mfma_f32_32x32x16_bf16 v[176:191], v[24:27], v[108:111], v[176:191]
  ds_read_b128 v[72:75], v8 offset:31744
  v_exp_f32 v83, v167
  v_add_f32 v84, v84, v82
  v_add_u32 v8, s48, v2
  v_mfma_f32_32x32x16_bf16 v[176:191], v[28:31], v[112:115], v[176:191]
  ds_read_b128 v[12:15], v8 offset:0
  v_exp_f32 v80, v168
  v_add_f32 v84, v84, v83
  v_cvt_pk_bf16_f32 v147, v82, v83
  buffer_load_dwordx4 v2, s[24:27], s51 offen offset:1024 sc1 lds
  v_mfma_f32_32x32x16_bf16 v[176:191], v[32:35], v[116:119], v[176:191]
  ds_read_b128 v[16:19], v8 offset:1024
  v_exp_f32 v81, v169
  v_add_f32 v84, v84, v80
  v_add_f32 v86, v86, v85
  v_mfma_f32_32x32x16_bf16 v[176:191], v[36:39], v[120:123], v[176:191]
  ds_read_b128 v[20:23], v8 offset:2048
  v_exp_f32 v82, v170
  v_add_f32 v84, v84, v81
  v_cvt_pk_bf16_f32 v148, v80, v81
  buffer_load_dwordx4 v2, s[24:27], s51 offen offset:2048 sc1 lds
  v_mfma_f32_32x32x16_bf16 v[176:191], v[40:43], v[124:127], v[176:191]
  ds_read_b128 v[24:27], v8 offset:3072
  v_exp_f32 v83, v171
  v_add_f32 v84, v84, v82
  s_add_u32 s47, s47, 1
  buffer_load_dwordx4 v2, s[24:27], s51 offen offset:3072 sc1 lds
  v_mfma_f32_32x32x16_bf16 v[192:207], v[44:47], v[152:155], v[192:207]
  ds_read_b128 v[28:31], v8 offset:4096
  v_exp_f32 v80, v172
  v_add_f32 v84, v84, v83
  v_cvt_pk_bf16_f32 v149, v82, v83
  s_add_u32 m0, s58, 16384
  s_nop 0
  buffer_load_dwordx4 v2, s[24:27], s52 offen offset:0 sc1 lds
  v_mfma_f32_32x32x16_bf16 v[208:223], v[48:51], v[152:155], v[208:223]
  ds_read_b128 v[32:35], v8 offset:5120
  v_exp_f32 v81, v173
  v_add_f32 v84, v84, v80
  s_waitcnt lgkmcnt(4)
  v_mfma_f32_32x32x16_bf16 v[224:239], v[52:55], v[152:155], v[224:239]
  ds_read_b128 v[36:39], v8 offset:6144
  v_exp_f32 v82, v174
  v_add_f32 v84, v84, v81
  v_cvt_pk_bf16_f32 v150, v80, v81
  buffer_load_dwordx4 v2, s[24:27], s52 offen offset:1024 sc1 lds
  v_mfma_f32_32x32x16_bf16 v[240:255], v[56:59], v[152:155], v[240:255]
  ds_read_b128 v[40:43], v8 offset:7168
  v_exp_f32 v83, v175
  v_add_f32 v84, v84, v82
  buffer_load_dwordx4 v2, s[24:27], s52 offen offset:2048 sc1 lds
  v_mfma_f32_32x32x16_bf16 v[192:207], v[60:63], v[156:159], v[192:207]
  ds_read_b128 v[44:47], v8 offset:16384
  s_add_u32 s56, s47, 0
  s_lshl_b32 s56, s56, 6
  s_add_u32 s56, s56, 32
  v_subrev_u32 v87, s56, v3
  v_cmp_le_i32 s[8:9], 0, v87
  v_cmp_le_i32 s[10:11], 1, v87
  v_cmp_le_i32 s[12:13], 2, v87
  v_cmp_le_i32 s[14:15], 3, v87
  s_nop 1
  v_cndmask_b32 v176, v88, v176, s[8:9]
  v_cndmask_b32 v177, v88, v177, s[10:11]
  v_cndmask_b32 v178, v88, v178, s[12:13]
  v_cndmask_b32 v179, v88, v179, s[14:15]
  v_cmp_le_i32 s[8:9], 16, v87
  v_cmp_le_i32 s[10:11], 17, v87
  v_cmp_le_i32 s[12:13], 18, v87
  v_cmp_le_i32 s[14:15], 19, v87
  s_nop 1
  v_cndmask_b32 v180, v88, v180, s[8:9]
  v_cndmask_b32 v181, v88, v181, s[10:11]
  v_cndmask_b32 v182, v88, v182, s[12:13]
  v_cndmask_b32 v183, v88, v183, s[14:15]
  v_cmp_le_i32 s[8:9], 8, v87
  v_cmp_le_i32 s[10:11], 9, v87
  v_cmp_le_i32 s[12:13], 10, v87
  v_cmp_le_i32 s[14:15], 11, v87
  s_nop 1
  v_cndmask_b32 v184, v88, v184, s[8:9]
  v_cndmask_b32 v185, v88, v185, s[10:11]
  v_cndmask_b32 v186, v88, v186, s[12:13]
  v_cndmask_b32 v187, v88, v187, s[14:15]
  v_cmp_le_i32 s[8:9], 24, v87
  v_cmp_le_i32 s[10:11], 25, v87
  v_cmp_le_i32 s[12:13], 26, v87
  v_cmp_le_i32 s[14:15], 27, v87
  s_nop 1
  v_cndmask_b32 v188, v88, v188, s[8:9]
  v_cndmask_b32 v189, v88, v189, s[10:11]
  v_cndmask_b32 v190, v88, v190, s[12:13]
  v_cndmask_b32 v191, v88, v191, s[14:15]
  v_exp_f32 v80, v176
  v_add_f32 v84, v84, v83
  v_cvt_pk_bf16_f32 v151, v82, v83
  buffer_load_dwordx4 v2, s[24:27], s52 offen offset:3072 sc1 lds
  v_mfma_f32_32x32x16_bf16 v[208:223], v[64:67], v[156:159], v[208:223]
  ds_read_b128 v[48:51], v8 offset:17408
  v_exp_f32 v81, v177
  v_cmp_lt_f32 vcc, s60, v84
  s_add_u32 s50, s50, 1
  s_add_u32 s59, s59, 32768
  s_and_b32 s59, s59, 131071
  v_mfma_f32_32x32x16_bf16 v[224:239], v[68:71], v[156:159], v[224:239]
  ds_read_b128 v[52:55], v8 offset:18432
  v_exp_f32 v82, v178
  v_add_f32 v85, v80, v81
  v_cvt_pk_bf16_f32 v152, v80, v81
  v_mfma_f32_32x32x16_bf16 v[240:255], v[72:75], v[156:159], v[240:255]
  ds_read_b128 v[56:59], v8 offset:19456
  v_exp_f32 v83, v179
  v_add_f32 v85, v85, v82
  s_cbranch_vccnz sequential_preLN__compressed_kv_cla__dense_activation_squared_relu__prompt_kernel_chk0_Am
sequential_preLN__compressed_kv_cla__dense_activation_squared_relu__prompt_kernel_chk0_Am_ret:
  s_sub_u32 s66, s66, 1
  s_cbranch_scc0 sequential_preLN__compressed_kv_cla__dense_activation_squared_relu__prompt_kernel_loopAm
  s_branch Lend_32
Lev_33:
.p2align 3
sequential_preLN__compressed_kv_cla__dense_activation_squared_relu__prompt_kernel_loopAme:
  v_mfma_f32_32x32x16_bf16 v[160:175], v[12:15], v[96:99], v[128:143]
  ds_read_b128 v[60:63], v8 offset:20480
  v_exp_f32 v80, v180
  v_add_f32 v85, v85, v83
  v_cvt_pk_bf16_f32 v153, v82, v83
  v_mfma_f32_32x32x16_bf16 v[160:175], v[16:19], v[100:103], v[160:175]
  ds_read_b128 v[64:67], v8 offset:21504
  v_exp_f32 v81, v181
  v_add_f32 v85, v85, v80
  s_waitcnt lgkmcnt(4)
  v_mfma_f32_32x32x16_bf16 v[160:175], v[20:23], v[104:107], v[160:175]
  ds_read_b128 v[68:71], v8 offset:22528
  v_exp_f32 v82, v182
  v_add_f32 v85, v85, v81
  v_cvt_pk_bf16_f32 v154, v80, v81
  v_mfma_f32_32x32x16_bf16 v[160:175], v[24:27], v[108:111], v[160:175]
  ds_read_b128 v[72:75], v8 offset:23552
  v_exp_f32 v83, v183
  v_add_f32 v85, v85, v82
  v_add_f32 v86, v86, v84
  v_mfma_f32_32x32x16_bf16 v[160:175], v[28:31], v[112:115], v[160:175]
  ds_read_b128 v[12:15], v8 offset:8192
  v_exp_f32 v80, v184
  v_add_f32 v85, v85, v83
  v_cvt_pk_bf16_f32 v155, v82, v83
  v_mfma_f32_32x32x16_bf16 v[160:175], v[32:35], v[116:119], v[160:175]
  ds_read_b128 v[16:19], v8 offset:9216
  v_exp_f32 v81, v185
  v_add_f32 v85, v85, v80
  s_add_u32 s48, s48, 32768
  v_mfma_f32_32x32x16_bf16 v[160:175], v[36:39], v[120:123], v[160:175]
  ds_read_b128 v[20:23], v8 offset:10240
  v_exp_f32 v82, v186
  v_add_f32 v85, v85, v81
  v_cvt_pk_bf16_f32 v156, v80, v81
  v_mfma_f32_32x32x16_bf16 v[160:175], v[40:43], v[124:127], v[160:175]
  ds_read_b128 v[24:27], v8 offset:11264
  v_exp_f32 v83, v187
  v_add_f32 v85, v85, v82
  s_and_b32 s48, s48, 131071
  v_mfma_f32_32x32x16_bf16 v[192:207], v[44:47], v[144:147], v[192:207]
  ds_read_b128 v[28:31], v8 offset:12288
  v_exp_f32 v80, v188
  v_add_f32 v85, v85, v83
  v_cvt_pk_bf16_f32 v157, v82, v83
  v_mfma_f32_32x32x16_bf16 v[208:223], v[48:51], v[144:147], v[208:223]
  ds_read_b128 v[32:35], v8 offset:13312
  v_exp_f32 v81, v189
  v_add_f32 v85, v85, v80
  s_waitcnt lgkmcnt(4)
  v_mfma_f32_32x32x16_bf16 v[224:239], v[52:55], v[144:147], v[224:239]
  ds_read_b128 v[36:39], v8 offset:14336
  v_exp_f32 v82, v190
  v_add_f32 v85, v85, v81
  v_cvt_pk_bf16_f32 v158, v80, v81
  v_mfma_f32_32x32x16_bf16 v[240:255], v[56:59], v[144:147], v[240:255]
  ds_read_b128 v[40:43], v8 offset:15360
  v_exp_f32 v83, v191
  v_add_f32 v85, v85, v82
  v_mfma_f32_32x32x16_bf16 v[192:207], v[60:63], v[148:151], v[192:207]
  ds_read_b128 v[44:47], v8 offset:24576
  s_add_u32 s56, s47, 1
  s_lshl_b32 s56, s56, 6
  s_add_u32 s56, s56, 0
  v_subrev_u32 v87, s56, v3
  v_cmp_le_i32 s[8:9], 0, v87
  v_cmp_le_i32 s[10:11], 1, v87
  v_cmp_le_i32 s[12:13], 2, v87
  v_cmp_le_i32 s[14:15], 3, v87
  s_nop 1
  v_cndmask_b32 v160, v88, v160, s[8:9]
  v_cndmask_b32 v161, v88, v161, s[10:11]
  v_cndmask_b32 v162, v88, v162, s[12:13]
  v_cndmask_b32 v163, v88, v163, s[14:15]
  v_cmp_le_i32 s[8:9], 16, v87
  v_cmp_le_i32 s[10:11], 17, v87
  v_cmp_le_i32 s[12:13], 18, v87
  v_cmp_le_i32 s[14:15], 19, v87
  s_nop 1
  v_cndmask_b32 v164, v88, v164, s[8:9]
  v_cndmask_b32 v165, v88, v165, s[10:11]
  v_cndmask_b32 v166, v88, v166, s[12:13]
  v_cndmask_b32 v167, v88, v167, s[14:15]
  v_cmp_le_i32 s[8:9], 8, v87
  v_cmp_le_i32 s[10:11], 9, v87
  v_cmp_le_i32 s[12:13], 10, v87
  v_cmp_le_i32 s[14:15], 11, v87
  s_nop 1
  v_cndmask_b32 v168, v88, v168, s[8:9]
  v_cndmask_b32 v169, v88, v169, s[10:11]
  v_cndmask_b32 v170, v88, v170, s[12:13]
  v_cndmask_b32 v171, v88, v171, s[14:15]
  v_cmp_le_i32 s[8:9], 24, v87
  v_cmp_le_i32 s[10:11], 25, v87
  v_cmp_le_i32 s[12:13], 26, v87
  v_cmp_le_i32 s[14:15], 27, v87
  s_nop 1
  v_cndmask_b32 v172, v88, v172, s[8:9]
  v_cndmask_b32 v173, v88, v173, s[10:11]
  v_cndmask_b32 v174, v88, v174, s[12:13]
  v_cndmask_b32 v175, v88, v175, s[14:15]
  v_exp_f32 v80, v160
  v_add_f32 v85, v85, v83
  v_cvt_pk_bf16_f32 v159, v82, v83
  v_mfma_f32_32x32x16_bf16 v[208:223], v[64:67], v[148:151], v[208:223]
  ds_read_b128 v[48:51], v8 offset:25600
  v_exp_f32 v81, v161
  v_cmp_lt_f32 vcc, s60, v85
  s_waitcnt vmcnt(8)
  s_barrier
  v_mfma_f32_32x32x16_bf16 v[224:239], v[68:71], v[148:151], v[224:239]
  ds_read_b128 v[52:55], v8 offset:26624
  v_exp_f32 v82, v162
  v_add_f32 v84, v80, v81
  v_cvt_pk_bf16_f32 v144, v80, v81
  s_lshl_b32 s31, s50, 14
  s_add_u32 s31, s31, s64
  s_add_u32 s51, s31, 0x4000
  s_add_u32 s52, s31, 0x1200000
  s_cmp_lt_u32 s50, s46
  v_mfma_f32_32x32x16_bf16 v[240:255], v[72:75], v[148:151], v[240:255]
  ds_read_b128 v[56:59], v8 offset:27648
  v_exp_f32 v83, v163
  v_add_f32 v84, v84, v82
  s_cbranch_vccnz sequential_preLN__compressed_kv_cla__dense_activation_squared_relu__prompt_kernel_chk1_Ame
sequential_preLN__compressed_kv_cla__dense_activation_squared_relu__prompt_kernel_chk1_Ame_ret:
  ds_read_b128 v[60:63], v8 offset:28672
  v_exp_f32 v80, v164
  v_add_f32 v84, v84, v83
  v_cvt_pk_bf16_f32 v145, v82, v83
  s_cselect_b32 s51, s51, s61
  s_cselect_b32 s52, s52, s61
  s_lshl_b32 s58, s53, 12
  s_add_u32 s58, s58, s59
  ds_read_b128 v[64:67], v8 offset:29696
  v_exp_f32 v81, v165
  v_add_f32 v84, v84, v80
  s_waitcnt lgkmcnt(4)
  ds_read_b128 v[68:71], v8 offset:30720
  v_exp_f32 v82, v166
  v_add_f32 v84, v84, v81
  v_cvt_pk_bf16_f32 v146, v80, v81
  s_add_u32 m0, s58, 0
  s_nop 0
  buffer_load_dwordx4 v2, s[24:27], s51 offen offset:0 sc1 lds
  ds_read_b128 v[72:75], v8 offset:31744
  v_exp_f32 v83, v167
  v_add_f32 v84, v84, v82
  v_add_u32 v8, s48, v2
  ds_read_b128 v[12:15], v8 offset:0
  v_exp_f32 v80, v168
  v_add_f32 v84, v84, v83
  v_cvt_pk_bf16_f32 v147, v82, v83
  buffer_load_dwordx4 v2, s[24:27], s51 offen offset:1024 sc1 lds
  ds_read_b128 v[16:19], v8 offset:1024
  v_exp_f32 v81, v169
  v_add_f32 v84, v84, v80
  v_add_f32 v86, v86, v85
  ds_read_b128 v[20:23], v8 offset:2048
  v_exp_f32 v82, v170
  v_add_f32 v84, v84, v81
  v_cvt_pk_bf16_f32 v148, v80, v81
  buffer_load_dwordx4 v2, s[24:27], s51 offen offset:2048 sc1 lds
  ds_read_b128 v[24:27], v8 offset:3072
  v_exp_f32 v83, v171
  v_add_f32 v84, v84, v82
  s_add_u32 s47, s47, 1
  buffer_load_dwordx4 v2, s[24:27], s51 offen offset:3072 sc1 lds
  v_mfma_f32_32x32x16_bf16 v[192:207], v[44:47], v[152:155], v[192:207]
  ds_read_b128 v[28:31], v8 offset:4096
  v_exp_f32 v80, v172
  v_add_f32 v84, v84, v83
  v_cvt_pk_bf16_f32 v149, v82, v83
  s_add_u32 m0, s58, 16384
  s_nop 0
  buffer_load_dwordx4 v2, s[24:27], s52 offen offset:0 sc1 lds
  v_mfma_f32_32x32x16_bf16 v[208:223], v[48:51], v[152:155], v[208:223]
  ds_read_b128 v[32:35], v8 offset:5120
  v_exp_f32 v81, v173
  v_add_f32 v84, v84, v80
  s_waitcnt lgkmcnt(4)
  v_mfma_f32_32x32x16_bf16 v[224:239], v[52:55], v[152:155], v[224:239]
  ds_read_b128 v[36:39], v8 offset:6144
  v_exp_f32 v82, v174
  v_add_f32 v84, v84, v81
  v_cvt_pk_bf16_f32 v150, v80, v81
  buffer_load_dwordx4 v2, s[24:27], s52 offen offset:1024 sc1 lds
  v_mfma_f32_32x32x16_bf16 v[240:255], v[56:59], v[152:155], v[240:255]
  ds_read_b128 v[40:43], v8 offset:7168
  v_exp_f32 v83, v175
  v_add_f32 v84, v84, v82
  buffer_load_dwordx4 v2, s[24:27], s52 offen offset:2048 sc1 lds
  v_mfma_f32_32x32x16_bf16 v[192:207], v[60:63], v[156:159], v[192:207]
  ds_read_b128 v[44:47], v8 offset:16384
  v_add_f32 v84, v84, v83
  v_cvt_pk_bf16_f32 v151, v82, v83
  buffer_load_dwordx4 v2, s[24:27], s52 offen offset:3072 sc1 lds
  v_mfma_f32_32x32x16_bf16 v[208:223], v[64:67], v[156:159], v[208:223]
  ds_read_b128 v[48:51], v8 offset:17408
  v_cmp_lt_f32 vcc, s60, v84
  s_add_u32 s50, s50, 1
  s_add_u32 s59, s59, 32768
  s_and_b32 s59, s59, 131071
  v_mfma_f32_32x32x16_bf16 v[224:239], v[68:71], v[156:159], v[224:239]
  ds_read_b128 v[52:55], v8 offset:18432
  v_mfma_f32_32x32x16_bf16 v[240:255], v[72:75], v[156:159], v[240:255]
  ds_read_b128 v[56:59], v8 offset:19456
  s_cbranch_vccnz sequential_preLN__compressed_kv_cla__dense_activation_squared_relu__prompt_kernel_chk0_Ame
sequential_preLN__compressed_kv_cla__dense_activation_squared_relu__prompt_kernel_chk0_Ame_ret:
  s_sub_u32 s66, s66, 1
  s_cbranch_scc0 sequential_preLN__compressed_kv_cla__dense_activation_squared_relu__prompt_kernel_loopAme
Lend_32:
  s_waitcnt lgkmcnt(0)
  s_bitcmp0_b32 s54, 0
  s_cbranch_scc1 Lfe_34
  ds_read_b128 v[12:15], v8 offset:16384
  ds_read_b128 v[16:19], v8 offset:17408
  ds_read_b128 v[20:23], v8 offset:18432
  ds_read_b128 v[24:27], v8 offset:19456
  ds_read_b128 v[28:31], v8 offset:20480
  ds_read_b128 v[32:35], v8 offset:21504
  ds_read_b128 v[36:39], v8 offset:22528
  ds_read_b128 v[40:43], v8 offset:23552
  ds_read_b128 v[44:47], v8 offset:24576
  ds_read_b128 v[48:51], v8 offset:28672
  ds_read_b128 v[52:55], v8 offset:25600
  ds_read_b128 v[56:59], v8 offset:29696
  v_add_f32 v86, v86, v84
  s_waitcnt lgkmcnt(8)
  v_mfma_f32_32x32x16_bf16 v[192:207], v[12:15], v[144:147], v[192:207]
  ds_read_b128 v[60:63], v8 offset:26624
  v_exp_f32 v80, v180
  v_add_f32 v85, v85, v83
  v_cvt_pk_bf16_f32 v153, v82, v83
  v_exp_f32 v81, v181
  v_mfma_f32_32x32x16_bf16 v[208:223], v[16:19], v[144:147], v[208:223]
  ds_read_b128 v[64:67], v8 offset:30720
  v_add_f32 v85, v85, v80
  v_exp_f32 v82, v182
  v_add_f32 v85, v85, v81
  v_cvt_pk_bf16_f32 v154, v80, v81
  v_mfma_f32_32x32x16_bf16 v[224:239], v[20:23], v[144:147], v[224:239]
  ds_read_b128 v[68:71], v8 offset:27648
  v_exp_f32 v83, v183
  v_add_f32 v85, v85, v82
  v_exp_f32 v80, v184
  v_add_f32 v85, v85, v83
  v_mfma_f32_32x32x16_bf16 v[240:255], v[24:27], v[144:147], v[240:255]
  ds_read_b128 v[72:75], v8 offset:31744
  v_cvt_pk_bf16_f32 v155, v82, v83
  v_exp_f32 v81, v185
  v_add_f32 v85, v85, v80
  v_exp_f32 v82, v186
  s_waitcnt lgkmcnt(8)
  v_mfma_f32_32x32x16_bf16 v[192:207], v[28:31], v[148:151], v[192:207]
  v_add_f32 v85, v85, v81
  v_cvt_pk_bf16_f32 v156, v80, v81
  v_exp_f32 v83, v187
  v_add_f32 v85, v85, v82
  v_mfma_f32_32x32x16_bf16 v[208:223], v[32:35], v[148:151], v[208:223]
  v_exp_f32 v80, v188
  v_add_f32 v85, v85, v83
  v_cvt_pk_bf16_f32 v157, v82, v83
  v_exp_f32 v81, v189
  v_mfma_f32_32x32x16_bf16 v[224:239], v[36:39], v[148:151], v[224:239]
  v_add_f32 v85, v85, v80
  v_exp_f32 v82, v190
  v_add_f32 v85, v85, v81
  v_cvt_pk_bf16_f32 v158, v80, v81
  v_mfma_f32_32x32x16_bf16 v[240:255], v[40:43], v[148:151], v[240:255]
  v_exp_f32 v83, v191
  v_add_f32 v85, v85, v82
  v_add_f32 v85, v85, v83
  v_cvt_pk_bf16_f32 v159, v82, v83
  v_cmp_lt_f32 vcc, s60, v85
  s_nop 1
  s_cbranch_vccnz sequential_preLN__compressed_kv_cla__dense_activation_squared_relu__prompt_kernel_chk1_finA
sequential_preLN__compressed_kv_cla__dense_activation_squared_relu__prompt_kernel_chk1_finA_ret:
  v_add_f32 v86, v86, v85
  v_mov_b32 v90, v86
  s_lshl_b32 s31, s54, 5
  s_add_u32 s31, s31, s28
  v_permlane32_swap_b32 v86, v90
  s_lshl_b32 s31, s31, 13
  s_add_u32 s31, s31, 0x2400000
  v_add_f32 v86, v86, v90
  v_rcp_f32 v86, v86
  s_add_u32 s32, s31, 4096
  s_waitcnt lgkmcnt(0)
  v_mfma_f32_32x32x16_bf16 v[192:207], v[44:47], v[152:155], v[192:207]
  s_nop 3
  v_mfma_f32_32x32x16_bf16 v[192:207], v[48:51], v[156:159], v[192:207]
  s_nop 3
  v_mfma_f32_32x32x16_bf16 v[208:223], v[52:55], v[152:155], v[208:223]
  s_nop 3
  v_mfma_f32_32x32x16_bf16 v[208:223], v[56:59], v[156:159], v[208:223]
  s_nop 3
  v_mfma_f32_32x32x16_bf16 v[224:239], v[60:63], v[152:155], v[224:239]
  v_mul_f32 v192, v192, v86
  v_mul_f32 v193, v193, v86
  v_mul_f32 v194, v194, v86
  v_mul_f32 v195, v195, v86
  v_mul_f32 v196, v196, v86
  v_mul_f32 v197, v197, v86
  v_mul_f32 v198, v198, v86
  v_mul_f32 v199, v199, v86
  v_cvt_pk_bf16_f32 v192, v192, v193
  v_cvt_pk_bf16_f32 v193, v194, v195
  v_cvt_pk_bf16_f32 v194, v196, v197
  v_cvt_pk_bf16_f32 v195, v198, v199
  buffer_store_dwordx4 v[192:195], v2, s[24:27], s31 offen offset:0 sc1
  v_mfma_f32_32x32x16_bf16 v[224:239], v[64:67], v[156:159], v[224:239]
  v_mul_f32 v200, v200, v86
  v_mul_f32 v201, v201, v86
  v_mul_f32 v202, v202, v86
  v_mul_f32 v203, v203, v86
  v_mul_f32 v204, v204, v86
  v_mul_f32 v205, v205, v86
  v_mul_f32 v206, v206, v86
  v_mul_f32 v207, v207, v86
  v_cvt_pk_bf16_f32 v200, v200, v201
  v_cvt_pk_bf16_f32 v201, v202, v203
  v_cvt_pk_bf16_f32 v202, v204, v205
  v_cvt_pk_bf16_f32 v203, v206, v207
  buffer_store_dwordx4 v[200:203], v2, s[24:27], s31 offen offset:1024 sc1
  v_mfma_f32_32x32x16_bf16 v[240:255], v[68:71], v[152:155], v[240:255]
  v_mul_f32 v208, v208, v86
  v_mul_f32 v209, v209, v86
  v_mul_f32 v210, v210, v86
  v_mul_f32 v211, v211, v86
  v_mul_f32 v212, v212, v86
  v_mul_f32 v213, v213, v86
  v_mul_f32 v214, v214, v86
  v_mul_f32 v215, v215, v86
  v_cvt_pk_bf16_f32 v208, v208, v209
  v_cvt_pk_bf16_f32 v209, v210, v211
  v_cvt_pk_bf16_f32 v210, v212, v213
  v_cvt_pk_bf16_f32 v211, v214, v215
  buffer_store_dwordx4 v[208:211], v2, s[24:27], s31 offen offset:2048 sc1
  v_mfma_f32_32x32x16_bf16 v[240:255], v[72:75], v[156:159], v[240:255]
  v_mul_f32 v216, v216, v86
  v_mul_f32 v217, v217, v86
  v_mul_f32 v218, v218, v86
  v_mul_f32 v219, v219, v86
  v_mul_f32 v220, v220, v86
  v_mul_f32 v221, v221, v86
  v_mul_f32 v222, v222, v86
  v_mul_f32 v223, v223, v86
  v_cvt_pk_bf16_f32 v216, v216, v217
  v_cvt_pk_bf16_f32 v217, v218, v219
  v_cvt_pk_bf16_f32 v218, v220, v221
  v_cvt_pk_bf16_f32 v219, v222, v223
  buffer_store_dwordx4 v[216:219], v2, s[24:27], s31 offen offset:3072 sc1
  s_nop 7
  s_nop 3
  v_mul_f32 v224, v224, v86
  v_mul_f32 v225, v225, v86
  v_mul_f32 v226, v226, v86
  v_mul_f32 v227, v227, v86
  v_mul_f32 v228, v228, v86
  v_mul_f32 v229, v229, v86
  v_mul_f32 v230, v230, v86
  v_mul_f32 v231, v231, v86
  v_cvt_pk_bf16_f32 v224, v224, v225
  v_cvt_pk_bf16_f32 v225, v226, v227
  v_cvt_pk_bf16_f32 v226, v228, v229
  v_cvt_pk_bf16_f32 v227, v230, v231
  buffer_store_dwordx4 v[224:227], v2, s[24:27], s32 offen offset:0 sc1
  v_mul_f32 v232, v232, v86
  v_mul_f32 v233, v233, v86
  v_mul_f32 v234, v234, v86
  v_mul_f32 v235, v235, v86
  v_mul_f32 v236, v236, v86
  v_mul_f32 v237, v237, v86
  v_mul_f32 v238, v238, v86
  v_mul_f32 v239, v239, v86
  v_cvt_pk_bf16_f32 v232, v232, v233
  v_cvt_pk_bf16_f32 v233, v234, v235
  v_cvt_pk_bf16_f32 v234, v236, v237
  v_cvt_pk_bf16_f32 v235, v238, v239
  buffer_store_dwordx4 v[232:235], v2, s[24:27], s32 offen offset:1024 sc1
  v_mul_f32 v240, v240, v86
  v_mul_f32 v241, v241, v86
  v_mul_f32 v242, v242, v86
  v_mul_f32 v243, v243, v86
  v_mul_f32 v244, v244, v86
  v_mul_f32 v245, v245, v86
  v_mul_f32 v246, v246, v86
  v_mul_f32 v247, v247, v86
  v_cvt_pk_bf16_f32 v240, v240, v241
  v_cvt_pk_bf16_f32 v241, v242, v243
  v_cvt_pk_bf16_f32 v242, v244, v245
  v_cvt_pk_bf16_f32 v243, v246, v247
  buffer_store_dwordx4 v[240:243], v2, s[24:27], s32 offen offset:2048 sc1
  v_mul_f32 v248, v248, v86
  v_mul_f32 v249, v249, v86
  v_mul_f32 v250, v250, v86
  v_mul_f32 v251, v251, v86
  v_mul_f32 v252, v252, v86
  v_mul_f32 v253, v253, v86
  v_mul_f32 v254, v254, v86
  v_mul_f32 v255, v255, v86
  v_cvt_pk_bf16_f32 v248, v248, v249
  v_cvt_pk_bf16_f32 v249, v250, v251
  v_cvt_pk_bf16_f32 v250, v252, v253
  v_cvt_pk_bf16_f32 v251, v254, v255
  buffer_store_dwordx4 v[248:251], v2, s[24:27], s32 offen offset:3072 sc1
  s_branch Lff_35
Lfe_34:
  ds_read_b128 v[12:15], v8 offset:16384
  ds_read_b128 v[16:19], v8 offset:17408
  ds_read_b128 v[20:23], v8 offset:18432
  ds_read_b128 v[24:27], v8 offset:19456
  ds_read_b128 v[28:31], v8 offset:20480
  ds_read_b128 v[32:35], v8 offset:21504
  ds_read_b128 v[36:39], v8 offset:22528
  ds_read_b128 v[40:43], v8 offset:23552
  ds_read_b128 v[44:47], v8 offset:24576
  ds_read_b128 v[48:51], v8 offset:28672
  ds_read_b128 v[52:55], v8 offset:25600
  ds_read_b128 v[56:59], v8 offset:29696
  v_add_f32 v86, v86, v84
  s_waitcnt lgkmcnt(8)
  v_mfma_f32_32x32x16_bf16 v[192:207], v[12:15], v[144:147], v[192:207]
  ds_read_b128 v[60:63], v8 offset:26624
  v_mfma_f32_32x32x16_bf16 v[208:223], v[16:19], v[144:147], v[208:223]
  ds_read_b128 v[64:67], v8 offset:30720
  v_mfma_f32_32x32x16_bf16 v[224:239], v[20:23], v[144:147], v[224:239]
  ds_read_b128 v[68:71], v8 offset:27648
  v_mfma_f32_32x32x16_bf16 v[240:255], v[24:27], v[144:147], v[240:255]
  ds_read_b128 v[72:75], v8 offset:31744
  s_waitcnt lgkmcnt(8)
  v_mfma_f32_32x32x16_bf16 v[192:207], v[28:31], v[148:151], v[192:207]
  v_mfma_f32_32x32x16_bf16 v[208:223], v[32:35], v[148:151], v[208:223]
  v_mfma_f32_32x32x16_bf16 v[224:239], v[36:39], v[148:151], v[224:239]
  v_mfma_f32_32x32x16_bf16 v[240:255], v[40:43], v[148:151], v[240:255]
  v_mov_b32 v90, v86
  s_lshl_b32 s31, s54, 5
  s_add_u32 s31, s31, s28
  v_permlane32_swap_b32 v86, v90
  s_lshl_b32 s31, s31, 13
  s_add_u32 s31, s31, 0x2400000
  v_add_f32 v86, v86, v90
  v_rcp_f32 v86, v86
  s_add_u32 s32, s31, 4096
  s_waitcnt lgkmcnt(0)
  s_nop 7
  v_mul_f32 v192, v192, v86
  v_mul_f32 v193, v193, v86
  v_mul_f32 v194, v194, v86
  v_mul_f32 v195, v195, v86
  v_mul_f32 v196, v196, v86
  v_mul_f32 v197, v197, v86
  v_mul_f32 v198, v198, v86
  v_mul_f32 v199, v199, v86
  v_cvt_pk_bf16_f32 v192, v192, v193
  v_cvt_pk_bf16_f32 v193, v194, v195
  v_cvt_pk_bf16_f32 v194, v196, v197
  v_cvt_pk_bf16_f32 v195, v198, v199
  buffer_store_dwordx4 v[192:195], v2, s[24:27], s31 offen offset:0 sc1
  v_mul_f32 v200, v200, v86
  v_mul_f32 v201, v201, v86
  v_mul_f32 v202, v202, v86
  v_mul_f32 v203, v203, v86
  v_mul_f32 v204, v204, v86
  v_mul_f32 v205, v205, v86
  v_mul_f32 v206, v206, v86
  v_mul_f32 v207, v207, v86
  v_cvt_pk_bf16_f32 v200, v200, v201
  v_cvt_pk_bf16_f32 v201, v202, v203
  v_cvt_pk_bf16_f32 v202, v204, v205
  v_cvt_pk_bf16_f32 v203, v206, v207
  buffer_store_dwordx4 v[200:203], v2, s[24:27], s31 offen offset:1024 sc1
  v_mul_f32 v208, v208, v86
  v_mul_f32 v209, v209, v86
  v_mul_f32 v210, v210, v86
  v_mul_f32 v211, v211, v86
  v_mul_f32 v212, v212, v86
  v_mul_f32 v213, v213, v86
  v_mul_f32 v214, v214, v86
  v_mul_f32 v215, v215, v86
  v_cvt_pk_bf16_f32 v208, v208, v209
  v_cvt_pk_bf16_f32 v209, v210, v211
  v_cvt_pk_bf16_f32 v210, v212, v213
  v_cvt_pk_bf16_f32 v211, v214, v215
  buffer_store_dwordx4 v[208:211], v2, s[24:27], s31 offen offset:2048 sc1
  v_mul_f32 v216, v216, v86
  v_mul_f32 v217, v217, v86
  v_mul_f32 v218, v218, v86
  v_mul_f32 v219, v219, v86
  v_mul_f32 v220, v220, v86
  v_mul_f32 v221, v221, v86
  v_mul_f32 v222, v222, v86
  v_mul_f32 v223, v223, v86
  v_cvt_pk_bf16_f32 v216, v216, v217
  v_cvt_pk_bf16_f32 v217, v218, v219
  v_cvt_pk_bf16_f32 v218, v220, v221
  v_cvt_pk_bf16_f32 v219, v222, v223
  buffer_store_dwordx4 v[216:219], v2, s[24:27], s31 offen offset:3072 sc1
  v_mul_f32 v224, v224, v86
  v_mul_f32 v225, v225, v86
  v_mul_f32 v226, v226, v86
  v_mul_f32 v227, v227, v86
  v_mul_f32 v228, v228, v86
  v_mul_f32 v229, v229, v86
  v_mul_f32 v230, v230, v86
  v_mul_f32 v231, v231, v86
  v_cvt_pk_bf16_f32 v224, v224, v225
  v_cvt_pk_bf16_f32 v225, v226, v227
  v_cvt_pk_bf16_f32 v226, v228, v229
  v_cvt_pk_bf16_f32 v227, v230, v231
  buffer_store_dwordx4 v[224:227], v2, s[24:27], s32 offen offset:0 sc1
  v_mul_f32 v232, v232, v86
  v_mul_f32 v233, v233, v86
  v_mul_f32 v234, v234, v86
  v_mul_f32 v235, v235, v86
  v_mul_f32 v236, v236, v86
  v_mul_f32 v237, v237, v86
  v_mul_f32 v238, v238, v86
  v_mul_f32 v239, v239, v86
  v_cvt_pk_bf16_f32 v232, v232, v233
  v_cvt_pk_bf16_f32 v233, v234, v235
  v_cvt_pk_bf16_f32 v234, v236, v237
  v_cvt_pk_bf16_f32 v235, v238, v239
  buffer_store_dwordx4 v[232:235], v2, s[24:27], s32 offen offset:1024 sc1
  v_mul_f32 v240, v240, v86
  v_mul_f32 v241, v241, v86
  v_mul_f32 v242, v242, v86
  v_mul_f32 v243, v243, v86
  v_mul_f32 v244, v244, v86
  v_mul_f32 v245, v245, v86
  v_mul_f32 v246, v246, v86
  v_mul_f32 v247, v247, v86
  v_cvt_pk_bf16_f32 v240, v240, v241
  v_cvt_pk_bf16_f32 v241, v242, v243
  v_cvt_pk_bf16_f32 v242, v244, v245
  v_cvt_pk_bf16_f32 v243, v246, v247
  buffer_store_dwordx4 v[240:243], v2, s[24:27], s32 offen offset:2048 sc1
  v_mul_f32 v248, v248, v86
  v_mul_f32 v249, v249, v86
  v_mul_f32 v250, v250, v86
  v_mul_f32 v251, v251, v86
  v_mul_f32 v252, v252, v86
  v_mul_f32 v253, v253, v86
  v_mul_f32 v254, v254, v86
  v_mul_f32 v255, v255, v86
  v_cvt_pk_bf16_f32 v248, v248, v249
  v_cvt_pk_bf16_f32 v249, v250, v251
  v_cvt_pk_bf16_f32 v250, v252, v253
  v_cvt_pk_bf16_f32 v251, v254, v255
  buffer_store_dwordx4 v[248:251], v2, s[24:27], s32 offen offset:3072 sc1
Lff_35:
  s_load_dwordx2 s[4:5], s[0:1], 40
  s_mul_i32 s31, s2, 16384
  s_mul_i32 s32, s53, 4096
  s_add_u32 s31, s31, s32
  s_waitcnt lgkmcnt(0)
  s_mov_b32 s6, 0x400000
  s_mov_b32 s7, 0x20000
  buffer_load_dwordx4 v[144:147], v2, s[4:7], s31 offen offset:0
  buffer_load_dwordx4 v[148:151], v2, s[4:7], s31 offen offset:1024
  buffer_load_dwordx4 v[152:155], v2, s[4:7], s31 offen offset:2048
  buffer_load_dwordx4 v[156:159], v2, s[4:7], s31 offen offset:3072
  s_load_dwordx2 s[4:5], s[0:1], 56
  s_mul_i32 s31, s2, 8192
  s_mul_i32 s32, s53, 2048
  s_add_u32 s31, s31, s32
  s_waitcnt lgkmcnt(0)
  s_mov_b32 s6, 0x1c0000
  s_mov_b32 s7, 0x20000
  buffer_load_dwordx4 v[144:147], v2, s[4:7], s31 offen offset:0
  buffer_load_dwordx4 v[148:151], v2, s[4:7], s31 offen offset:1024
  s_load_dwordx2 s[4:5], s[0:1], 72
  s_mul_i32 s31, s2, 8192
  s_mul_i32 s32, s53, 2048
  s_add_u32 s31, s31, s32
  s_waitcnt lgkmcnt(0)
  s_mov_b32 s6, 0x1c0000
  s_mov_b32 s7, 0x20000
  buffer_load_dwordx4 v[144:147], v2, s[4:7], s31 offen offset:0
  buffer_load_dwordx4 v[148:151], v2, s[4:7], s31 offen offset:1024
  s_mov_b32 s65, 0
sequential_preLN__compressed_kv_cla__dense_activation_squared_relu__prompt_kernel_ldloop:
  s_cmp_lt_u32 s65, 2
  s_cbranch_scc1 sequential_preLN__compressed_kv_cla__dense_activation_squared_relu__prompt_kernel_ldloop_w16
  s_waitcnt vmcnt(8)
  s_branch sequential_preLN__compressed_kv_cla__dense_activation_squared_relu__prompt_kernel_ldloop_go
sequential_preLN__compressed_kv_cla__dense_activation_squared_relu__prompt_kernel_ldloop_w16:
  s_waitcnt vmcnt(24)
sequential_preLN__compressed_kv_cla__dense_activation_squared_relu__prompt_kernel_ldloop_go:
  s_barrier
  s_lshl_b32 s31, s50, 14
  s_add_u32 s31, s31, s64
  s_add_u32 s51, s31, 0x4000
  s_add_u32 s52, s31, 0x1200000
  s_cmp_lt_u32 s50, s46
  s_cselect_b32 s51, s51, s61
  s_cselect_b32 s52, s52, s61
  s_lshl_b32 s58, s53, 12
  s_add_u32 s58, s58, s59
  s_add_u32 m0, s58, 0
  s_nop 0
  buffer_load_dwordx4 v2, s[24:27], s51 offen offset:0 sc1 lds
  buffer_load_dwordx4 v2, s[24:27], s51 offen offset:1024 sc1 lds
  buffer_load_dwordx4 v2, s[24:27], s51 offen offset:2048 sc1 lds
  buffer_load_dwordx4 v2, s[24:27], s51 offen offset:3072 sc1 lds
  s_add_u32 m0, s58, 16384
  s_nop 0
  buffer_load_dwordx4 v2, s[24:27], s52 offen offset:0 sc1 lds
  buffer_load_dwordx4 v2, s[24:27], s52 offen offset:1024 sc1 lds
  buffer_load_dwordx4 v2, s[24:27], s52 offen offset:2048 sc1 lds
  buffer_load_dwordx4 v2, s[24:27], s52 offen offset:3072 sc1 lds
  s_add_u32 s50, s50, 1
  s_add_u32 s59, s59, 32768
  s_and_b32 s59, s59, 131071
  s_add_u32 s65, s65, 1
  s_add_u32 s31, s65, s45
  s_cmp_lt_u32 s31, s46
  s_cbranch_scc1 sequential_preLN__compressed_kv_cla__dense_activation_squared_relu__prompt_kernel_ldloop
  s_load_dwordx2 s[4:5], s[0:1], 40
  s_bfe_u32 s31, s2, 0x20001
  s_lshl_b32 s31, s31, 20
  s_lshr_b32 s32, s2, 3
  s_lshl_b32 s32, s32, 15
  s_add_u32 s31, s31, s32
  s_lshl_b32 s32, s53, 13
  s_add_u32 s31, s31, s32
  s_waitcnt lgkmcnt(0)
  s_mov_b32 s6, 0x400000
  s_mov_b32 s7, 0x20000
  buffer_load_dwordx4 v[144:147], v2, s[4:7], s31 offen offset:0
  buffer_load_dwordx4 v[148:151], v2, s[4:7], s31 offen offset:1024
  buffer_load_dwordx4 v[152:155], v2, s[4:7], s31 offen offset:2048
  buffer_load_dwordx4 v[156:159], v2, s[4:7], s31 offen offset:3072
  s_add_u32 s31, s31, 4096
  buffer_load_dwordx4 v[144:147], v2, s[4:7], s31 offen offset:0
  buffer_load_dwordx4 v[148:151], v2, s[4:7], s31 offen offset:1024
  buffer_load_dwordx4 v[152:155], v2, s[4:7], s31 offen offset:2048
  buffer_load_dwordx4 v[156:159], v2, s[4:7], s31 offen offset:3072
  s_waitcnt vmcnt(0)
sequential_preLN__compressed_kv_cla__dense_activation_squared_relu__prompt_kernel_ta:
  s_barrier
  s_cmp_lg_u32 s30, 0
  s_cbranch_scc1 Lw1_36
  s_lshl_b32 s69, s2, 7
  s_add_u32 s69, s69, 0x5240000
  v_mov_b32 v11, 1
  s_mov_b64 exec, 1
  buffer_store_dword v11, off, s[24:27], s69 sc1
  s_mov_b64 exec, -1
Lw1_36:
  s_mov_b32 s46, s30
  s_load_dwordx2 s[4:5], s[0:1], 40
  s_load_dwordx2 s[8:9], s[0:1], 104
  s_mov_b32 s16, s46
  s_lshr_b32 s29, s16, 2
  s_and_b32 s16, s16, 3
  s_bfe_u32 s27, s2, 0x20001
  s_and_b32 s17, s2, 1
  s_lshl_b32 s17, s17, 3
  s_lshr_b32 s19, s2, 5
  s_add_u32 s17, s17, s19
  s_bfe_u32 s18, s2, 0x20003
  s_lshl_b32 s26, s18, 1
  s_add_u32 s26, s26, s19
  s_and_b32 s26, s26, 7
  s_mov_b32 s26, 0
  v_lshlrev_b32 v1, 4, v0
  v_lshrrev_b32 v8, 5, v0
  v_bfe_u32 v5, v0, 2, 2
  s_movk_i32 s19, 1024
  v_mul_lo_u32 v2, v5, s19
  v_lshrrev_b32 v5, 4, v0
  v_lshl_add_u32 v2, v5, 6, v2
  v_and_b32 v5, 3, v0
  v_lshl_add_u32 v2, v5, 4, v2
  v_lshlrev_b32 v3, 10, v8
  v_bfe_u32 v5, v0, 2, 2
  v_lshl_add_u32 v3, v5, 6, v3
  v_bfe_u32 v5, v0, 4, 1
  v_lshl_add_u32 v3, v5, 5, v3
  v_and_b32 v5, 3, v0
  v_lshl_add_u32 v3, v5, 3, v3
  v_add_u32 v4, 0x10000, v3
  s_waitcnt lgkmcnt(0)
  s_mov_b32 s6, 0x400000
  s_mov_b32 s7, 0x20000
  s_mov_b32 s10, 0x10000000
  s_mov_b32 s11, 0x20000
  s_lshl_b32 s25, s17, 2
  s_add_u32 s25, s25, s16
  s_lshl_b32 s22, s25, 18
  s_lshl_b32 s19, s27, 16
  s_add_u32 s22, s22, s19
  s_add_u32 s22, s22, 0x2400000
  s_lshl_b32 s23, s27, 20
  s_mul_i32 s19, s16, 4096
  s_add_u32 s23, s23, s19
  s_lshl_b32 s19, s18, 8
  s_add_u32 s23, s23, s19
  s_lshl_b32 s24, s16, 10
  s_cmp_eq_u32 s29, 0
  s_cbranch_scc1 sequential_preLN__compressed_kv_cla__dense_activation_squared_relu__prompt_kernel_p_compute
  s_add_u32 s28, s26, 0
  s_and_b32 s28, s28, 7
  s_mul_i32 s20, s28, 131072
  s_add_u32 s20, s20, s23
  s_add_u32 m0, s24, 0
  s_add_u32 s19, s20, 0
  buffer_load_dwordx4 v2, s[4:7], s19 offen lds
  s_add_u32 m0, s24, 4096
  s_add_u32 s19, s20, 16384
  buffer_load_dwordx4 v2, s[4:7], s19 offen lds
  s_add_u32 m0, s24, 8192
  s_add_u32 s19, s20, 32768
  buffer_load_dwordx4 v2, s[4:7], s19 offen lds
  s_add_u32 m0, s24, 12288
  s_add_u32 s19, s20, 49152
  buffer_load_dwordx4 v2, s[4:7], s19 offen lds
  s_add_u32 m0, s24, 16384
  s_add_u32 s19, s20, 65536
  buffer_load_dwordx4 v2, s[4:7], s19 offen lds
  s_add_u32 m0, s24, 20480
  s_add_u32 s19, s20, 81920
  buffer_load_dwordx4 v2, s[4:7], s19 offen lds
  s_add_u32 m0, s24, 24576
  s_add_u32 s19, s20, 98304
  buffer_load_dwordx4 v2, s[4:7], s19 offen lds
  s_add_u32 m0, s24, 28672
  s_add_u32 s19, s20, 114688
  buffer_load_dwordx4 v2, s[4:7], s19 offen lds
  s_add_u32 s28, s26, 1
  s_and_b32 s28, s28, 7
  s_mul_i32 s20, s28, 131072
  s_add_u32 s20, s20, s23
  s_add_u32 m0, s24, 32768
  s_add_u32 s19, s20, 0
  buffer_load_dwordx4 v2, s[4:7], s19 offen lds
  s_add_u32 m0, s24, 36864
  s_add_u32 s19, s20, 16384
  buffer_load_dwordx4 v2, s[4:7], s19 offen lds
  s_add_u32 m0, s24, 40960
  s_add_u32 s19, s20, 32768
  buffer_load_dwordx4 v2, s[4:7], s19 offen lds
  s_add_u32 m0, s24, 45056
  s_add_u32 s19, s20, 49152
  buffer_load_dwordx4 v2, s[4:7], s19 offen lds
  s_add_u32 m0, s24, 49152
  s_add_u32 s19, s20, 65536
  buffer_load_dwordx4 v2, s[4:7], s19 offen lds
  s_add_u32 m0, s24, 53248
  s_add_u32 s19, s20, 81920
  buffer_load_dwordx4 v2, s[4:7], s19 offen lds
  s_add_u32 m0, s24, 57344
  s_add_u32 s19, s20, 98304
  buffer_load_dwordx4 v2, s[4:7], s19 offen lds
  s_add_u32 m0, s24, 61440
  s_add_u32 s19, s20, 114688
  buffer_load_dwordx4 v2, s[4:7], s19 offen lds
  s_add_u32 s28, s26, 2
  s_and_b32 s28, s28, 7
  s_mul_i32 s20, s28, 131072
  s_add_u32 s20, s20, s23
  s_add_u32 m0, s24, 65536
  s_add_u32 s19, s20, 0
  buffer_load_dwordx4 v2, s[4:7], s19 offen lds
  s_add_u32 m0, s24, 69632
  s_add_u32 s19, s20, 16384
  buffer_load_dwordx4 v2, s[4:7], s19 offen lds
  s_add_u32 m0, s24, 73728
  s_add_u32 s19, s20, 32768
  buffer_load_dwordx4 v2, s[4:7], s19 offen lds
  s_add_u32 m0, s24, 77824
  s_add_u32 s19, s20, 49152
  buffer_load_dwordx4 v2, s[4:7], s19 offen lds
  s_add_u32 m0, s24, 81920
  s_add_u32 s19, s20, 65536
  buffer_load_dwordx4 v2, s[4:7], s19 offen lds
  s_add_u32 m0, s24, 86016
  s_add_u32 s19, s20, 81920
  buffer_load_dwordx4 v2, s[4:7], s19 offen lds
  s_add_u32 m0, s24, 90112
  s_add_u32 s19, s20, 98304
  buffer_load_dwordx4 v2, s[4:7], s19 offen lds
  s_add_u32 m0, s24, 94208
  s_add_u32 s19, s20, 114688
  buffer_load_dwordx4 v2, s[4:7], s19 offen lds
  s_waitcnt vmcnt(16)
  s_barrier
  s_waitcnt vmcnt(8)
  s_barrier
  s_add_u32 s28, s26, 3
  s_and_b32 s28, s28, 7
  s_mul_i32 s20, s28, 131072
  s_add_u32 s20, s20, s23
  s_add_u32 m0, s24, 98304
  s_add_u32 s19, s20, 0
  buffer_load_dwordx4 v2, s[4:7], s19 offen lds
  s_add_u32 m0, s24, 102400
  s_add_u32 s19, s20, 16384
  buffer_load_dwordx4 v2, s[4:7], s19 offen lds
  s_add_u32 m0, s24, 106496
  s_add_u32 s19, s20, 32768
  buffer_load_dwordx4 v2, s[4:7], s19 offen lds
  s_add_u32 m0, s24, 110592
  s_add_u32 s19, s20, 49152
  buffer_load_dwordx4 v2, s[4:7], s19 offen lds
  s_add_u32 m0, s24, 114688
  s_add_u32 s19, s20, 65536
  buffer_load_dwordx4 v2, s[4:7], s19 offen lds
  s_add_u32 m0, s24, 118784
  s_add_u32 s19, s20, 81920
  buffer_load_dwordx4 v2, s[4:7], s19 offen lds
  s_add_u32 m0, s24, 122880
  s_add_u32 s19, s20, 98304
  buffer_load_dwordx4 v2, s[4:7], s19 offen lds
  s_add_u32 m0, s24, 126976
  s_add_u32 s19, s20, 114688
  buffer_load_dwordx4 v2, s[4:7], s19 offen lds
  s_add_u32 s28, s26, 4
  s_and_b32 s28, s28, 7
  s_mul_i32 s20, s28, 131072
  s_add_u32 s20, s20, s23
  s_add_u32 m0, s24, 0
  s_add_u32 s19, s20, 0
  buffer_load_dwordx4 v2, s[4:7], s19 offen lds
  s_add_u32 m0, s24, 4096
  s_add_u32 s19, s20, 16384
  buffer_load_dwordx4 v2, s[4:7], s19 offen lds
  s_add_u32 m0, s24, 8192
  s_add_u32 s19, s20, 32768
  buffer_load_dwordx4 v2, s[4:7], s19 offen lds
  s_add_u32 m0, s24, 12288
  s_add_u32 s19, s20, 49152
  buffer_load_dwordx4 v2, s[4:7], s19 offen lds
  s_add_u32 m0, s24, 16384
  s_add_u32 s19, s20, 65536
  buffer_load_dwordx4 v2, s[4:7], s19 offen lds
  s_add_u32 m0, s24, 20480
  s_add_u32 s19, s20, 81920
  buffer_load_dwordx4 v2, s[4:7], s19 offen lds
  s_add_u32 m0, s24, 24576
  s_add_u32 s19, s20, 98304
  buffer_load_dwordx4 v2, s[4:7], s19 offen lds
  s_add_u32 m0, s24, 28672
  s_add_u32 s19, s20, 114688
  buffer_load_dwordx4 v2, s[4:7], s19 offen lds
  s_waitcnt vmcnt(8)
  s_barrier
  s_add_u32 s28, s26, 5
  s_and_b32 s28, s28, 7
  s_mul_i32 s20, s28, 131072
  s_add_u32 s20, s20, s23
  s_add_u32 m0, s24, 32768
  s_add_u32 s19, s20, 0
  buffer_load_dwordx4 v2, s[4:7], s19 offen lds
  s_add_u32 m0, s24, 36864
  s_add_u32 s19, s20, 16384
  buffer_load_dwordx4 v2, s[4:7], s19 offen lds
  s_add_u32 m0, s24, 40960
  s_add_u32 s19, s20, 32768
  buffer_load_dwordx4 v2, s[4:7], s19 offen lds
  s_add_u32 m0, s24, 45056
  s_add_u32 s19, s20, 49152
  buffer_load_dwordx4 v2, s[4:7], s19 offen lds
  s_add_u32 m0, s24, 49152
  s_add_u32 s19, s20, 65536
  buffer_load_dwordx4 v2, s[4:7], s19 offen lds
  s_add_u32 m0, s24, 53248
  s_add_u32 s19, s20, 81920
  buffer_load_dwordx4 v2, s[4:7], s19 offen lds
  s_add_u32 m0, s24, 57344
  s_add_u32 s19, s20, 98304
  buffer_load_dwordx4 v2, s[4:7], s19 offen lds
  s_add_u32 m0, s24, 61440
  s_add_u32 s19, s20, 114688
  buffer_load_dwordx4 v2, s[4:7], s19 offen lds
  s_waitcnt vmcnt(8)
  s_barrier
  s_add_u32 s28, s26, 6
  s_and_b32 s28, s28, 7
  s_mul_i32 s20, s28, 131072
  s_add_u32 s20, s20, s23
  s_add_u32 m0, s24, 65536
  s_add_u32 s19, s20, 0
  buffer_load_dwordx4 v2, s[4:7], s19 offen lds
  s_add_u32 m0, s24, 69632
  s_add_u32 s19, s20, 16384
  buffer_load_dwordx4 v2, s[4:7], s19 offen lds
  s_add_u32 m0, s24, 73728
  s_add_u32 s19, s20, 32768
  buffer_load_dwordx4 v2, s[4:7], s19 offen lds
  s_add_u32 m0, s24, 77824
  s_add_u32 s19, s20, 49152
  buffer_load_dwordx4 v2, s[4:7], s19 offen lds
  s_add_u32 m0, s24, 81920
  s_add_u32 s19, s20, 65536
  buffer_load_dwordx4 v2, s[4:7], s19 offen lds
  s_add_u32 m0, s24, 86016
  s_add_u32 s19, s20, 81920
  buffer_load_dwordx4 v2, s[4:7], s19 offen lds
  s_add_u32 m0, s24, 90112
  s_add_u32 s19, s20, 98304
  buffer_load_dwordx4 v2, s[4:7], s19 offen lds
  s_add_u32 m0, s24, 94208
  s_add_u32 s19, s20, 114688
  buffer_load_dwordx4 v2, s[4:7], s19 offen lds
  s_waitcnt vmcnt(8)
  s_barrier
  s_add_u32 s28, s26, 7
  s_and_b32 s28, s28, 7
  s_mul_i32 s20, s28, 131072
  s_add_u32 s20, s20, s23
  s_add_u32 m0, s24, 98304
  s_add_u32 s19, s20, 0
  buffer_load_dwordx4 v2, s[4:7], s19 offen lds
  s_add_u32 m0, s24, 102400
  s_add_u32 s19, s20, 16384
  buffer_load_dwordx4 v2, s[4:7], s19 offen lds
  s_add_u32 m0, s24, 106496
  s_add_u32 s19, s20, 32768
  buffer_load_dwordx4 v2, s[4:7], s19 offen lds
  s_add_u32 m0, s24, 110592
  s_add_u32 s19, s20, 49152
  buffer_load_dwordx4 v2, s[4:7], s19 offen lds
  s_add_u32 m0, s24, 114688
  s_add_u32 s19, s20, 65536
  buffer_load_dwordx4 v2, s[4:7], s19 offen lds
  s_add_u32 m0, s24, 118784
  s_add_u32 s19, s20, 81920
  buffer_load_dwordx4 v2, s[4:7], s19 offen lds
  s_add_u32 m0, s24, 122880
  s_add_u32 s19, s20, 98304
  buffer_load_dwordx4 v2, s[4:7], s19 offen lds
  s_add_u32 m0, s24, 126976
  s_add_u32 s19, s20, 114688
  buffer_load_dwordx4 v2, s[4:7], s19 offen lds
  s_waitcnt vmcnt(8)
  s_barrier
  s_waitcnt vmcnt(0)
  s_barrier
  s_barrier
  s_branch sequential_preLN__compressed_kv_cla__dense_activation_squared_relu__prompt_kernel_p_t0
sequential_preLN__compressed_kv_cla__dense_activation_squared_relu__prompt_kernel_p_compute:
  s_sub_u32 s19, 15, s17
  s_min_u32 s19, s19, s17
  s_lshl_b32 s19, s19, 5
  s_lshl_b32 s20, s27, 3
  s_add_u32 s19, s19, s20
  v_and_b32 v9, 7, v0
  v_add_u32 v9, s19, v9
  v_lshlrev_b32 v9, 7, v9
  s_mov_b32 s21, 0x5240000
  s_mov_b32 s47, 0x40000
Lfsp_40:
  buffer_load_dword v10, v9, s[8:11], s21 offen sc1
  s_waitcnt vmcnt(0)
  v_cmp_eq_u32 vcc, 1, v10
  s_nop 3
  s_cmp_eq_u64 vcc, -1
  s_cbranch_scc1 Lfok_39
  s_sleep 3
  s_sub_u32 s47, s47, 1
  s_cbranch_scc0 Lfsp_40
Lfok_39:
  s_add_u32 s28, s26, 0
  s_and_b32 s28, s28, 7
  s_lshl_b32 s21, s28, 13
  s_add_u32 s21, s21, s22
  buffer_load_dwordx4 v[128:131], v1, s[8:11], s21 offen offset:0 sc1
  buffer_load_dwordx4 v[132:135], v1, s[8:11], s21 offen offset:1024 sc1
  buffer_load_dwordx4 v[136:139], v1, s[8:11], s21 offen offset:2048 sc1
  buffer_load_dwordx4 v[140:143], v1, s[8:11], s21 offen offset:3072 sc1
  s_add_u32 s21, s21, 4096
  buffer_load_dwordx4 v[144:147], v1, s[8:11], s21 offen offset:0 sc1
  buffer_load_dwordx4 v[148:151], v1, s[8:11], s21 offen offset:1024 sc1
  buffer_load_dwordx4 v[152:155], v1, s[8:11], s21 offen offset:2048 sc1
  buffer_load_dwordx4 v[156:159], v1, s[8:11], s21 offen offset:3072 sc1
  s_barrier
  ds_read_b64_tr_b16 v[16:17], v3 offset:0
  ds_read_b64_tr_b16 v[18:19], v3 offset:2048
  ds_read_b64_tr_b16 v[20:21], v3 offset:256
  ds_read_b64_tr_b16 v[22:23], v3 offset:2304
  ds_read_b64_tr_b16 v[24:25], v3 offset:512
  ds_read_b64_tr_b16 v[26:27], v3 offset:2560
  ds_read_b64_tr_b16 v[28:29], v3 offset:768
  ds_read_b64_tr_b16 v[30:31], v3 offset:2816
  ds_read_b64_tr_b16 v[32:33], v3 offset:4096
  ds_read_b64_tr_b16 v[34:35], v3 offset:6144
  ds_read_b64_tr_b16 v[36:37], v3 offset:4352
  ds_read_b64_tr_b16 v[38:39], v3 offset:6400
  ds_read_b64_tr_b16 v[40:41], v3 offset:4608
  ds_read_b64_tr_b16 v[42:43], v3 offset:6656
  s_waitcnt vmcnt(0)
  s_waitcnt lgkmcnt(10)
  v_mfma_f32_32x32x16_bf16 v[64:79], v[16:19], v[128:131], 0
  s_add_u32 s28, s26, 1
  s_and_b32 s28, s28, 7
  s_lshl_b32 s21, s28, 13
  s_add_u32 s21, s21, s22
  buffer_load_dwordx4 v[160:163], v1, s[8:11], s21 offen offset:0 sc1
  ds_read_b64_tr_b16 v[16:17], v3 offset:4864
  ds_read_b64_tr_b16 v[18:19], v3 offset:6912
  v_mfma_f32_32x32x16_bf16 v[80:95], v[20:23], v[128:131], 0
  buffer_load_dwordx4 v[164:167], v1, s[8:11], s21 offen offset:1024 sc1
  ds_read_b64_tr_b16 v[20:21], v3 offset:8192
  ds_read_b64_tr_b16 v[22:23], v3 offset:10240
  s_waitcnt lgkmcnt(10)
  v_mfma_f32_32x32x16_bf16 v[96:111], v[24:27], v[128:131], 0
  buffer_load_dwordx4 v[168:171], v1, s[8:11], s21 offen offset:2048 sc1
  ds_read_b64_tr_b16 v[24:25], v3 offset:8448
  ds_read_b64_tr_b16 v[26:27], v3 offset:10496
  v_mfma_f32_32x32x16_bf16 v[112:127], v[28:31], v[128:131], 0
  buffer_load_dwordx4 v[172:175], v1, s[8:11], s21 offen offset:3072 sc1
  ds_read_b64_tr_b16 v[28:29], v3 offset:8704
  ds_read_b64_tr_b16 v[30:31], v3 offset:10752
  s_waitcnt lgkmcnt(10)
  v_mfma_f32_32x32x16_bf16 v[64:79], v[32:35], v[132:135], v[64:79]
  s_add_u32 s21, s21, 4096
  buffer_load_dwordx4 v[176:179], v1, s[8:11], s21 offen offset:0 sc1
  ds_read_b64_tr_b16 v[32:33], v3 offset:8960
  ds_read_b64_tr_b16 v[34:35], v3 offset:11008
  v_mfma_f32_32x32x16_bf16 v[80:95], v[36:39], v[132:135], v[80:95]
  buffer_load_dwordx4 v[180:183], v1, s[8:11], s21 offen offset:1024 sc1
  ds_read_b64_tr_b16 v[36:37], v3 offset:12288
  ds_read_b64_tr_b16 v[38:39], v3 offset:14336
  s_waitcnt lgkmcnt(10)
  v_mfma_f32_32x32x16_bf16 v[96:111], v[40:43], v[132:135], v[96:111]
  buffer_load_dwordx4 v[184:187], v1, s[8:11], s21 offen offset:2048 sc1
  ds_read_b64_tr_b16 v[40:41], v3 offset:12544
  ds_read_b64_tr_b16 v[42:43], v3 offset:14592
  v_mfma_f32_32x32x16_bf16 v[112:127], v[16:19], v[132:135], v[112:127]
  buffer_load_dwordx4 v[188:191], v1, s[8:11], s21 offen offset:3072 sc1
  ds_read_b64_tr_b16 v[16:17], v3 offset:12800
  ds_read_b64_tr_b16 v[18:19], v3 offset:14848
  s_waitcnt lgkmcnt(10)
  v_mfma_f32_32x32x16_bf16 v[64:79], v[20:23], v[136:139], v[64:79]
  s_add_u32 s28, s26, 2
  s_and_b32 s28, s28, 7
  s_lshl_b32 s21, s28, 13
  s_add_u32 s21, s21, s22
  buffer_load_dwordx4 v[192:195], v1, s[8:11], s21 offen offset:0 sc1
  ds_read_b64_tr_b16 v[20:21], v3 offset:13056
  ds_read_b64_tr_b16 v[22:23], v3 offset:15104
  v_mfma_f32_32x32x16_bf16 v[80:95], v[24:27], v[136:139], v[80:95]
  buffer_load_dwordx4 v[196:199], v1, s[8:11], s21 offen offset:1024 sc1
  ds_read_b64_tr_b16 v[24:25], v3 offset:16384
  ds_read_b64_tr_b16 v[26:27], v3 offset:18432
  s_waitcnt lgkmcnt(10)
  v_mfma_f32_32x32x16_bf16 v[96:111], v[28:31], v[136:139], v[96:111]
  buffer_load_dwordx4 v[200:203], v1, s[8:11], s21 offen offset:2048 sc1
  ds_read_b64_tr_b16 v[28:29], v3 offset:16640
  ds_read_b64_tr_b16 v[30:31], v3 offset:18688
  v_mfma_f32_32x32x16_bf16 v[112:127], v[32:35], v[136:139], v[112:127]
  buffer_load_dwordx4 v[204:207], v1, s[8:11], s21 offen offset:3072 sc1
  ds_read_b64_tr_b16 v[32:33], v3 offset:16896
  ds_read_b64_tr_b16 v[34:35], v3 offset:18944
  s_waitcnt lgkmcnt(10)
  v_mfma_f32_32x32x16_bf16 v[64:79], v[36:39], v[140:143], v[64:79]
  ds_read_b64_tr_b16 v[36:37], v3 offset:17152
  ds_read_b64_tr_b16 v[38:39], v3 offset:19200
  v_mfma_f32_32x32x16_bf16 v[80:95], v[40:43], v[140:143], v[80:95]
  s_add_u32 s21, s21, 4096
  buffer_load_dwordx4 v[208:211], v1, s[8:11], s21 offen offset:0 sc1
  ds_read_b64_tr_b16 v[40:41], v3 offset:20480
  ds_read_b64_tr_b16 v[42:43], v3 offset:22528
  s_waitcnt lgkmcnt(10)
  v_mfma_f32_32x32x16_bf16 v[96:111], v[16:19], v[140:143], v[96:111]
  buffer_load_dwordx4 v[212:215], v1, s[8:11], s21 offen offset:1024 sc1
  ds_read_b64_tr_b16 v[16:17], v3 offset:20736
  ds_read_b64_tr_b16 v[18:19], v3 offset:22784
  v_mfma_f32_32x32x16_bf16 v[112:127], v[20:23], v[140:143], v[112:127]
  ds_read_b64_tr_b16 v[20:21], v3 offset:20992
  ds_read_b64_tr_b16 v[22:23], v3 offset:23040
  s_waitcnt lgkmcnt(10)
  v_mfma_f32_32x32x16_bf16 v[64:79], v[24:27], v[144:147], v[64:79]
  buffer_load_dwordx4 v[216:219], v1, s[8:11], s21 offen offset:2048 sc1
  ds_read_b64_tr_b16 v[24:25], v3 offset:21248
  ds_read_b64_tr_b16 v[26:27], v3 offset:23296
  v_mfma_f32_32x32x16_bf16 v[80:95], v[28:31], v[144:147], v[80:95]
  buffer_load_dwordx4 v[220:223], v1, s[8:11], s21 offen offset:3072 sc1
  ds_read_b64_tr_b16 v[28:29], v3 offset:24576
  ds_read_b64_tr_b16 v[30:31], v3 offset:26624
  s_waitcnt lgkmcnt(10)
  v_mfma_f32_32x32x16_bf16 v[96:111], v[32:35], v[144:147], v[96:111]
  ds_read_b64_tr_b16 v[32:33], v3 offset:24832
  ds_read_b64_tr_b16 v[34:35], v3 offset:26880
  v_mfma_f32_32x32x16_bf16 v[112:127], v[36:39], v[144:147], v[112:127]
  ds_read_b64_tr_b16 v[36:37], v3 offset:25088
  ds_read_b64_tr_b16 v[38:39], v3 offset:27136
  s_waitcnt lgkmcnt(10)
  v_mfma_f32_32x32x16_bf16 v[64:79], v[40:43], v[148:151], v[64:79]
  ds_read_b64_tr_b16 v[40:41], v3 offset:25344
  ds_read_b64_tr_b16 v[42:43], v3 offset:27392
  v_mfma_f32_32x32x16_bf16 v[80:95], v[16:19], v[148:151], v[80:95]
  ds_read_b64_tr_b16 v[16:17], v3 offset:28672
  ds_read_b64_tr_b16 v[18:19], v3 offset:30720
  s_waitcnt lgkmcnt(10)
  v_mfma_f32_32x32x16_bf16 v[96:111], v[20:23], v[148:151], v[96:111]
  ds_read_b64_tr_b16 v[20:21], v3 offset:28928
  ds_read_b64_tr_b16 v[22:23], v3 offset:30976
  v_mfma_f32_32x32x16_bf16 v[112:127], v[24:27], v[148:151], v[112:127]
  ds_read_b64_tr_b16 v[24:25], v3 offset:29184
  ds_read_b64_tr_b16 v[26:27], v3 offset:31232
  s_waitcnt lgkmcnt(10)
  v_mfma_f32_32x32x16_bf16 v[64:79], v[28:31], v[152:155], v[64:79]
  ds_read_b64_tr_b16 v[28:29], v3 offset:29440
  ds_read_b64_tr_b16 v[30:31], v3 offset:31488
  v_mfma_f32_32x32x16_bf16 v[80:95], v[32:35], v[152:155], v[80:95]
  s_waitcnt lgkmcnt(8)
  v_mfma_f32_32x32x16_bf16 v[96:111], v[36:39], v[152:155], v[96:111]
  v_mfma_f32_32x32x16_bf16 v[112:127], v[40:43], v[152:155], v[112:127]
  s_waitcnt lgkmcnt(4)
  v_mfma_f32_32x32x16_bf16 v[64:79], v[16:19], v[156:159], v[64:79]
  v_mfma_f32_32x32x16_bf16 v[80:95], v[20:23], v[156:159], v[80:95]
  s_waitcnt lgkmcnt(0)
  v_mfma_f32_32x32x16_bf16 v[96:111], v[24:27], v[156:159], v[96:111]
  v_mfma_f32_32x32x16_bf16 v[112:127], v[28:31], v[156:159], v[112:127]
  s_barrier
  ds_read_b64_tr_b16 v[32:33], v3 offset:32768
  ds_read_b64_tr_b16 v[34:35], v3 offset:34816
  ds_read_b64_tr_b16 v[36:37], v3 offset:33024
  ds_read_b64_tr_b16 v[38:39], v3 offset:35072
  ds_read_b64_tr_b16 v[40:41], v3 offset:33280
  ds_read_b64_tr_b16 v[42:43], v3 offset:35328
  ds_read_b64_tr_b16 v[16:17], v3 offset:33536
  ds_read_b64_tr_b16 v[18:19], v3 offset:35584
  ds_read_b64_tr_b16 v[20:21], v3 offset:36864
  ds_read_b64_tr_b16 v[22:23], v3 offset:38912
  ds_read_b64_tr_b16 v[24:25], v3 offset:37120
  ds_read_b64_tr_b16 v[26:27], v3 offset:39168
  ds_read_b64_tr_b16 v[28:29], v3 offset:37376
  ds_read_b64_tr_b16 v[30:31], v3 offset:39424
  s_waitcnt vmcnt(8)
  s_waitcnt lgkmcnt(10)
  v_mfma_f32_32x32x16_bf16 v[64:79], v[32:35], v[160:163], v[64:79]
  ds_read_b64_tr_b16 v[32:33], v3 offset:37632
  ds_read_b64_tr_b16 v[34:35], v3 offset:39680
  v_mfma_f32_32x32x16_bf16 v[80:95], v[36:39], v[160:163], v[80:95]
  ds_read_b64_tr_b16 v[36:37], v3 offset:40960
  ds_read_b64_tr_b16 v[38:39], v3 offset:43008
  s_waitcnt lgkmcnt(10)
  v_mfma_f32_32x32x16_bf16 v[96:111], v[40:43], v[160:163], v[96:111]
  s_add_u32 s28, s26, 3
  s_and_b32 s28, s28, 7
  s_lshl_b32 s21, s28, 13
  s_add_u32 s21, s21, s22
  buffer_load_dwordx4 v[224:227], v1, s[8:11], s21 offen offset:0 sc1
  ds_read_b64_tr_b16 v[40:41], v3 offset:41216
  ds_read_b64_tr_b16 v[42:43], v3 offset:43264
  v_mfma_f32_32x32x16_bf16 v[112:127], v[16:19], v[160:163], v[112:127]
  ds_read_b64_tr_b16 v[16:17], v3 offset:41472
  ds_read_b64_tr_b16 v[18:19], v3 offset:43520
  s_waitcnt lgkmcnt(10)
  v_mfma_f32_32x32x16_bf16 v[64:79], v[20:23], v[164:167], v[64:79]
  ds_read_b64_tr_b16 v[20:21], v3 offset:41728
  ds_read_b64_tr_b16 v[22:23], v3 offset:43776
  v_mfma_f32_32x32x16_bf16 v[80:95], v[24:27], v[164:167], v[80:95]
  buffer_load_dwordx4 v[228:231], v1, s[8:11], s21 offen offset:1024 sc1
  ds_read_b64_tr_b16 v[24:25], v3 offset:45056
  ds_read_b64_tr_b16 v[26:27], v3 offset:47104
  s_waitcnt lgkmcnt(10)
  v_mfma_f32_32x32x16_bf16 v[96:111], v[28:31], v[164:167], v[96:111]
  ds_read_b64_tr_b16 v[28:29], v3 offset:45312
  ds_read_b64_tr_b16 v[30:31], v3 offset:47360
  v_mfma_f32_32x32x16_bf16 v[112:127], v[32:35], v[164:167], v[112:127]
  ds_read_b64_tr_b16 v[32:33], v3 offset:45568
  ds_read_b64_tr_b16 v[34:35], v3 offset:47616
  s_waitcnt lgkmcnt(10)
  v_mfma_f32_32x32x16_bf16 v[64:79], v[36:39], v[168:171], v[64:79]
  buffer_load_dwordx4 v[232:235], v1, s[8:11], s21 offen offset:2048 sc1
  ds_read_b64_tr_b16 v[36:37], v3 offset:45824
  ds_read_b64_tr_b16 v[38:39], v3 offset:47872
  v_mfma_f32_32x32x16_bf16 v[80:95], v[40:43], v[168:171], v[80:95]
  ds_read_b64_tr_b16 v[40:41], v3 offset:49152
  ds_read_b64_tr_b16 v[42:43], v3 offset:51200
  s_waitcnt lgkmcnt(10)
  v_mfma_f32_32x32x16_bf16 v[96:111], v[16:19], v[168:171], v[96:111]
  ds_read_b64_tr_b16 v[16:17], v3 offset:49408
  ds_read_b64_tr_b16 v[18:19], v3 offset:51456
  v_mfma_f32_32x32x16_bf16 v[112:127], v[20:23], v[168:171], v[112:127]
  buffer_load_dwordx4 v[236:239], v1, s[8:11], s21 offen offset:3072 sc1
  ds_read_b64_tr_b16 v[20:21], v3 offset:49664
  ds_read_b64_tr_b16 v[22:23], v3 offset:51712
  s_waitcnt lgkmcnt(10)
  v_mfma_f32_32x32x16_bf16 v[64:79], v[24:27], v[172:175], v[64:79]
  ds_read_b64_tr_b16 v[24:25], v3 offset:49920
  ds_read_b64_tr_b16 v[26:27], v3 offset:51968
  v_mfma_f32_32x32x16_bf16 v[80:95], v[28:31], v[172:175], v[80:95]
  ds_read_b64_tr_b16 v[28:29], v3 offset:53248
  ds_read_b64_tr_b16 v[30:31], v3 offset:55296
  s_waitcnt lgkmcnt(10)
  v_mfma_f32_32x32x16_bf16 v[96:111], v[32:35], v[172:175], v[96:111]
  s_add_u32 s21, s21, 4096
  buffer_load_dwordx4 v[240:243], v1, s[8:11], s21 offen offset:0 sc1
  ds_read_b64_tr_b16 v[32:33], v3 offset:53504
  ds_read_b64_tr_b16 v[34:35], v3 offset:55552
  v_mfma_f32_32x32x16_bf16 v[112:127], v[36:39], v[172:175], v[112:127]
  ds_read_b64_tr_b16 v[36:37], v3 offset:53760
  ds_read_b64_tr_b16 v[38:39], v3 offset:55808
  s_waitcnt lgkmcnt(10)
  v_mfma_f32_32x32x16_bf16 v[64:79], v[40:43], v[176:179], v[64:79]
  ds_read_b64_tr_b16 v[40:41], v3 offset:54016
  ds_read_b64_tr_b16 v[42:43], v3 offset:56064
  v_mfma_f32_32x32x16_bf16 v[80:95], v[16:19], v[176:179], v[80:95]
  buffer_load_dwordx4 v[244:247], v1, s[8:11], s21 offen offset:1024 sc1
  ds_read_b64_tr_b16 v[16:17], v3 offset:57344
  ds_read_b64_tr_b16 v[18:19], v3 offset:59392
  s_waitcnt lgkmcnt(10)
  v_mfma_f32_32x32x16_bf16 v[96:111], v[20:23], v[176:179], v[96:111]
  ds_read_b64_tr_b16 v[20:21], v3 offset:57600
  ds_read_b64_tr_b16 v[22:23], v3 offset:59648
  v_mfma_f32_32x32x16_bf16 v[112:127], v[24:27], v[176:179], v[112:127]
  ds_read_b64_tr_b16 v[24:25], v3 offset:57856
  ds_read_b64_tr_b16 v[26:27], v3 offset:59904
  s_waitcnt lgkmcnt(10)
  v_mfma_f32_32x32x16_bf16 v[64:79], v[28:31], v[180:183], v[64:79]
  buffer_load_dwordx4 v[248:251], v1, s[8:11], s21 offen offset:2048 sc1
  ds_read_b64_tr_b16 v[28:29], v3 offset:58112
  ds_read_b64_tr_b16 v[30:31], v3 offset:60160
  v_mfma_f32_32x32x16_bf16 v[80:95], v[32:35], v[180:183], v[80:95]
  ds_read_b64_tr_b16 v[32:33], v3 offset:61440
  ds_read_b64_tr_b16 v[34:35], v3 offset:63488
  s_waitcnt lgkmcnt(10)
  v_mfma_f32_32x32x16_bf16 v[96:111], v[36:39], v[180:183], v[96:111]
  ds_read_b64_tr_b16 v[36:37], v3 offset:61696
  ds_read_b64_tr_b16 v[38:39], v3 offset:63744
  v_mfma_f32_32x32x16_bf16 v[112:127], v[40:43], v[180:183], v[112:127]
  buffer_load_dwordx4 v[252:255], v1, s[8:11], s21 offen offset:3072 sc1
  ds_read_b64_tr_b16 v[40:41], v3 offset:61952
  ds_read_b64_tr_b16 v[42:43], v3 offset:64000
  s_waitcnt lgkmcnt(10)
  v_mfma_f32_32x32x16_bf16 v[64:79], v[16:19], v[184:187], v[64:79]
  ds_read_b64_tr_b16 v[16:17], v3 offset:62208
  ds_read_b64_tr_b16 v[18:19], v3 offset:64256
  v_mfma_f32_32x32x16_bf16 v[80:95], v[20:23], v[184:187], v[80:95]
  s_waitcnt lgkmcnt(8)
  v_mfma_f32_32x32x16_bf16 v[96:111], v[24:27], v[184:187], v[96:111]
  v_mfma_f32_32x32x16_bf16 v[112:127], v[28:31], v[184:187], v[112:127]
  s_waitcnt lgkmcnt(4)
  v_mfma_f32_32x32x16_bf16 v[64:79], v[32:35], v[188:191], v[64:79]
  v_mfma_f32_32x32x16_bf16 v[80:95], v[36:39], v[188:191], v[80:95]
  s_waitcnt lgkmcnt(0)
  v_mfma_f32_32x32x16_bf16 v[96:111], v[40:43], v[188:191], v[96:111]
  v_mfma_f32_32x32x16_bf16 v[112:127], v[16:19], v[188:191], v[112:127]
  s_barrier
  ds_read_b64_tr_b16 v[20:21], v4 offset:0
  ds_read_b64_tr_b16 v[22:23], v4 offset:2048
  ds_read_b64_tr_b16 v[24:25], v4 offset:256
  ds_read_b64_tr_b16 v[26:27], v4 offset:2304
  ds_read_b64_tr_b16 v[28:29], v4 offset:512
  ds_read_b64_tr_b16 v[30:31], v4 offset:2560
  ds_read_b64_tr_b16 v[32:33], v4 offset:768
  ds_read_b64_tr_b16 v[34:35], v4 offset:2816
  ds_read_b64_tr_b16 v[36:37], v4 offset:4096
  ds_read_b64_tr_b16 v[38:39], v4 offset:6144
  ds_read_b64_tr_b16 v[40:41], v4 offset:4352
  ds_read_b64_tr_b16 v[42:43], v4 offset:6400
  ds_read_b64_tr_b16 v[16:17], v4 offset:4608
  ds_read_b64_tr_b16 v[18:19], v4 offset:6656
  s_waitcnt vmcnt(8)
  s_waitcnt lgkmcnt(10)
  v_mfma_f32_32x32x16_bf16 v[64:79], v[20:23], v[192:195], v[64:79]
  ds_read_b64_tr_b16 v[20:21], v4 offset:4864
  ds_read_b64_tr_b16 v[22:23], v4 offset:6912
  v_mfma_f32_32x32x16_bf16 v[80:95], v[24:27], v[192:195], v[80:95]
  ds_read_b64_tr_b16 v[24:25], v4 offset:8192
  ds_read_b64_tr_b16 v[26:27], v4 offset:10240
  s_waitcnt lgkmcnt(10)
  v_mfma_f32_32x32x16_bf16 v[96:111], v[28:31], v[192:195], v[96:111]
  s_add_u32 s28, s26, 4
  s_and_b32 s28, s28, 7
  s_lshl_b32 s21, s28, 13
  s_add_u32 s21, s21, s22
  buffer_load_dwordx4 v[128:131], v1, s[8:11], s21 offen offset:0 sc1
  ds_read_b64_tr_b16 v[28:29], v4 offset:8448
  ds_read_b64_tr_b16 v[30:31], v4 offset:10496
  v_mfma_f32_32x32x16_bf16 v[112:127], v[32:35], v[192:195], v[112:127]
  ds_read_b64_tr_b16 v[32:33], v4 offset:8704
  ds_read_b64_tr_b16 v[34:35], v4 offset:10752
  s_waitcnt lgkmcnt(10)
  v_mfma_f32_32x32x16_bf16 v[64:79], v[36:39], v[196:199], v[64:79]
  ds_read_b64_tr_b16 v[36:37], v4 offset:8960
  ds_read_b64_tr_b16 v[38:39], v4 offset:11008
  v_mfma_f32_32x32x16_bf16 v[80:95], v[40:43], v[196:199], v[80:95]
  buffer_load_dwordx4 v[132:135], v1, s[8:11], s21 offen offset:1024 sc1
  ds_read_b64_tr_b16 v[40:41], v4 offset:12288
  ds_read_b64_tr_b16 v[42:43], v4 offset:14336
  s_waitcnt lgkmcnt(10)
  v_mfma_f32_32x32x16_bf16 v[96:111], v[16:19], v[196:199], v[96:111]
  ds_read_b64_tr_b16 v[16:17], v4 offset:12544
  ds_read_b64_tr_b16 v[18:19], v4 offset:14592
  v_mfma_f32_32x32x16_bf16 v[112:127], v[20:23], v[196:199], v[112:127]
  ds_read_b64_tr_b16 v[20:21], v4 offset:12800
  ds_read_b64_tr_b16 v[22:23], v4 offset:14848
  s_waitcnt lgkmcnt(10)
  v_mfma_f32_32x32x16_bf16 v[64:79], v[24:27], v[200:203], v[64:79]
  buffer_load_dwordx4 v[136:139], v1, s[8:11], s21 offen offset:2048 sc1
  ds_read_b64_tr_b16 v[24:25], v4 offset:13056
  ds_read_b64_tr_b16 v[26:27], v4 offset:15104
  v_mfma_f32_32x32x16_bf16 v[80:95], v[28:31], v[200:203], v[80:95]
  ds_read_b64_tr_b16 v[28:29], v4 offset:16384
  ds_read_b64_tr_b16 v[30:31], v4 offset:18432
  s_waitcnt lgkmcnt(10)
  v_mfma_f32_32x32x16_bf16 v[96:111], v[32:35], v[200:203], v[96:111]
  ds_read_b64_tr_b16 v[32:33], v4 offset:16640
  ds_read_b64_tr_b16 v[34:35], v4 offset:18688
  v_mfma_f32_32x32x16_bf16 v[112:127], v[36:39], v[200:203], v[112:127]
  buffer_load_dwordx4 v[140:143], v1, s[8:11], s21 offen offset:3072 sc1
  ds_read_b64_tr_b16 v[36:37], v4 offset:16896
  ds_read_b64_tr_b16 v[38:39], v4 offset:18944
  s_waitcnt lgkmcnt(10)
  v_mfma_f32_32x32x16_bf16 v[64:79], v[40:43], v[204:207], v[64:79]
  ds_read_b64_tr_b16 v[40:41], v4 offset:17152
  ds_read_b64_tr_b16 v[42:43], v4 offset:19200
  v_mfma_f32_32x32x16_bf16 v[80:95], v[16:19], v[204:207], v[80:95]
  ds_read_b64_tr_b16 v[16:17], v4 offset:20480
  ds_read_b64_tr_b16 v[18:19], v4 offset:22528
  s_waitcnt lgkmcnt(10)
  v_mfma_f32_32x32x16_bf16 v[96:111], v[20:23], v[204:207], v[96:111]
  s_add_u32 s21, s21, 4096
  buffer_load_dwordx4 v[144:147], v1, s[8:11], s21 offen offset:0 sc1
  ds_read_b64_tr_b16 v[20:21], v4 offset:20736
  ds_read_b64_tr_b16 v[22:23], v4 offset:22784
  v_mfma_f32_32x32x16_bf16 v[112:127], v[24:27], v[204:207], v[112:127]
  ds_read_b64_tr_b16 v[24:25], v4 offset:20992
  ds_read_b64_tr_b16 v[26:27], v4 offset:23040
  s_waitcnt lgkmcnt(10)
  v_mfma_f32_32x32x16_bf16 v[64:79], v[28:31], v[208:211], v[64:79]
  ds_read_b64_tr_b16 v[28:29], v4 offset:21248
  ds_read_b64_tr_b16 v[30:31], v4 offset:23296
  v_mfma_f32_32x32x16_bf16 v[80:95], v[32:35], v[208:211], v[80:95]
  buffer_load_dwordx4 v[148:151], v1, s[8:11], s21 offen offset:1024 sc1
  ds_read_b64_tr_b16 v[32:33], v4 offset:24576
  ds_read_b64_tr_b16 v[34:35], v4 offset:26624
  s_waitcnt lgkmcnt(10)
  v_mfma_f32_32x32x16_bf16 v[96:111], v[36:39], v[208:211], v[96:111]
  ds_read_b64_tr_b16 v[36:37], v4 offset:24832
  ds_read_b64_tr_b16 v[38:39], v4 offset:26880
  v_mfma_f32_32x32x16_bf16 v[112:127], v[40:43], v[208:211], v[112:127]
  ds_read_b64_tr_b16 v[40:41], v4 offset:25088
  ds_read_b64_tr_b16 v[42:43], v4 offset:27136
  s_waitcnt lgkmcnt(10)
  v_mfma_f32_32x32x16_bf16 v[64:79], v[16:19], v[212:215], v[64:79]
  buffer_load_dwordx4 v[152:155], v1, s[8:11], s21 offen offset:2048 sc1
  ds_read_b64_tr_b16 v[16:17], v4 offset:25344
  ds_read_b64_tr_b16 v[18:19], v4 offset:27392
  v_mfma_f32_32x32x16_bf16 v[80:95], v[20:23], v[212:215], v[80:95]
  ds_read_b64_tr_b16 v[20:21], v4 offset:28672
  ds_read_b64_tr_b16 v[22:23], v4 offset:30720
  s_waitcnt lgkmcnt(10)
  v_mfma_f32_32x32x16_bf16 v[96:111], v[24:27], v[212:215], v[96:111]
  ds_read_b64_tr_b16 v[24:25], v4 offset:28928
  ds_read_b64_tr_b16 v[26:27], v4 offset:30976
  v_mfma_f32_32x32x16_bf16 v[112:127], v[28:31], v[212:215], v[112:127]
  buffer_load_dwordx4 v[156:159], v1, s[8:11], s21 offen offset:3072 sc1
  ds_read_b64_tr_b16 v[28:29], v4 offset:29184
  ds_read_b64_tr_b16 v[30:31], v4 offset:31232
  s_waitcnt lgkmcnt(10)
  v_mfma_f32_32x32x16_bf16 v[64:79], v[32:35], v[216:219], v[64:79]
  ds_read_b64_tr_b16 v[32:33], v4 offset:29440
  ds_read_b64_tr_b16 v[34:35], v4 offset:31488
  v_mfma_f32_32x32x16_bf16 v[80:95], v[36:39], v[216:219], v[80:95]
  ds_read_b64_tr_b16 v[36:37], v4 offset:32768
  ds_read_b64_tr_b16 v[38:39], v4 offset:34816
  s_waitcnt lgkmcnt(10)
  v_mfma_f32_32x32x16_bf16 v[96:111], v[40:43], v[216:219], v[96:111]
  ds_read_b64_tr_b16 v[40:41], v4 offset:33024
  ds_read_b64_tr_b16 v[42:43], v4 offset:35072
  v_mfma_f32_32x32x16_bf16 v[112:127], v[16:19], v[216:219], v[112:127]
  ds_read_b64_tr_b16 v[16:17], v4 offset:33280
  ds_read_b64_tr_b16 v[18:19], v4 offset:35328
  s_waitcnt lgkmcnt(10)
  v_mfma_f32_32x32x16_bf16 v[64:79], v[20:23], v[220:223], v[64:79]
  ds_read_b64_tr_b16 v[20:21], v4 offset:33536
  ds_read_b64_tr_b16 v[22:23], v4 offset:35584
  v_mfma_f32_32x32x16_bf16 v[80:95], v[24:27], v[220:223], v[80:95]
  ds_read_b64_tr_b16 v[24:25], v4 offset:36864
  ds_read_b64_tr_b16 v[26:27], v4 offset:38912
  s_waitcnt lgkmcnt(10)
  v_mfma_f32_32x32x16_bf16 v[96:111], v[28:31], v[220:223], v[96:111]
  ds_read_b64_tr_b16 v[28:29], v4 offset:37120
  ds_read_b64_tr_b16 v[30:31], v4 offset:39168
  v_mfma_f32_32x32x16_bf16 v[112:127], v[32:35], v[220:223], v[112:127]
  s_barrier
  ds_read_b64_tr_b16 v[32:33], v4 offset:37376
  ds_read_b64_tr_b16 v[34:35], v4 offset:39424
  s_waitcnt vmcnt(8)
  s_waitcnt lgkmcnt(10)
  v_mfma_f32_32x32x16_bf16 v[64:79], v[36:39], v[224:227], v[64:79]
  ds_read_b64_tr_b16 v[36:37], v4 offset:37632
  ds_read_b64_tr_b16 v[38:39], v4 offset:39680
  v_mfma_f32_32x32x16_bf16 v[80:95], v[40:43], v[224:227], v[80:95]
  ds_read_b64_tr_b16 v[40:41], v4 offset:40960
  ds_read_b64_tr_b16 v[42:43], v4 offset:43008
  s_waitcnt lgkmcnt(10)
  v_mfma_f32_32x32x16_bf16 v[96:111], v[16:19], v[224:227], v[96:111]
  s_add_u32 s28, s26, 5
  s_and_b32 s28, s28, 7
  s_lshl_b32 s21, s28, 13
  s_add_u32 s21, s21, s22
  buffer_load_dwordx4 v[160:163], v1, s[8:11], s21 offen offset:0 sc1
  ds_read_b64_tr_b16 v[16:17], v4 offset:41216
  ds_read_b64_tr_b16 v[18:19], v4 offset:43264
  v_mfma_f32_32x32x16_bf16 v[112:127], v[20:23], v[224:227], v[112:127]
  ds_read_b64_tr_b16 v[20:21], v4 offset:41472
  ds_read_b64_tr_b16 v[22:23], v4 offset:43520
  s_waitcnt lgkmcnt(10)
  v_mfma_f32_32x32x16_bf16 v[64:79], v[24:27], v[228:231], v[64:79]
  ds_read_b64_tr_b16 v[24:25], v4 offset:41728
  ds_read_b64_tr_b16 v[26:27], v4 offset:43776
  v_mfma_f32_32x32x16_bf16 v[80:95], v[28:31], v[228:231], v[80:95]
  buffer_load_dwordx4 v[164:167], v1, s[8:11], s21 offen offset:1024 sc1
  ds_read_b64_tr_b16 v[28:29], v4 offset:45056
  ds_read_b64_tr_b16 v[30:31], v4 offset:47104
  s_waitcnt lgkmcnt(10)
  v_mfma_f32_32x32x16_bf16 v[96:111], v[32:35], v[228:231], v[96:111]
  ds_read_b64_tr_b16 v[32:33], v4 offset:45312
  ds_read_b64_tr_b16 v[34:35], v4 offset:47360
  v_mfma_f32_32x32x16_bf16 v[112:127], v[36:39], v[228:231], v[112:127]
  ds_read_b64_tr_b16 v[36:37], v4 offset:45568
  ds_read_b64_tr_b16 v[38:39], v4 offset:47616
  s_waitcnt lgkmcnt(10)
  v_mfma_f32_32x32x16_bf16 v[64:79], v[40:43], v[232:235], v[64:79]
  buffer_load_dwordx4 v[168:171], v1, s[8:11], s21 offen offset:2048 sc1
  ds_read_b64_tr_b16 v[40:41], v4 offset:45824
  ds_read_b64_tr_b16 v[42:43], v4 offset:47872
  v_mfma_f32_32x32x16_bf16 v[80:95], v[16:19], v[232:235], v[80:95]
  ds_read_b64_tr_b16 v[16:17], v4 offset:49152
  ds_read_b64_tr_b16 v[18:19], v4 offset:51200
  s_waitcnt lgkmcnt(10)
  v_mfma_f32_32x32x16_bf16 v[96:111], v[20:23], v[232:235], v[96:111]
  ds_read_b64_tr_b16 v[20:21], v4 offset:49408
  ds_read_b64_tr_b16 v[22:23], v4 offset:51456
  v_mfma_f32_32x32x16_bf16 v[112:127], v[24:27], v[232:235], v[112:127]
  buffer_load_dwordx4 v[172:175], v1, s[8:11], s21 offen offset:3072 sc1
  ds_read_b64_tr_b16 v[24:25], v4 offset:49664
  ds_read_b64_tr_b16 v[26:27], v4 offset:51712
  s_waitcnt lgkmcnt(10)
  v_mfma_f32_32x32x16_bf16 v[64:79], v[28:31], v[236:239], v[64:79]
  ds_read_b64_tr_b16 v[28:29], v4 offset:49920
  ds_read_b64_tr_b16 v[30:31], v4 offset:51968
  v_mfma_f32_32x32x16_bf16 v[80:95], v[32:35], v[236:239], v[80:95]
  ds_read_b64_tr_b16 v[32:33], v4 offset:53248
  ds_read_b64_tr_b16 v[34:35], v4 offset:55296
  s_waitcnt lgkmcnt(10)
  v_mfma_f32_32x32x16_bf16 v[96:111], v[36:39], v[236:239], v[96:111]
  s_add_u32 s21, s21, 4096
  buffer_load_dwordx4 v[176:179], v1, s[8:11], s21 offen offset:0 sc1
  ds_read_b64_tr_b16 v[36:37], v4 offset:53504
  ds_read_b64_tr_b16 v[38:39], v4 offset:55552
  v_mfma_f32_32x32x16_bf16 v[112:127], v[40:43], v[236:239], v[112:127]
  ds_read_b64_tr_b16 v[40:41], v4 offset:53760
  ds_read_b64_tr_b16 v[42:43], v4 offset:55808
  s_waitcnt lgkmcnt(10)
  v_mfma_f32_32x32x16_bf16 v[64:79], v[16:19], v[240:243], v[64:79]
  ds_read_b64_tr_b16 v[16:17], v4 offset:54016
  ds_read_b64_tr_b16 v[18:19], v4 offset:56064
  v_mfma_f32_32x32x16_bf16 v[80:95], v[20:23], v[240:243], v[80:95]
  buffer_load_dwordx4 v[180:183], v1, s[8:11], s21 offen offset:1024 sc1
  ds_read_b64_tr_b16 v[20:21], v4 offset:57344
  ds_read_b64_tr_b16 v[22:23], v4 offset:59392
  s_waitcnt lgkmcnt(10)
  v_mfma_f32_32x32x16_bf16 v[96:111], v[24:27], v[240:243], v[96:111]
  ds_read_b64_tr_b16 v[24:25], v4 offset:57600
  ds_read_b64_tr_b16 v[26:27], v4 offset:59648
  v_mfma_f32_32x32x16_bf16 v[112:127], v[28:31], v[240:243], v[112:127]
  ds_read_b64_tr_b16 v[28:29], v4 offset:57856
  ds_read_b64_tr_b16 v[30:31], v4 offset:59904
  s_waitcnt lgkmcnt(10)
  v_mfma_f32_32x32x16_bf16 v[64:79], v[32:35], v[244:247], v[64:79]
  buffer_load_dwordx4 v[184:187], v1, s[8:11], s21 offen offset:2048 sc1
  ds_read_b64_tr_b16 v[32:33], v4 offset:58112
  ds_read_b64_tr_b16 v[34:35], v4 offset:60160
  v_mfma_f32_32x32x16_bf16 v[80:95], v[36:39], v[244:247], v[80:95]
  ds_read_b64_tr_b16 v[36:37], v4 offset:61440
  ds_read_b64_tr_b16 v[38:39], v4 offset:63488
  s_waitcnt lgkmcnt(10)
  v_mfma_f32_32x32x16_bf16 v[96:111], v[40:43], v[244:247], v[96:111]
  ds_read_b64_tr_b16 v[40:41], v4 offset:61696
  ds_read_b64_tr_b16 v[42:43], v4 offset:63744
  v_mfma_f32_32x32x16_bf16 v[112:127], v[16:19], v[244:247], v[112:127]
  buffer_load_dwordx4 v[188:191], v1, s[8:11], s21 offen offset:3072 sc1
  ds_read_b64_tr_b16 v[16:17], v4 offset:61952
  ds_read_b64_tr_b16 v[18:19], v4 offset:64000
  s_waitcnt lgkmcnt(10)
  v_mfma_f32_32x32x16_bf16 v[64:79], v[20:23], v[248:251], v[64:79]
  ds_read_b64_tr_b16 v[20:21], v4 offset:62208
  ds_read_b64_tr_b16 v[22:23], v4 offset:64256
  v_mfma_f32_32x32x16_bf16 v[80:95], v[24:27], v[248:251], v[80:95]
  ds_read_b64_tr_b16 v[24:25], v3 offset:0
  ds_read_b64_tr_b16 v[26:27], v3 offset:2048
  s_waitcnt lgkmcnt(10)
  v_mfma_f32_32x32x16_bf16 v[96:111], v[28:31], v[248:251], v[96:111]
  ds_read_b64_tr_b16 v[28:29], v3 offset:256
  ds_read_b64_tr_b16 v[30:31], v3 offset:2304
  v_mfma_f32_32x32x16_bf16 v[112:127], v[32:35], v[248:251], v[112:127]
  ds_read_b64_tr_b16 v[32:33], v3 offset:512
  ds_read_b64_tr_b16 v[34:35], v3 offset:2560
  s_waitcnt lgkmcnt(10)
  v_mfma_f32_32x32x16_bf16 v[64:79], v[36:39], v[252:255], v[64:79]
  ds_read_b64_tr_b16 v[36:37], v3 offset:768
  ds_read_b64_tr_b16 v[38:39], v3 offset:2816
  v_mfma_f32_32x32x16_bf16 v[80:95], v[40:43], v[252:255], v[80:95]
  ds_read_b64_tr_b16 v[40:41], v3 offset:4096
  ds_read_b64_tr_b16 v[42:43], v3 offset:6144
  s_waitcnt lgkmcnt(10)
  v_mfma_f32_32x32x16_bf16 v[96:111], v[16:19], v[252:255], v[96:111]
  ds_read_b64_tr_b16 v[16:17], v3 offset:4352
  ds_read_b64_tr_b16 v[18:19], v3 offset:6400
  v_mfma_f32_32x32x16_bf16 v[112:127], v[20:23], v[252:255], v[112:127]
  s_barrier
  ds_read_b64_tr_b16 v[20:21], v3 offset:4608
  ds_read_b64_tr_b16 v[22:23], v3 offset:6656
  s_waitcnt vmcnt(8)
  s_waitcnt lgkmcnt(10)
  v_mfma_f32_32x32x16_bf16 v[64:79], v[24:27], v[128:131], v[64:79]
  ds_read_b64_tr_b16 v[24:25], v3 offset:4864
  ds_read_b64_tr_b16 v[26:27], v3 offset:6912
  v_mfma_f32_32x32x16_bf16 v[80:95], v[28:31], v[128:131], v[80:95]
  ds_read_b64_tr_b16 v[28:29], v3 offset:8192
  ds_read_b64_tr_b16 v[30:31], v3 offset:10240
  s_waitcnt lgkmcnt(10)
  v_mfma_f32_32x32x16_bf16 v[96:111], v[32:35], v[128:131], v[96:111]
  s_add_u32 s28, s26, 6
  s_and_b32 s28, s28, 7
  s_lshl_b32 s21, s28, 13
  s_add_u32 s21, s21, s22
  buffer_load_dwordx4 v[192:195], v1, s[8:11], s21 offen offset:0 sc1
  ds_read_b64_tr_b16 v[32:33], v3 offset:8448
  ds_read_b64_tr_b16 v[34:35], v3 offset:10496
  v_mfma_f32_32x32x16_bf16 v[112:127], v[36:39], v[128:131], v[112:127]
  ds_read_b64_tr_b16 v[36:37], v3 offset:8704
  ds_read_b64_tr_b16 v[38:39], v3 offset:10752
  s_waitcnt lgkmcnt(10)
  v_mfma_f32_32x32x16_bf16 v[64:79], v[40:43], v[132:135], v[64:79]
  ds_read_b64_tr_b16 v[40:41], v3 offset:8960
  ds_read_b64_tr_b16 v[42:43], v3 offset:11008
  v_mfma_f32_32x32x16_bf16 v[80:95], v[16:19], v[132:135], v[80:95]
  buffer_load_dwordx4 v[196:199], v1, s[8:11], s21 offen offset:1024 sc1
  ds_read_b64_tr_b16 v[16:17], v3 offset:12288
  ds_read_b64_tr_b16 v[18:19], v3 offset:14336
  s_waitcnt lgkmcnt(10)
  v_mfma_f32_32x32x16_bf16 v[96:111], v[20:23], v[132:135], v[96:111]
  ds_read_b64_tr_b16 v[20:21], v3 offset:12544
  ds_read_b64_tr_b16 v[22:23], v3 offset:14592
  v_mfma_f32_32x32x16_bf16 v[112:127], v[24:27], v[132:135], v[112:127]
  ds_read_b64_tr_b16 v[24:25], v3 offset:12800
  ds_read_b64_tr_b16 v[26:27], v3 offset:14848
  s_waitcnt lgkmcnt(10)
  v_mfma_f32_32x32x16_bf16 v[64:79], v[28:31], v[136:139], v[64:79]
  buffer_load_dwordx4 v[200:203], v1, s[8:11], s21 offen offset:2048 sc1
  ds_read_b64_tr_b16 v[28:29], v3 offset:13056
  ds_read_b64_tr_b16 v[30:31], v3 offset:15104
  v_mfma_f32_32x32x16_bf16 v[80:95], v[32:35], v[136:139], v[80:95]
  ds_read_b64_tr_b16 v[32:33], v3 offset:16384
  ds_read_b64_tr_b16 v[34:35], v3 offset:18432
  s_waitcnt lgkmcnt(10)
  v_mfma_f32_32x32x16_bf16 v[96:111], v[36:39], v[136:139], v[96:111]
  ds_read_b64_tr_b16 v[36:37], v3 offset:16640
  ds_read_b64_tr_b16 v[38:39], v3 offset:18688
  v_mfma_f32_32x32x16_bf16 v[112:127], v[40:43], v[136:139], v[112:127]
  buffer_load_dwordx4 v[204:207], v1, s[8:11], s21 offen offset:3072 sc1
  ds_read_b64_tr_b16 v[40:41], v3 offset:16896
  ds_read_b64_tr_b16 v[42:43], v3 offset:18944
  s_waitcnt lgkmcnt(10)
  v_mfma_f32_32x32x16_bf16 v[64:79], v[16:19], v[140:143], v[64:79]
  ds_read_b64_tr_b16 v[16:17], v3 offset:17152
  ds_read_b64_tr_b16 v[18:19], v3 offset:19200
  v_mfma_f32_32x32x16_bf16 v[80:95], v[20:23], v[140:143], v[80:95]
  ds_read_b64_tr_b16 v[20:21], v3 offset:20480
  ds_read_b64_tr_b16 v[22:23], v3 offset:22528
  s_waitcnt lgkmcnt(10)
  v_mfma_f32_32x32x16_bf16 v[96:111], v[24:27], v[140:143], v[96:111]
  s_add_u32 s21, s21, 4096
  buffer_load_dwordx4 v[208:211], v1, s[8:11], s21 offen offset:0 sc1
  ds_read_b64_tr_b16 v[24:25], v3 offset:20736
  ds_read_b64_tr_b16 v[26:27], v3 offset:22784
  v_mfma_f32_32x32x16_bf16 v[112:127], v[28:31], v[140:143], v[112:127]
  ds_read_b64_tr_b16 v[28:29], v3 offset:20992
  ds_read_b64_tr_b16 v[30:31], v3 offset:23040
  s_waitcnt lgkmcnt(10)
  v_mfma_f32_32x32x16_bf16 v[64:79], v[32:35], v[144:147], v[64:79]
  ds_read_b64_tr_b16 v[32:33], v3 offset:21248
  ds_read_b64_tr_b16 v[34:35], v3 offset:23296
  v_mfma_f32_32x32x16_bf16 v[80:95], v[36:39], v[144:147], v[80:95]
  buffer_load_dwordx4 v[212:215], v1, s[8:11], s21 offen offset:1024 sc1
  ds_read_b64_tr_b16 v[36:37], v3 offset:24576
  ds_read_b64_tr_b16 v[38:39], v3 offset:26624
  s_waitcnt lgkmcnt(10)
  v_mfma_f32_32x32x16_bf16 v[96:111], v[40:43], v[144:147], v[96:111]
  ds_read_b64_tr_b16 v[40:41], v3 offset:24832
  ds_read_b64_tr_b16 v[42:43], v3 offset:26880
  v_mfma_f32_32x32x16_bf16 v[112:127], v[16:19], v[144:147], v[112:127]
  ds_read_b64_tr_b16 v[16:17], v3 offset:25088
  ds_read_b64_tr_b16 v[18:19], v3 offset:27136
  s_waitcnt lgkmcnt(10)
  v_mfma_f32_32x32x16_bf16 v[64:79], v[20:23], v[148:151], v[64:79]
  buffer_load_dwordx4 v[216:219], v1, s[8:11], s21 offen offset:2048 sc1
  ds_read_b64_tr_b16 v[20:21], v3 offset:25344
  ds_read_b64_tr_b16 v[22:23], v3 offset:27392
  v_mfma_f32_32x32x16_bf16 v[80:95], v[24:27], v[148:151], v[80:95]
  ds_read_b64_tr_b16 v[24:25], v3 offset:28672
  ds_read_b64_tr_b16 v[26:27], v3 offset:30720
  s_waitcnt lgkmcnt(10)
  v_mfma_f32_32x32x16_bf16 v[96:111], v[28:31], v[148:151], v[96:111]
  ds_read_b64_tr_b16 v[28:29], v3 offset:28928
  ds_read_b64_tr_b16 v[30:31], v3 offset:30976
  v_mfma_f32_32x32x16_bf16 v[112:127], v[32:35], v[148:151], v[112:127]
  buffer_load_dwordx4 v[220:223], v1, s[8:11], s21 offen offset:3072 sc1
  ds_read_b64_tr_b16 v[32:33], v3 offset:29184
  ds_read_b64_tr_b16 v[34:35], v3 offset:31232
  s_waitcnt lgkmcnt(10)
  v_mfma_f32_32x32x16_bf16 v[64:79], v[36:39], v[152:155], v[64:79]
  ds_read_b64_tr_b16 v[36:37], v3 offset:29440
  ds_read_b64_tr_b16 v[38:39], v3 offset:31488
  v_mfma_f32_32x32x16_bf16 v[80:95], v[40:43], v[152:155], v[80:95]
  ds_read_b64_tr_b16 v[40:41], v3 offset:32768
  ds_read_b64_tr_b16 v[42:43], v3 offset:34816
  s_waitcnt lgkmcnt(10)
  v_mfma_f32_32x32x16_bf16 v[96:111], v[16:19], v[152:155], v[96:111]
  ds_read_b64_tr_b16 v[16:17], v3 offset:33024
  ds_read_b64_tr_b16 v[18:19], v3 offset:35072
  v_mfma_f32_32x32x16_bf16 v[112:127], v[20:23], v[152:155], v[112:127]
  ds_read_b64_tr_b16 v[20:21], v3 offset:33280
  ds_read_b64_tr_b16 v[22:23], v3 offset:35328
  s_waitcnt lgkmcnt(10)
  v_mfma_f32_32x32x16_bf16 v[64:79], v[24:27], v[156:159], v[64:79]
  ds_read_b64_tr_b16 v[24:25], v3 offset:33536
  ds_read_b64_tr_b16 v[26:27], v3 offset:35584
  v_mfma_f32_32x32x16_bf16 v[80:95], v[28:31], v[156:159], v[80:95]
  ds_read_b64_tr_b16 v[28:29], v3 offset:36864
  ds_read_b64_tr_b16 v[30:31], v3 offset:38912
  s_waitcnt lgkmcnt(10)
  v_mfma_f32_32x32x16_bf16 v[96:111], v[32:35], v[156:159], v[96:111]
  ds_read_b64_tr_b16 v[32:33], v3 offset:37120
  ds_read_b64_tr_b16 v[34:35], v3 offset:39168
  v_mfma_f32_32x32x16_bf16 v[112:127], v[36:39], v[156:159], v[112:127]
  s_barrier
  ds_read_b64_tr_b16 v[36:37], v3 offset:37376
  ds_read_b64_tr_b16 v[38:39], v3 offset:39424
  s_waitcnt vmcnt(8)
  s_waitcnt lgkmcnt(10)
  v_mfma_f32_32x32x16_bf16 v[64:79], v[40:43], v[160:163], v[64:79]
  ds_read_b64_tr_b16 v[40:41], v3 offset:37632
  ds_read_b64_tr_b16 v[42:43], v3 offset:39680
  v_mfma_f32_32x32x16_bf16 v[80:95], v[16:19], v[160:163], v[80:95]
  ds_read_b64_tr_b16 v[16:17], v3 offset:40960
  ds_read_b64_tr_b16 v[18:19], v3 offset:43008
  s_waitcnt lgkmcnt(10)
  v_mfma_f32_32x32x16_bf16 v[96:111], v[20:23], v[160:163], v[96:111]
  s_add_u32 s28, s26, 7
  s_and_b32 s28, s28, 7
  s_lshl_b32 s21, s28, 13
  s_add_u32 s21, s21, s22
  buffer_load_dwordx4 v[224:227], v1, s[8:11], s21 offen offset:0 sc1
  ds_read_b64_tr_b16 v[20:21], v3 offset:41216
  ds_read_b64_tr_b16 v[22:23], v3 offset:43264
  v_mfma_f32_32x32x16_bf16 v[112:127], v[24:27], v[160:163], v[112:127]
  ds_read_b64_tr_b16 v[24:25], v3 offset:41472
  ds_read_b64_tr_b16 v[26:27], v3 offset:43520
  s_waitcnt lgkmcnt(10)
  v_mfma_f32_32x32x16_bf16 v[64:79], v[28:31], v[164:167], v[64:79]
  ds_read_b64_tr_b16 v[28:29], v3 offset:41728
  ds_read_b64_tr_b16 v[30:31], v3 offset:43776
  v_mfma_f32_32x32x16_bf16 v[80:95], v[32:35], v[164:167], v[80:95]
  buffer_load_dwordx4 v[228:231], v1, s[8:11], s21 offen offset:1024 sc1
  ds_read_b64_tr_b16 v[32:33], v3 offset:45056
  ds_read_b64_tr_b16 v[34:35], v3 offset:47104
  s_waitcnt lgkmcnt(10)
  v_mfma_f32_32x32x16_bf16 v[96:111], v[36:39], v[164:167], v[96:111]
  ds_read_b64_tr_b16 v[36:37], v3 offset:45312
  ds_read_b64_tr_b16 v[38:39], v3 offset:47360
  v_mfma_f32_32x32x16_bf16 v[112:127], v[40:43], v[164:167], v[112:127]
  ds_read_b64_tr_b16 v[40:41], v3 offset:45568
  ds_read_b64_tr_b16 v[42:43], v3 offset:47616
  s_waitcnt lgkmcnt(10)
  v_mfma_f32_32x32x16_bf16 v[64:79], v[16:19], v[168:171], v[64:79]
  buffer_load_dwordx4 v[232:235], v1, s[8:11], s21 offen offset:2048 sc1
  ds_read_b64_tr_b16 v[16:17], v3 offset:45824
  ds_read_b64_tr_b16 v[18:19], v3 offset:47872
  v_mfma_f32_32x32x16_bf16 v[80:95], v[20:23], v[168:171], v[80:95]
  ds_read_b64_tr_b16 v[20:21], v3 offset:49152
  ds_read_b64_tr_b16 v[22:23], v3 offset:51200
  s_waitcnt lgkmcnt(10)
  v_mfma_f32_32x32x16_bf16 v[96:111], v[24:27], v[168:171], v[96:111]
  ds_read_b64_tr_b16 v[24:25], v3 offset:49408
  ds_read_b64_tr_b16 v[26:27], v3 offset:51456
  v_mfma_f32_32x32x16_bf16 v[112:127], v[28:31], v[168:171], v[112:127]
  buffer_load_dwordx4 v[236:239], v1, s[8:11], s21 offen offset:3072 sc1
  ds_read_b64_tr_b16 v[28:29], v3 offset:49664
  ds_read_b64_tr_b16 v[30:31], v3 offset:51712
  s_waitcnt lgkmcnt(10)
  v_mfma_f32_32x32x16_bf16 v[64:79], v[32:35], v[172:175], v[64:79]
  ds_read_b64_tr_b16 v[32:33], v3 offset:49920
  ds_read_b64_tr_b16 v[34:35], v3 offset:51968
  v_mfma_f32_32x32x16_bf16 v[80:95], v[36:39], v[172:175], v[80:95]
  ds_read_b64_tr_b16 v[36:37], v3 offset:53248
  ds_read_b64_tr_b16 v[38:39], v3 offset:55296
  s_waitcnt lgkmcnt(10)
  v_mfma_f32_32x32x16_bf16 v[96:111], v[40:43], v[172:175], v[96:111]
  s_add_u32 s21, s21, 4096
  buffer_load_dwordx4 v[240:243], v1, s[8:11], s21 offen offset:0 sc1
  ds_read_b64_tr_b16 v[40:41], v3 offset:53504
  ds_read_b64_tr_b16 v[42:43], v3 offset:55552
  v_mfma_f32_32x32x16_bf16 v[112:127], v[16:19], v[172:175], v[112:127]
  ds_read_b64_tr_b16 v[16:17], v3 offset:53760
  ds_read_b64_tr_b16 v[18:19], v3 offset:55808
  s_waitcnt lgkmcnt(10)
  v_mfma_f32_32x32x16_bf16 v[64:79], v[20:23], v[176:179], v[64:79]
  ds_read_b64_tr_b16 v[20:21], v3 offset:54016
  ds_read_b64_tr_b16 v[22:23], v3 offset:56064
  v_mfma_f32_32x32x16_bf16 v[80:95], v[24:27], v[176:179], v[80:95]
  buffer_load_dwordx4 v[244:247], v1, s[8:11], s21 offen offset:1024 sc1
  ds_read_b64_tr_b16 v[24:25], v3 offset:57344
  ds_read_b64_tr_b16 v[26:27], v3 offset:59392
  s_waitcnt lgkmcnt(10)
  v_mfma_f32_32x32x16_bf16 v[96:111], v[28:31], v[176:179], v[96:111]
  ds_read_b64_tr_b16 v[28:29], v3 offset:57600
  ds_read_b64_tr_b16 v[30:31], v3 offset:59648
  v_mfma_f32_32x32x16_bf16 v[112:127], v[32:35], v[176:179], v[112:127]
  ds_read_b64_tr_b16 v[32:33], v3 offset:57856
  ds_read_b64_tr_b16 v[34:35], v3 offset:59904
  s_waitcnt lgkmcnt(10)
  v_mfma_f32_32x32x16_bf16 v[64:79], v[36:39], v[180:183], v[64:79]
  buffer_load_dwordx4 v[248:251], v1, s[8:11], s21 offen offset:2048 sc1
  ds_read_b64_tr_b16 v[36:37], v3 offset:58112
  ds_read_b64_tr_b16 v[38:39], v3 offset:60160
  v_mfma_f32_32x32x16_bf16 v[80:95], v[40:43], v[180:183], v[80:95]
  ds_read_b64_tr_b16 v[40:41], v3 offset:61440
  ds_read_b64_tr_b16 v[42:43], v3 offset:63488
  s_waitcnt lgkmcnt(10)
  v_mfma_f32_32x32x16_bf16 v[96:111], v[16:19], v[180:183], v[96:111]
  ds_read_b64_tr_b16 v[16:17], v3 offset:61696
  ds_read_b64_tr_b16 v[18:19], v3 offset:63744
  v_mfma_f32_32x32x16_bf16 v[112:127], v[20:23], v[180:183], v[112:127]
  buffer_load_dwordx4 v[252:255], v1, s[8:11], s21 offen offset:3072 sc1
  ds_read_b64_tr_b16 v[20:21], v3 offset:61952
  ds_read_b64_tr_b16 v[22:23], v3 offset:64000
  s_waitcnt lgkmcnt(10)
  v_mfma_f32_32x32x16_bf16 v[64:79], v[24:27], v[184:187], v[64:79]
  ds_read_b64_tr_b16 v[24:25], v3 offset:62208
  ds_read_b64_tr_b16 v[26:27], v3 offset:64256
  v_mfma_f32_32x32x16_bf16 v[80:95], v[28:31], v[184:187], v[80:95]
  ds_read_b64_tr_b16 v[28:29], v4 offset:0
  ds_read_b64_tr_b16 v[30:31], v4 offset:2048
  s_waitcnt lgkmcnt(10)
  v_mfma_f32_32x32x16_bf16 v[96:111], v[32:35], v[184:187], v[96:111]
  ds_read_b64_tr_b16 v[32:33], v4 offset:256
  ds_read_b64_tr_b16 v[34:35], v4 offset:2304
  v_mfma_f32_32x32x16_bf16 v[112:127], v[36:39], v[184:187], v[112:127]
  ds_read_b64_tr_b16 v[36:37], v4 offset:512
  ds_read_b64_tr_b16 v[38:39], v4 offset:2560
  s_waitcnt lgkmcnt(10)
  v_mfma_f32_32x32x16_bf16 v[64:79], v[40:43], v[188:191], v[64:79]
  ds_read_b64_tr_b16 v[40:41], v4 offset:768
  ds_read_b64_tr_b16 v[42:43], v4 offset:2816
  v_mfma_f32_32x32x16_bf16 v[80:95], v[16:19], v[188:191], v[80:95]
  ds_read_b64_tr_b16 v[16:17], v4 offset:4096
  ds_read_b64_tr_b16 v[18:19], v4 offset:6144
  s_waitcnt lgkmcnt(10)
  v_mfma_f32_32x32x16_bf16 v[96:111], v[20:23], v[188:191], v[96:111]
  ds_read_b64_tr_b16 v[20:21], v4 offset:4352
  ds_read_b64_tr_b16 v[22:23], v4 offset:6400
  v_mfma_f32_32x32x16_bf16 v[112:127], v[24:27], v[188:191], v[112:127]
  s_barrier
  ds_read_b64_tr_b16 v[24:25], v4 offset:4608
  ds_read_b64_tr_b16 v[26:27], v4 offset:6656
  s_waitcnt vmcnt(8)
  s_waitcnt lgkmcnt(10)
  v_mfma_f32_32x32x16_bf16 v[64:79], v[28:31], v[192:195], v[64:79]
  ds_read_b64_tr_b16 v[28:29], v4 offset:4864
  ds_read_b64_tr_b16 v[30:31], v4 offset:6912
  v_mfma_f32_32x32x16_bf16 v[80:95], v[32:35], v[192:195], v[80:95]
  ds_read_b64_tr_b16 v[32:33], v4 offset:8192
  ds_read_b64_tr_b16 v[34:35], v4 offset:10240
  s_waitcnt lgkmcnt(10)
  v_mfma_f32_32x32x16_bf16 v[96:111], v[36:39], v[192:195], v[96:111]
  ds_read_b64_tr_b16 v[36:37], v4 offset:8448
  ds_read_b64_tr_b16 v[38:39], v4 offset:10496
  v_mfma_f32_32x32x16_bf16 v[112:127], v[40:43], v[192:195], v[112:127]
  ds_read_b64_tr_b16 v[40:41], v4 offset:8704
  ds_read_b64_tr_b16 v[42:43], v4 offset:10752
  s_waitcnt lgkmcnt(10)
  v_mfma_f32_32x32x16_bf16 v[64:79], v[16:19], v[196:199], v[64:79]
  ds_read_b64_tr_b16 v[16:17], v4 offset:8960
  ds_read_b64_tr_b16 v[18:19], v4 offset:11008
  v_mfma_f32_32x32x16_bf16 v[80:95], v[20:23], v[196:199], v[80:95]
  ds_read_b64_tr_b16 v[20:21], v4 offset:12288
  ds_read_b64_tr_b16 v[22:23], v4 offset:14336
  s_waitcnt lgkmcnt(10)
  v_mfma_f32_32x32x16_bf16 v[96:111], v[24:27], v[196:199], v[96:111]
  ds_read_b64_tr_b16 v[24:25], v4 offset:12544
  ds_read_b64_tr_b16 v[26:27], v4 offset:14592
  v_mfma_f32_32x32x16_bf16 v[112:127], v[28:31], v[196:199], v[112:127]
  ds_read_b64_tr_b16 v[28:29], v4 offset:12800
  ds_read_b64_tr_b16 v[30:31], v4 offset:14848
  s_waitcnt lgkmcnt(10)
  v_mfma_f32_32x32x16_bf16 v[64:79], v[32:35], v[200:203], v[64:79]
  ds_read_b64_tr_b16 v[32:33], v4 offset:13056
  ds_read_b64_tr_b16 v[34:35], v4 offset:15104
  v_mfma_f32_32x32x16_bf16 v[80:95], v[36:39], v[200:203], v[80:95]
  ds_read_b64_tr_b16 v[36:37], v4 offset:16384
  ds_read_b64_tr_b16 v[38:39], v4 offset:18432
  s_waitcnt lgkmcnt(10)
  v_mfma_f32_32x32x16_bf16 v[96:111], v[40:43], v[200:203], v[96:111]
  ds_read_b64_tr_b16 v[40:41], v4 offset:16640
  ds_read_b64_tr_b16 v[42:43], v4 offset:18688
  v_mfma_f32_32x32x16_bf16 v[112:127], v[16:19], v[200:203], v[112:127]
  ds_read_b64_tr_b16 v[16:17], v4 offset:16896
  ds_read_b64_tr_b16 v[18:19], v4 offset:18944
  s_waitcnt lgkmcnt(10)
  v_mfma_f32_32x32x16_bf16 v[64:79], v[20:23], v[204:207], v[64:79]
  ds_read_b64_tr_b16 v[20:21], v4 offset:17152
  ds_read_b64_tr_b16 v[22:23], v4 offset:19200
  v_mfma_f32_32x32x16_bf16 v[80:95], v[24:27], v[204:207], v[80:95]
  ds_read_b64_tr_b16 v[24:25], v4 offset:20480
  ds_read_b64_tr_b16 v[26:27], v4 offset:22528
  s_waitcnt lgkmcnt(10)
  v_mfma_f32_32x32x16_bf16 v[96:111], v[28:31], v[204:207], v[96:111]
  ds_read_b64_tr_b16 v[28:29], v4 offset:20736
  ds_read_b64_tr_b16 v[30:31], v4 offset:22784
  v_mfma_f32_32x32x16_bf16 v[112:127], v[32:35], v[204:207], v[112:127]
  ds_read_b64_tr_b16 v[32:33], v4 offset:20992
  ds_read_b64_tr_b16 v[34:35], v4 offset:23040
  s_waitcnt lgkmcnt(10)
  v_mfma_f32_32x32x16_bf16 v[64:79], v[36:39], v[208:211], v[64:79]
  ds_read_b64_tr_b16 v[36:37], v4 offset:21248
  ds_read_b64_tr_b16 v[38:39], v4 offset:23296
  v_mfma_f32_32x32x16_bf16 v[80:95], v[40:43], v[208:211], v[80:95]
  ds_read_b64_tr_b16 v[40:41], v4 offset:24576
  ds_read_b64_tr_b16 v[42:43], v4 offset:26624
  s_waitcnt lgkmcnt(10)
  v_mfma_f32_32x32x16_bf16 v[96:111], v[16:19], v[208:211], v[96:111]
  ds_read_b64_tr_b16 v[16:17], v4 offset:24832
  ds_read_b64_tr_b16 v[18:19], v4 offset:26880
  v_mfma_f32_32x32x16_bf16 v[112:127], v[20:23], v[208:211], v[112:127]
  ds_read_b64_tr_b16 v[20:21], v4 offset:25088
  ds_read_b64_tr_b16 v[22:23], v4 offset:27136
  s_waitcnt lgkmcnt(10)
  v_mfma_f32_32x32x16_bf16 v[64:79], v[24:27], v[212:215], v[64:79]
  ds_read_b64_tr_b16 v[24:25], v4 offset:25344
  ds_read_b64_tr_b16 v[26:27], v4 offset:27392
  v_mfma_f32_32x32x16_bf16 v[80:95], v[28:31], v[212:215], v[80:95]
  ds_read_b64_tr_b16 v[28:29], v4 offset:28672
  ds_read_b64_tr_b16 v[30:31], v4 offset:30720
  s_waitcnt lgkmcnt(10)
  v_mfma_f32_32x32x16_bf16 v[96:111], v[32:35], v[212:215], v[96:111]
  ds_read_b64_tr_b16 v[32:33], v4 offset:28928
  ds_read_b64_tr_b16 v[34:35], v4 offset:30976
  v_mfma_f32_32x32x16_bf16 v[112:127], v[36:39], v[212:215], v[112:127]
  ds_read_b64_tr_b16 v[36:37], v4 offset:29184
  ds_read_b64_tr_b16 v[38:39], v4 offset:31232
  s_waitcnt lgkmcnt(10)
  v_mfma_f32_32x32x16_bf16 v[64:79], v[40:43], v[216:219], v[64:79]
  ds_read_b64_tr_b16 v[40:41], v4 offset:29440
  ds_read_b64_tr_b16 v[42:43], v4 offset:31488
  v_mfma_f32_32x32x16_bf16 v[80:95], v[16:19], v[216:219], v[80:95]
  ds_read_b64_tr_b16 v[16:17], v4 offset:32768
  ds_read_b64_tr_b16 v[18:19], v4 offset:34816
  s_waitcnt lgkmcnt(10)
  v_mfma_f32_32x32x16_bf16 v[96:111], v[20:23], v[216:219], v[96:111]
  ds_read_b64_tr_b16 v[20:21], v4 offset:36864
  ds_read_b64_tr_b16 v[22:23], v4 offset:38912
  v_mfma_f32_32x32x16_bf16 v[112:127], v[24:27], v[216:219], v[112:127]
  ds_read_b64_tr_b16 v[24:25], v4 offset:40960
  ds_read_b64_tr_b16 v[26:27], v4 offset:43008
  s_waitcnt lgkmcnt(10)
  v_mfma_f32_32x32x16_bf16 v[64:79], v[28:31], v[220:223], v[64:79]
  ds_read_b64_tr_b16 v[28:29], v4 offset:45056
  ds_read_b64_tr_b16 v[30:31], v4 offset:47104
  v_mfma_f32_32x32x16_bf16 v[80:95], v[32:35], v[220:223], v[80:95]
  ds_read_b64_tr_b16 v[32:33], v4 offset:49152
  ds_read_b64_tr_b16 v[34:35], v4 offset:51200
  s_waitcnt lgkmcnt(10)
  v_mfma_f32_32x32x16_bf16 v[96:111], v[36:39], v[220:223], v[96:111]
  ds_read_b64_tr_b16 v[36:37], v4 offset:53248
  ds_read_b64_tr_b16 v[38:39], v4 offset:55296
  v_mfma_f32_32x32x16_bf16 v[112:127], v[40:43], v[220:223], v[112:127]
  s_barrier
  s_lshl_b32 s48, s27, 6
  s_add_u32 s48, s48, s25
  s_lshl_b32 s48, s48, 15
  s_lshl_b32 s49, s18, 13
  s_add_u32 s48, s48, s49
  s_add_u32 s48, s48, 0x4600000
  s_add_u32 s49, s48, 4096
  ds_read_b64_tr_b16 v[40:41], v4 offset:57344
  ds_read_b64_tr_b16 v[42:43], v4 offset:59392
  s_waitcnt vmcnt(0)
  s_waitcnt lgkmcnt(10)
  v_mfma_f32_32x32x16_bf16 v[64:79], v[16:19], v[224:227], v[64:79]
  ds_read_b64_tr_b16 v[16:17], v4 offset:61440
  ds_read_b64_tr_b16 v[18:19], v4 offset:63488
  v_mfma_f32_32x32x16_bf16 v[64:79], v[20:23], v[228:231], v[64:79]
  ds_read_b64_tr_b16 v[20:21], v4 offset:33024
  ds_read_b64_tr_b16 v[22:23], v4 offset:35072
  s_waitcnt lgkmcnt(10)
  v_mfma_f32_32x32x16_bf16 v[64:79], v[24:27], v[232:235], v[64:79]
  ds_read_b64_tr_b16 v[24:25], v4 offset:37120
  ds_read_b64_tr_b16 v[26:27], v4 offset:39168
  v_mfma_f32_32x32x16_bf16 v[64:79], v[28:31], v[236:239], v[64:79]
  ds_read_b64_tr_b16 v[28:29], v4 offset:41216
  ds_read_b64_tr_b16 v[30:31], v4 offset:43264
  s_waitcnt lgkmcnt(10)
  v_mfma_f32_32x32x16_bf16 v[64:79], v[32:35], v[240:243], v[64:79]
  ds_read_b64_tr_b16 v[32:33], v4 offset:45312
  ds_read_b64_tr_b16 v[34:35], v4 offset:47360
  v_mfma_f32_32x32x16_bf16 v[64:79], v[36:39], v[244:247], v[64:79]
  ds_read_b64_tr_b16 v[36:37], v4 offset:49408
  ds_read_b64_tr_b16 v[38:39], v4 offset:51456
  s_waitcnt lgkmcnt(10)
  v_mfma_f32_32x32x16_bf16 v[64:79], v[40:43], v[248:251], v[64:79]
  ds_read_b64_tr_b16 v[40:41], v4 offset:53504
  ds_read_b64_tr_b16 v[42:43], v4 offset:55552
  v_mfma_f32_32x32x16_bf16 v[64:79], v[16:19], v[252:255], v[64:79]
  ds_read_b64_tr_b16 v[16:17], v4 offset:57600
  ds_read_b64_tr_b16 v[18:19], v4 offset:59648
  s_waitcnt lgkmcnt(10)
  v_mfma_f32_32x32x16_bf16 v[80:95], v[20:23], v[224:227], v[80:95]
  ds_read_b64_tr_b16 v[20:21], v4 offset:61696
  ds_read_b64_tr_b16 v[22:23], v4 offset:63744
  v_mfma_f32_32x32x16_bf16 v[80:95], v[24:27], v[228:231], v[80:95]
  ds_read_b64_tr_b16 v[24:25], v4 offset:33280
  ds_read_b64_tr_b16 v[26:27], v4 offset:35328
  s_waitcnt lgkmcnt(10)
  v_mfma_f32_32x32x16_bf16 v[80:95], v[28:31], v[232:235], v[80:95]
  ds_read_b64_tr_b16 v[28:29], v4 offset:37376
  ds_read_b64_tr_b16 v[30:31], v4 offset:39424
  v_mfma_f32_32x32x16_bf16 v[80:95], v[32:35], v[236:239], v[80:95]
  s_nop 3
  v_cvt_pk_bf16_f32 v64, v64, v65
  v_cvt_pk_bf16_f32 v65, v66, v67
  ds_read_b64_tr_b16 v[32:33], v4 offset:41472
  ds_read_b64_tr_b16 v[34:35], v4 offset:43520
  s_waitcnt lgkmcnt(10)
  v_mfma_f32_32x32x16_bf16 v[80:95], v[36:39], v[240:243], v[80:95]
  v_cvt_pk_bf16_f32 v66, v68, v69
  v_cvt_pk_bf16_f32 v67, v70, v71
  buffer_store_dwordx4 v[64:67], v1, s[8:11], s48 offen offset:0 sc1
  ds_read_b64_tr_b16 v[36:37], v4 offset:45568
  ds_read_b64_tr_b16 v[38:39], v4 offset:47616
  v_mfma_f32_32x32x16_bf16 v[80:95], v[40:43], v[244:247], v[80:95]
  v_cvt_pk_bf16_f32 v72, v72, v73
  v_cvt_pk_bf16_f32 v73, v74, v75
  v_cvt_pk_bf16_f32 v74, v76, v77
  ds_read_b64_tr_b16 v[40:41], v4 offset:49664
  ds_read_b64_tr_b16 v[42:43], v4 offset:51712
  s_waitcnt lgkmcnt(10)
  v_mfma_f32_32x32x16_bf16 v[80:95], v[16:19], v[248:251], v[80:95]
  v_cvt_pk_bf16_f32 v75, v78, v79
  buffer_store_dwordx4 v[72:75], v1, s[8:11], s48 offen offset:1024 sc1
  ds_read_b64_tr_b16 v[16:17], v4 offset:53760
  ds_read_b64_tr_b16 v[18:19], v4 offset:55808
  v_mfma_f32_32x32x16_bf16 v[80:95], v[20:23], v[252:255], v[80:95]
  ds_read_b64_tr_b16 v[20:21], v4 offset:57856
  ds_read_b64_tr_b16 v[22:23], v4 offset:59904
  s_waitcnt lgkmcnt(10)
  v_mfma_f32_32x32x16_bf16 v[96:111], v[24:27], v[224:227], v[96:111]
  ds_read_b64_tr_b16 v[24:25], v4 offset:61952
  ds_read_b64_tr_b16 v[26:27], v4 offset:64000
  v_mfma_f32_32x32x16_bf16 v[96:111], v[28:31], v[228:231], v[96:111]
  ds_read_b64_tr_b16 v[28:29], v4 offset:33536
  ds_read_b64_tr_b16 v[30:31], v4 offset:35584
  s_waitcnt lgkmcnt(10)
  v_mfma_f32_32x32x16_bf16 v[96:111], v[32:35], v[232:235], v[96:111]
  ds_read_b64_tr_b16 v[32:33], v4 offset:37632
  ds_read_b64_tr_b16 v[34:35], v4 offset:39680
  v_mfma_f32_32x32x16_bf16 v[96:111], v[36:39], v[236:239], v[96:111]
  s_nop 3
  v_cvt_pk_bf16_f32 v80, v80, v81
  v_cvt_pk_bf16_f32 v81, v82, v83
  ds_read_b64_tr_b16 v[36:37], v4 offset:41728
  ds_read_b64_tr_b16 v[38:39], v4 offset:43776
  s_waitcnt lgkmcnt(10)
  v_mfma_f32_32x32x16_bf16 v[96:111], v[40:43], v[240:243], v[96:111]
  v_cvt_pk_bf16_f32 v82, v84, v85
  v_cvt_pk_bf16_f32 v83, v86, v87
  buffer_store_dwordx4 v[80:83], v1, s[8:11], s48 offen offset:2048 sc1
  ds_read_b64_tr_b16 v[40:41], v4 offset:45824
  ds_read_b64_tr_b16 v[42:43], v4 offset:47872
  v_mfma_f32_32x32x16_bf16 v[96:111], v[16:19], v[244:247], v[96:111]
  v_cvt_pk_bf16_f32 v88, v88, v89
  v_cvt_pk_bf16_f32 v89, v90, v91
  v_cvt_pk_bf16_f32 v90, v92, v93
  ds_read_b64_tr_b16 v[16:17], v4 offset:49920
  ds_read_b64_tr_b16 v[18:19], v4 offset:51968
  s_waitcnt lgkmcnt(10)
  v_mfma_f32_32x32x16_bf16 v[96:111], v[20:23], v[248:251], v[96:111]
  v_cvt_pk_bf16_f32 v91, v94, v95
  buffer_store_dwordx4 v[88:91], v1, s[8:11], s48 offen offset:3072 sc1
  ds_read_b64_tr_b16 v[20:21], v4 offset:54016
  ds_read_b64_tr_b16 v[22:23], v4 offset:56064
  v_mfma_f32_32x32x16_bf16 v[96:111], v[24:27], v[252:255], v[96:111]
  ds_read_b64_tr_b16 v[24:25], v4 offset:58112
  ds_read_b64_tr_b16 v[26:27], v4 offset:60160
  s_waitcnt lgkmcnt(10)
  v_mfma_f32_32x32x16_bf16 v[112:127], v[28:31], v[224:227], v[112:127]
  ds_read_b64_tr_b16 v[28:29], v4 offset:62208
  ds_read_b64_tr_b16 v[30:31], v4 offset:64256
  v_mfma_f32_32x32x16_bf16 v[112:127], v[32:35], v[228:231], v[112:127]
  s_waitcnt lgkmcnt(8)
  v_mfma_f32_32x32x16_bf16 v[112:127], v[36:39], v[232:235], v[112:127]
  v_mfma_f32_32x32x16_bf16 v[112:127], v[40:43], v[236:239], v[112:127]
  s_nop 3
  v_cvt_pk_bf16_f32 v96, v96, v97
  v_cvt_pk_bf16_f32 v97, v98, v99
  s_waitcnt lgkmcnt(4)
  v_mfma_f32_32x32x16_bf16 v[112:127], v[16:19], v[240:243], v[112:127]
  v_cvt_pk_bf16_f32 v98, v100, v101
  v_cvt_pk_bf16_f32 v99, v102, v103
  buffer_store_dwordx4 v[96:99], v1, s[8:11], s49 offen offset:0 sc1
  v_mfma_f32_32x32x16_bf16 v[112:127], v[20:23], v[244:247], v[112:127]
  v_cvt_pk_bf16_f32 v104, v104, v105
  v_cvt_pk_bf16_f32 v105, v106, v107
  v_cvt_pk_bf16_f32 v106, v108, v109
  s_waitcnt lgkmcnt(0)
  v_mfma_f32_32x32x16_bf16 v[112:127], v[24:27], v[248:251], v[112:127]
  v_cvt_pk_bf16_f32 v107, v110, v111
  buffer_store_dwordx4 v[104:107], v1, s[8:11], s49 offen offset:1024 sc1
  v_mfma_f32_32x32x16_bf16 v[112:127], v[28:31], v[252:255], v[112:127]
  s_nop 7
  s_nop 3
  v_cvt_pk_bf16_f32 v112, v112, v113
  v_cvt_pk_bf16_f32 v113, v114, v115
  v_cvt_pk_bf16_f32 v114, v116, v117
  v_cvt_pk_bf16_f32 v115, v118, v119
  buffer_store_dwordx4 v[112:115], v1, s[8:11], s49 offen offset:2048 sc1
  v_cvt_pk_bf16_f32 v120, v120, v121
  v_cvt_pk_bf16_f32 v121, v122, v123
  v_cvt_pk_bf16_f32 v122, v124, v125
  v_cvt_pk_bf16_f32 v123, v126, v127
  buffer_store_dwordx4 v[120:123], v1, s[8:11], s49 offen offset:3072 sc1
  s_waitcnt vmcnt(0)
sequential_preLN__compressed_kv_cla__dense_activation_squared_relu__prompt_kernel_p_t0:
  s_barrier
  s_cmp_lg_u32 s46, 0
  s_cbranch_scc1 Lf1_41
  s_lshl_b32 s21, s2, 7
  s_add_u32 s21, s21, 0x5230000
  v_mov_b32 v5, 1
  s_mov_b64 exec, 1
  buffer_store_dword v5, off, s[8:11], s21 sc1
  s_mov_b64 exec, -1
Lf1_41:
  s_load_dwordx4 s[4:7], s[0:1], 56
  s_load_dwordx2 s[8:9], s[0:1], 104
  s_load_dwordx2 s[40:41], s[0:1], 0
  s_mov_b32 s16, s46
  s_lshr_b32 s29, s16, 2
  s_and_b32 s16, s16, 3
  s_bfe_u32 s17, s2, 0x20001
  s_lshl_b32 s17, s17, 2
  s_bfe_u32 s19, s2, 0x20003
  s_add_u32 s17, s17, s19
  s_and_b32 s18, s2, 1
  s_mul_i32 s18, s18, 7
  s_lshr_b32 s19, s2, 5
  s_add_u32 s18, s18, s19
  s_and_b32 s26, s19, 3
  v_lshlrev_b32 v1, 4, v0
  v_lshrrev_b32 v8, 5, v0
  v_bfe_u32 v5, v0, 2, 2
  s_movk_i32 s19, 3584
  v_mul_lo_u32 v2, v5, s19
  v_lshrrev_b32 v5, 4, v0
  v_lshl_add_u32 v2, v5, 6, v2
  v_and_b32 v5, 3, v0
  v_lshl_add_u32 v2, v5, 4, v2
  v_lshlrev_b32 v3, 10, v8
  v_bfe_u32 v5, v0, 2, 2
  v_lshl_add_u32 v3, v5, 6, v3
  v_bfe_u32 v5, v0, 4, 1
  v_lshl_add_u32 v3, v5, 5, v3
  v_and_b32 v5, 3, v0
  v_lshl_add_u32 v3, v5, 3, v3
  v_add_u32 v4, 0x10000, v3
  s_waitcnt lgkmcnt(0)
  s_mov_b32 s12, s6
  s_mov_b32 s13, s7
  s_mov_b32 s14, 0xe00
  s_mov_b32 s15, 0x20000
  s_mov_b32 s6, 0x1c0000
  s_mov_b32 s7, 0x20000
  s_mov_b32 s10, 0x10000000
  s_mov_b32 s11, 0x20000
  s_mov_b32 s42, 0x200000
  s_mov_b32 s43, 0x20000
  s_lshl_b32 s25, s17, 2
  s_add_u32 s25, s25, s16
  s_lshl_b32 s22, s25, 15
  s_add_u32 s22, s22, 0x4400000
  s_mov_b32 s23, 0
  s_mul_i32 s19, s16, 14336
  s_add_u32 s23, s23, s19
  s_lshl_b32 s19, s18, 8
  s_add_u32 s23, s23, s19
  s_lshl_b32 s24, s16, 10
  s_cmp_eq_u32 s29, 0
  s_cbranch_scc1 sequential_preLN__compressed_kv_cla__dense_activation_squared_relu__prompt_kernel_b_compute
  s_cmp_lt_u32 s2, 224
  s_cbranch_scc1 Ltile_42
  s_barrier
  s_barrier
  s_barrier
  s_barrier
  s_branch sequential_preLN__compressed_kv_cla__dense_activation_squared_relu__prompt_kernel_b_t1
Ltile_42:
  s_add_u32 s28, s26, 0
  s_and_b32 s28, s28, 3
  s_mul_i32 s20, s28, 458752
  s_add_u32 s20, s20, s23
  s_add_u32 m0, s24, 0
  s_add_u32 s19, s20, 0
  buffer_load_dwordx4 v2, s[4:7], s19 offen lds
  s_add_u32 m0, s24, 4096
  s_add_u32 s19, s20, 57344
  buffer_load_dwordx4 v2, s[4:7], s19 offen lds
  s_add_u32 m0, s24, 8192
  s_add_u32 s19, s20, 114688
  buffer_load_dwordx4 v2, s[4:7], s19 offen lds
  s_add_u32 m0, s24, 12288
  s_add_u32 s19, s20, 172032
  buffer_load_dwordx4 v2, s[4:7], s19 offen lds
  s_add_u32 m0, s24, 16384
  s_add_u32 s19, s20, 229376
  buffer_load_dwordx4 v2, s[4:7], s19 offen lds
  s_add_u32 m0, s24, 20480
  s_add_u32 s19, s20, 286720
  buffer_load_dwordx4 v2, s[4:7], s19 offen lds
  s_add_u32 m0, s24, 24576
  s_add_u32 s19, s20, 344064
  buffer_load_dwordx4 v2, s[4:7], s19 offen lds
  s_add_u32 m0, s24, 28672
  s_add_u32 s19, s20, 401408
  buffer_load_dwordx4 v2, s[4:7], s19 offen lds
  v_lshlrev_b32 v5, 2, v0
  s_lshl_b32 s19, s18, 8
  s_mov_b32 m0, 131072
  s_nop 0
  buffer_load_dword v5, s[12:15], s19 offen lds
  s_add_u32 s28, s26, 1
  s_and_b32 s28, s28, 3
  s_mul_i32 s20, s28, 458752
  s_add_u32 s20, s20, s23
  s_add_u32 m0, s24, 32768
  s_add_u32 s19, s20, 0
  buffer_load_dwordx4 v2, s[4:7], s19 offen lds
  s_add_u32 m0, s24, 36864
  s_add_u32 s19, s20, 57344
  buffer_load_dwordx4 v2, s[4:7], s19 offen lds
  s_add_u32 m0, s24, 40960
  s_add_u32 s19, s20, 114688
  buffer_load_dwordx4 v2, s[4:7], s19 offen lds
  s_add_u32 m0, s24, 45056
  s_add_u32 s19, s20, 172032
  buffer_load_dwordx4 v2, s[4:7], s19 offen lds
  s_add_u32 m0, s24, 49152
  s_add_u32 s19, s20, 229376
  buffer_load_dwordx4 v2, s[4:7], s19 offen lds
  s_add_u32 m0, s24, 53248
  s_add_u32 s19, s20, 286720
  buffer_load_dwordx4 v2, s[4:7], s19 offen lds
  s_add_u32 m0, s24, 57344
  s_add_u32 s19, s20, 344064
  buffer_load_dwordx4 v2, s[4:7], s19 offen lds
  s_add_u32 m0, s24, 61440
  s_add_u32 s19, s20, 401408
  buffer_load_dwordx4 v2, s[4:7], s19 offen lds
  s_barrier
  s_barrier
  s_barrier
  s_barrier
  s_add_u32 s28, s26, 2
  s_and_b32 s28, s28, 3
  s_mul_i32 s20, s28, 458752
  s_add_u32 s20, s20, s23
  s_add_u32 m0, s24, 65536
  s_add_u32 s19, s20, 0
  buffer_load_dwordx4 v2, s[4:7], s19 offen lds
  s_add_u32 m0, s24, 69632
  s_add_u32 s19, s20, 57344
  buffer_load_dwordx4 v2, s[4:7], s19 offen lds
  s_add_u32 m0, s24, 73728
  s_add_u32 s19, s20, 114688
  buffer_load_dwordx4 v2, s[4:7], s19 offen lds
  s_add_u32 m0, s24, 77824
  s_add_u32 s19, s20, 172032
  buffer_load_dwordx4 v2, s[4:7], s19 offen lds
  s_add_u32 m0, s24, 81920
  s_add_u32 s19, s20, 229376
  buffer_load_dwordx4 v2, s[4:7], s19 offen lds
  s_add_u32 m0, s24, 86016
  s_add_u32 s19, s20, 286720
  buffer_load_dwordx4 v2, s[4:7], s19 offen lds
  s_add_u32 m0, s24, 90112
  s_add_u32 s19, s20, 344064
  buffer_load_dwordx4 v2, s[4:7], s19 offen lds
  s_add_u32 m0, s24, 94208
  s_add_u32 s19, s20, 401408
  buffer_load_dwordx4 v2, s[4:7], s19 offen lds
  s_add_u32 s28, s26, 3
  s_and_b32 s28, s28, 3
  s_mul_i32 s20, s28, 458752
  s_add_u32 s20, s20, s23
  s_add_u32 m0, s24, 98304
  s_add_u32 s19, s20, 0
  buffer_load_dwordx4 v2, s[4:7], s19 offen lds
  s_add_u32 m0, s24, 102400
  s_add_u32 s19, s20, 57344
  buffer_load_dwordx4 v2, s[4:7], s19 offen lds
  s_add_u32 m0, s24, 106496
  s_add_u32 s19, s20, 114688
  buffer_load_dwordx4 v2, s[4:7], s19 offen lds
  s_add_u32 m0, s24, 110592
  s_add_u32 s19, s20, 172032
  buffer_load_dwordx4 v2, s[4:7], s19 offen lds
  s_add_u32 m0, s24, 114688
  s_add_u32 s19, s20, 229376
  buffer_load_dwordx4 v2, s[4:7], s19 offen lds
  s_add_u32 m0, s24, 118784
  s_add_u32 s19, s20, 286720
  buffer_load_dwordx4 v2, s[4:7], s19 offen lds
  s_add_u32 m0, s24, 122880
  s_add_u32 s19, s20, 344064
  buffer_load_dwordx4 v2, s[4:7], s19 offen lds
  s_add_u32 m0, s24, 126976
  s_add_u32 s19, s20, 401408
  buffer_load_dwordx4 v2, s[4:7], s19 offen lds
  s_waitcnt vmcnt(24)
  s_barrier
  s_waitcnt vmcnt(16)
  s_barrier
  s_lshr_b32 s34, s2, 3
  s_load_dwordx2 s[36:37], s[0:1], 72
  s_mul_i32 s35, s34, 65536
  s_mul_i32 s20, s16, 16384
  s_add_u32 s35, s35, s20
  s_waitcnt lgkmcnt(0)
  s_mov_b32 s38, 0x1c0000
  s_mov_b32 s39, 0x20000
  buffer_load_dwordx4 v[64:67], v1, s[36:39], s35 offen offset:0
  buffer_load_dwordx4 v[68:71], v1, s[36:39], s35 offen offset:1024
  buffer_load_dwordx4 v[72:75], v1, s[36:39], s35 offen offset:2048
  buffer_load_dwordx4 v[76:79], v1, s[36:39], s35 offen offset:3072
  s_waitcnt vmcnt(12)
  s_barrier
  s_add_u32 s35, s35, 4096
  buffer_load_dwordx4 v[64:67], v1, s[36:39], s35 offen offset:0
  buffer_load_dwordx4 v[68:71], v1, s[36:39], s35 offen offset:1024
  buffer_load_dwordx4 v[72:75], v1, s[36:39], s35 offen offset:2048
  buffer_load_dwordx4 v[76:79], v1, s[36:39], s35 offen offset:3072
  s_waitcnt vmcnt(8)
  s_barrier
  s_add_u32 s35, s35, 4096
  buffer_load_dwordx4 v[64:67], v1, s[36:39], s35 offen offset:0
  buffer_load_dwordx4 v[68:71], v1, s[36:39], s35 offen offset:1024
  buffer_load_dwordx4 v[72:75], v1, s[36:39], s35 offen offset:2048
  buffer_load_dwordx4 v[76:79], v1, s[36:39], s35 offen offset:3072
  s_add_u32 s35, s35, 4096
  buffer_load_dwordx4 v[64:67], v1, s[36:39], s35 offen offset:0
  buffer_load_dwordx4 v[68:71], v1, s[36:39], s35 offen offset:1024
  buffer_load_dwordx4 v[72:75], v1, s[36:39], s35 offen offset:2048
  buffer_load_dwordx4 v[76:79], v1, s[36:39], s35 offen offset:3072
  s_branch sequential_preLN__compressed_kv_cla__dense_activation_squared_relu__prompt_kernel_b_t1
sequential_preLN__compressed_kv_cla__dense_activation_squared_relu__prompt_kernel_b_compute:
  s_lshr_b32 s44, s2, 2
  s_and_b32 s45, s2, 3
  s_lshl_b32 s45, s45, 3
  v_and_b32 v9, 7, v0
  v_bfe_u32 v10, v0, 3, 1
  v_lshrrev_b32 v11, 4, v0
  s_lshl_b32 s19, s16, 3
  v_add_u32 v11, s19, v11
  v_add_u32 v5, s45, v9
  v_lshlrev_b32 v12, 4, v5
  v_lshl_add_u32 v12, v10, 9, v12
  v_lshl_add_u32 v12, v11, 10, v12
  v_lshlrev_b32 v13, 10, v5
  v_lshl_add_u32 v13, v11, 5, v13
  v_lshl_add_u32 v13, v10, 3, v13
  s_lshl_b32 s44, s44, 15
  buffer_load_dwordx2 v[96:97], v13, s[40:43], s44 offen offset:0
  buffer_load_dwordx2 v[98:99], v13, s[40:43], s44 offen offset:16
  buffer_load_dwordx2 v[100:101], v13, s[40:43], s44 offen offset:128
  buffer_load_dwordx2 v[102:103], v13, s[40:43], s44 offen offset:144
  v_and_b32 v120, 3, v0
  v_lshlrev_b32 v120, 3, v120
  v_bfe_u32 v121, v0, 2, 2
  v_lshl_add_u32 v120, v121, 1, v120
  s_lshr_b32 s19, s2, 4
  s_and_b32 s20, s19, 7
  s_lshl_b32 s20, s20, 5
  s_lshr_b32 s19, s19, 3
  s_add_u32 s19, s19, s20
  v_add_u32 v120, s19, v120
  v_lshlrev_b32 v120, 7, v120
  s_mov_b32 s21, 0x5230000
  s_mov_b32 s47, 0x40000
Lfsp_46:
  buffer_load_dword v121, v120, s[8:11], s21 offen sc1
  s_waitcnt vmcnt(0)
  v_cmp_eq_u32 vcc, 1, v121
  s_nop 3
  s_cmp_eq_u64 vcc, -1
  s_cbranch_scc1 Lfok_45
  s_sleep 3
  s_sub_u32 s47, s47, 1
  s_cbranch_scc0 Lfsp_46
Lfok_45:
  s_add_u32 s20, s44, 0x4600000
  s_add_u32 s19, s20, 0
  buffer_load_dwordx4 v[64:67], v12, s[8:11], s19 offen sc1
  s_add_u32 s19, s20, 4096
  buffer_load_dwordx4 v[68:71], v12, s[8:11], s19 offen sc1
  s_add_u32 s20, s20, 0x200000
  s_add_u32 s19, s20, 0
  buffer_load_dwordx4 v[72:75], v12, s[8:11], s19 offen sc1
  s_add_u32 s19, s20, 4096
  buffer_load_dwordx4 v[76:79], v12, s[8:11], s19 offen sc1
  s_add_u32 s20, s20, 0x200000
  s_add_u32 s19, s20, 0
  buffer_load_dwordx4 v[80:83], v12, s[8:11], s19 offen sc1
  s_add_u32 s19, s20, 4096
  buffer_load_dwordx4 v[84:87], v12, s[8:11], s19 offen sc1
  s_add_u32 s20, s20, 0x200000
  s_add_u32 s19, s20, 0
  buffer_load_dwordx4 v[88:91], v12, s[8:11], s19 offen sc1
  s_add_u32 s19, s20, 4096
  buffer_load_dwordx4 v[92:95], v12, s[8:11], s19 offen sc1
  s_barrier
  s_waitcnt vmcnt(6)
  v_lshlrev_b32 v104, 16, v64
  v_and_b32 v105, 0xffff0000, v64
  v_lshlrev_b32 v106, 16, v65
  v_and_b32 v107, 0xffff0000, v65
  v_lshlrev_b32 v108, 16, v66
  v_and_b32 v109, 0xffff0000, v66
  v_lshlrev_b32 v110, 16, v67
  v_and_b32 v111, 0xffff0000, v67
  v_lshlrev_b32 v112, 16, v68
  v_and_b32 v113, 0xffff0000, v68
  v_lshlrev_b32 v114, 16, v69
  v_and_b32 v115, 0xffff0000, v69
  v_lshlrev_b32 v116, 16, v70
  v_and_b32 v117, 0xffff0000, v70
  v_lshlrev_b32 v118, 16, v71
  v_and_b32 v119, 0xffff0000, v71
  s_waitcnt vmcnt(4)
  v_lshlrev_b32 v120, 16, v72
  v_and_b32 v121, 0xffff0000, v72
  v_lshlrev_b32 v122, 16, v73
  v_and_b32 v123, 0xffff0000, v73
  v_lshlrev_b32 v124, 16, v74
  v_and_b32 v125, 0xffff0000, v74
  v_lshlrev_b32 v126, 16, v75
  v_and_b32 v127, 0xffff0000, v75
  v_add_f32 v104, v104, v120
  v_add_f32 v105, v105, v121
  v_add_f32 v106, v106, v122
  v_add_f32 v107, v107, v123
  v_add_f32 v108, v108, v124
  v_add_f32 v109, v109, v125
  v_add_f32 v110, v110, v126
  v_add_f32 v111, v111, v127
  v_lshlrev_b32 v120, 16, v76
  v_and_b32 v121, 0xffff0000, v76
  v_lshlrev_b32 v122, 16, v77
  v_and_b32 v123, 0xffff0000, v77
  v_lshlrev_b32 v124, 16, v78
  v_and_b32 v125, 0xffff0000, v78
  v_lshlrev_b32 v126, 16, v79
  v_and_b32 v127, 0xffff0000, v79
  v_add_f32 v112, v112, v120
  v_add_f32 v113, v113, v121
  v_add_f32 v114, v114, v122
  v_add_f32 v115, v115, v123
  v_add_f32 v116, v116, v124
  v_add_f32 v117, v117, v125
  v_add_f32 v118, v118, v126
  v_add_f32 v119, v119, v127
  s_waitcnt vmcnt(2)
  v_lshlrev_b32 v120, 16, v80
  v_and_b32 v121, 0xffff0000, v80
  v_lshlrev_b32 v122, 16, v81
  v_and_b32 v123, 0xffff0000, v81
  v_lshlrev_b32 v124, 16, v82
  v_and_b32 v125, 0xffff0000, v82
  v_lshlrev_b32 v126, 16, v83
  v_and_b32 v127, 0xffff0000, v83
  v_add_f32 v104, v104, v120
  v_add_f32 v105, v105, v121
  v_add_f32 v106, v106, v122
  v_add_f32 v107, v107, v123
  v_add_f32 v108, v108, v124
  v_add_f32 v109, v109, v125
  v_add_f32 v110, v110, v126
  v_add_f32 v111, v111, v127
  v_lshlrev_b32 v120, 16, v84
  v_and_b32 v121, 0xffff0000, v84
  v_lshlrev_b32 v122, 16, v85
  v_and_b32 v123, 0xffff0000, v85
  v_lshlrev_b32 v124, 16, v86
  v_and_b32 v125, 0xffff0000, v86
  v_lshlrev_b32 v126, 16, v87
  v_and_b32 v127, 0xffff0000, v87
  v_add_f32 v112, v112, v120
  v_add_f32 v113, v113, v121
  v_add_f32 v114, v114, v122
  v_add_f32 v115, v115, v123
  v_add_f32 v116, v116, v124
  v_add_f32 v117, v117, v125
  v_add_f32 v118, v118, v126
  v_add_f32 v119, v119, v127
  s_waitcnt vmcnt(0)
  v_lshlrev_b32 v120, 16, v88
  v_and_b32 v121, 0xffff0000, v88
  v_lshlrev_b32 v122, 16, v89
  v_and_b32 v123, 0xffff0000, v89
  v_lshlrev_b32 v124, 16, v90
  v_and_b32 v125, 0xffff0000, v90
  v_lshlrev_b32 v126, 16, v91
  v_and_b32 v127, 0xffff0000, v91
  v_add_f32 v104, v104, v120
  v_add_f32 v105, v105, v121
  v_add_f32 v106, v106, v122
  v_add_f32 v107, v107, v123
  v_add_f32 v108, v108, v124
  v_add_f32 v109, v109, v125
  v_add_f32 v110, v110, v126
  v_add_f32 v111, v111, v127
  v_lshlrev_b32 v120, 16, v92
  v_and_b32 v121, 0xffff0000, v92
  v_lshlrev_b32 v122, 16, v93
  v_and_b32 v123, 0xffff0000, v93
  v_lshlrev_b32 v124, 16, v94
  v_and_b32 v125, 0xffff0000, v94
  v_lshlrev_b32 v126, 16, v95
  v_and_b32 v127, 0xffff0000, v95
  v_add_f32 v112, v112, v120
  v_add_f32 v113, v113, v121
  v_add_f32 v114, v114, v122
  v_add_f32 v115, v115, v123
  v_add_f32 v116, v116, v124
  v_add_f32 v117, v117, v125
  v_add_f32 v118, v118, v126
  v_add_f32 v119, v119, v127
  s_waitcnt vmcnt(0)
  v_lshlrev_b32 v120, 16, v96
  v_and_b32 v121, 0xffff0000, v96
  v_lshlrev_b32 v122, 16, v97
  v_and_b32 v123, 0xffff0000, v97
  v_lshlrev_b32 v124, 16, v98
  v_and_b32 v125, 0xffff0000, v98
  v_lshlrev_b32 v126, 16, v99
  v_and_b32 v127, 0xffff0000, v99
  v_add_f32 v104, v104, v120
  v_add_f32 v105, v105, v121
  v_add_f32 v106, v106, v122
  v_add_f32 v107, v107, v123
  v_add_f32 v108, v108, v124
  v_add_f32 v109, v109, v125
  v_add_f32 v110, v110, v126
  v_add_f32 v111, v111, v127
  v_lshlrev_b32 v120, 16, v100
  v_and_b32 v121, 0xffff0000, v100
  v_lshlrev_b32 v122, 16, v101
  v_and_b32 v123, 0xffff0000, v101
  v_lshlrev_b32 v124, 16, v102
  v_and_b32 v125, 0xffff0000, v102
  v_lshlrev_b32 v126, 16, v103
  v_and_b32 v127, 0xffff0000, v103
  v_add_f32 v112, v112, v120
  v_add_f32 v113, v113, v121
  v_add_f32 v114, v114, v122
  v_add_f32 v115, v115, v123
  v_add_f32 v116, v116, v124
  v_add_f32 v117, v117, v125
  v_add_f32 v118, v118, v126
  v_add_f32 v119, v119, v127
  v_cvt_pk_bf16_f32 v128, v104, v105
  v_cvt_pk_bf16_f32 v129, v106, v107
  v_cvt_pk_bf16_f32 v130, v108, v109
  v_cvt_pk_bf16_f32 v131, v110, v111
  v_cvt_pk_bf16_f32 v132, v112, v113
  v_cvt_pk_bf16_f32 v133, v114, v115
  v_cvt_pk_bf16_f32 v134, v116, v117
  v_cvt_pk_bf16_f32 v135, v118, v119
  s_add_u32 s20, s44, 0x3800000
  s_add_u32 s19, s20, 4096
  buffer_store_dwordx4 v[128:131], v12, s[8:11], s20 offen sc1
  buffer_store_dwordx4 v[132:135], v12, s[8:11], s19 offen sc1
  v_lshlrev_b32 v104, 16, v128
  v_and_b32 v105, 0xffff0000, v128
  v_lshlrev_b32 v106, 16, v129
  v_and_b32 v107, 0xffff0000, v129
  v_lshlrev_b32 v108, 16, v130
  v_and_b32 v109, 0xffff0000, v130
  v_lshlrev_b32 v110, 16, v131
  v_and_b32 v111, 0xffff0000, v131
  v_lshlrev_b32 v112, 16, v132
  v_and_b32 v113, 0xffff0000, v132
  v_lshlrev_b32 v114, 16, v133
  v_and_b32 v115, 0xffff0000, v133
  v_lshlrev_b32 v116, 16, v134
  v_and_b32 v117, 0xffff0000, v134
  v_lshlrev_b32 v118, 16, v135
  v_and_b32 v119, 0xffff0000, v135
  v_add_f32 v136, v104, v105
  v_add_f32 v136, v136, v106
  v_add_f32 v136, v136, v107
  v_add_f32 v136, v136, v108
  v_add_f32 v136, v136, v109
  v_add_f32 v136, v136, v110
  v_add_f32 v136, v136, v111
  v_add_f32 v136, v136, v112
  v_add_f32 v136, v136, v113
  v_add_f32 v136, v136, v114
  v_add_f32 v136, v136, v115
  v_add_f32 v136, v136, v116
  v_add_f32 v136, v136, v117
  v_add_f32 v136, v136, v118
  v_add_f32 v136, v136, v119
  s_nop 1
  v_add_f32_dpp v136, v136, v136 row_ror:8 row_mask:0xf bank_mask:0xf
  v_mov_b32 v120, v136
  s_nop 1
  v_permlane16_swap_b32 v136, v120
  s_nop 1
  v_add_f32 v136, v136, v120
  v_mov_b32 v120, v136
  s_nop 1
  v_permlane32_swap_b32 v136, v120
  s_nop 1
  v_add_f32 v136, v136, v120
  v_lshlrev_b32 v120, 4, v9
  v_add_u32 v120, 131328, v120
  s_lshl_b32 s20, s16, 2
  v_add_u32 v121, s20, v120
  ds_write_b32 v121, v136
  s_waitcnt lgkmcnt(0)
  s_barrier
  ds_read_b128 v[124:127], v120
  s_waitcnt lgkmcnt(0)
  v_add_f32 v136, v124, v125
  v_add_f32 v136, v136, v126
  v_add_f32 v136, v136, v127
  v_mul_f32 v136, 0x3b000000, v136
  v_sub_f32 v104, v104, v136
  v_sub_f32 v105, v105, v136
  v_sub_f32 v106, v106, v136
  v_sub_f32 v107, v107, v136
  v_sub_f32 v108, v108, v136
  v_sub_f32 v109, v109, v136
  v_sub_f32 v110, v110, v136
  v_sub_f32 v111, v111, v136
  v_sub_f32 v112, v112, v136
  v_sub_f32 v113, v113, v136
  v_sub_f32 v114, v114, v136
  v_sub_f32 v115, v115, v136
  v_sub_f32 v116, v116, v136
  v_sub_f32 v117, v117, v136
  v_sub_f32 v118, v118, v136
  v_sub_f32 v119, v119, v136
  v_mul_f32 v137, v104, v104
  v_fmac_f32 v137, v105, v105
  v_fmac_f32 v137, v106, v106
  v_fmac_f32 v137, v107, v107
  v_fmac_f32 v137, v108, v108
  v_fmac_f32 v137, v109, v109
  v_fmac_f32 v137, v110, v110
  v_fmac_f32 v137, v111, v111
  v_fmac_f32 v137, v112, v112
  v_fmac_f32 v137, v113, v113
  v_fmac_f32 v137, v114, v114
  v_fmac_f32 v137, v115, v115
  v_fmac_f32 v137, v116, v116
  v_fmac_f32 v137, v117, v117
  v_fmac_f32 v137, v118, v118
  v_fmac_f32 v137, v119, v119
  s_nop 1
  v_add_f32_dpp v137, v137, v137 row_ror:8 row_mask:0xf bank_mask:0xf
  v_mov_b32 v120, v137
  s_nop 1
  v_permlane16_swap_b32 v137, v120
  s_nop 1
  v_add_f32 v137, v137, v120
  v_mov_b32 v120, v137
  s_nop 1
  v_permlane32_swap_b32 v137, v120
  s_nop 1
  v_add_f32 v137, v137, v120
  v_lshlrev_b32 v120, 4, v9
  v_add_u32 v120, 131456, v120
  s_lshl_b32 s20, s16, 2
  v_add_u32 v121, s20, v120
  ds_write_b32 v121, v137
  s_waitcnt lgkmcnt(0)
  s_barrier
  ds_read_b128 v[124:127], v120
  s_waitcnt lgkmcnt(0)
  v_add_f32 v137, v124, v125
  v_add_f32 v137, v137, v126
  v_add_f32 v137, v137, v127
  v_mov_b32 v136, 0x3727c5ac
  v_fmac_f32 v136, 0x3b000000, v137
  v_rsq_f32 v136, v136
  s_nop 0
  v_mul_f32 v104, v104, v136
  v_mul_f32 v105, v105, v136
  v_mul_f32 v106, v106, v136
  v_mul_f32 v107, v107, v136
  v_mul_f32 v108, v108, v136
  v_mul_f32 v109, v109, v136
  v_mul_f32 v110, v110, v136
  v_mul_f32 v111, v111, v136
  v_mul_f32 v112, v112, v136
  v_mul_f32 v113, v113, v136
  v_mul_f32 v114, v114, v136
  v_mul_f32 v115, v115, v136
  v_mul_f32 v116, v116, v136
  v_mul_f32 v117, v117, v136
  v_mul_f32 v118, v118, v136
  v_mul_f32 v119, v119, v136
  v_cvt_pk_bf16_f32 v140, v104, v105
  v_cvt_pk_bf16_f32 v141, v106, v107
  v_cvt_pk_bf16_f32 v142, v108, v109
  v_cvt_pk_bf16_f32 v143, v110, v111
  v_cvt_pk_bf16_f32 v144, v112, v113
  v_cvt_pk_bf16_f32 v145, v114, v115
  v_cvt_pk_bf16_f32 v146, v116, v117
  v_cvt_pk_bf16_f32 v147, v118, v119
  s_add_u32 s20, s44, 0x4400000
  s_add_u32 s19, s20, 4096
  buffer_store_dwordx4 v[140:143], v12, s[8:11], s20 offen sc1
  buffer_store_dwordx4 v[144:147], v12, s[8:11], s19 offen sc1
  s_waitcnt vmcnt(0)
  s_barrier
  s_cmp_lg_u32 s16, 0
  s_cbranch_scc1 Lfl_47
  s_lshl_b32 s21, s2, 7
  s_add_u32 s21, s21, 0x5210000
  v_mov_b32 v120, 1
  s_mov_b64 exec, 1
  buffer_store_dword v120, off, s[8:11], s21 sc1
  s_mov_b64 exec, -1
Lfl_47:
  s_cmp_ge_u32 s2, 224
  s_cbranch_scc1 sequential_preLN__compressed_kv_cla__dense_activation_squared_relu__prompt_kernel_b_t1
  v_and_b32 v120, 15, v0
  v_lshlrev_b32 v120, 7, v120
  s_lshl_b32 s21, s17, 11
  s_add_u32 s21, s21, 0x5210000
  s_mov_b32 s45, 0x40000
Lfsp_51:
  buffer_load_dword v121, v120, s[8:11], s21 offen sc1
  s_waitcnt vmcnt(0)
  v_cmp_eq_u32 vcc, 1, v121
  s_nop 3
  s_cmp_eq_u64 vcc, -1
  s_cbranch_scc1 Lfok_50
  s_sleep 3
  s_sub_u32 s45, s45, 1
  s_cbranch_scc0 Lfsp_51
Lfok_50:
  s_add_u32 s28, s26, 0
  s_and_b32 s28, s28, 3
  s_lshl_b32 s21, s28, 13
  s_add_u32 s21, s21, s22
  buffer_load_dwordx4 v[128:131], v1, s[8:11], s21 offen offset:0 sc1
  buffer_load_dwordx4 v[132:135], v1, s[8:11], s21 offen offset:1024 sc1
  buffer_load_dwordx4 v[136:139], v1, s[8:11], s21 offen offset:2048 sc1
  buffer_load_dwordx4 v[140:143], v1, s[8:11], s21 offen offset:3072 sc1
  s_add_u32 s21, s21, 4096
  buffer_load_dwordx4 v[144:147], v1, s[8:11], s21 offen offset:0 sc1
  buffer_load_dwordx4 v[148:151], v1, s[8:11], s21 offen offset:1024 sc1
  buffer_load_dwordx4 v[152:155], v1, s[8:11], s21 offen offset:2048 sc1
  buffer_load_dwordx4 v[156:159], v1, s[8:11], s21 offen offset:3072 sc1
  s_barrier
  ds_read_b64_tr_b16 v[16:17], v3 offset:0
  ds_read_b64_tr_b16 v[18:19], v3 offset:2048
  ds_read_b64_tr_b16 v[20:21], v3 offset:256
  ds_read_b64_tr_b16 v[22:23], v3 offset:2304
  ds_read_b64_tr_b16 v[24:25], v3 offset:512
  ds_read_b64_tr_b16 v[26:27], v3 offset:2560
  ds_read_b64_tr_b16 v[28:29], v3 offset:768
  ds_read_b64_tr_b16 v[30:31], v3 offset:2816
  ds_read_b64_tr_b16 v[32:33], v3 offset:4096
  ds_read_b64_tr_b16 v[34:35], v3 offset:6144
  ds_read_b64_tr_b16 v[36:37], v3 offset:4352
  ds_read_b64_tr_b16 v[38:39], v3 offset:6400
  ds_read_b64_tr_b16 v[40:41], v3 offset:4608
  ds_read_b64_tr_b16 v[42:43], v3 offset:6656
  s_waitcnt vmcnt(0)
  s_waitcnt lgkmcnt(10)
  v_mfma_f32_32x32x16_bf16 v[64:79], v[16:19], v[128:131], 0
  s_add_u32 s28, s26, 1
  s_and_b32 s28, s28, 3
  s_lshl_b32 s21, s28, 13
  s_add_u32 s21, s21, s22
  buffer_load_dwordx4 v[160:163], v1, s[8:11], s21 offen offset:0 sc1
  ds_read_b64_tr_b16 v[16:17], v3 offset:4864
  ds_read_b64_tr_b16 v[18:19], v3 offset:6912
  v_mfma_f32_32x32x16_bf16 v[80:95], v[20:23], v[128:131], 0
  buffer_load_dwordx4 v[164:167], v1, s[8:11], s21 offen offset:1024 sc1
  ds_read_b64_tr_b16 v[20:21], v3 offset:8192
  ds_read_b64_tr_b16 v[22:23], v3 offset:10240
  s_waitcnt lgkmcnt(10)
  v_mfma_f32_32x32x16_bf16 v[96:111], v[24:27], v[128:131], 0
  buffer_load_dwordx4 v[168:171], v1, s[8:11], s21 offen offset:2048 sc1
  ds_read_b64_tr_b16 v[24:25], v3 offset:8448
  ds_read_b64_tr_b16 v[26:27], v3 offset:10496
  v_mfma_f32_32x32x16_bf16 v[112:127], v[28:31], v[128:131], 0
  buffer_load_dwordx4 v[172:175], v1, s[8:11], s21 offen offset:3072 sc1
  ds_read_b64_tr_b16 v[28:29], v3 offset:8704
  ds_read_b64_tr_b16 v[30:31], v3 offset:10752
  s_waitcnt lgkmcnt(10)
  v_mfma_f32_32x32x16_bf16 v[64:79], v[32:35], v[132:135], v[64:79]
  s_add_u32 s21, s21, 4096
  buffer_load_dwordx4 v[176:179], v1, s[8:11], s21 offen offset:0 sc1
  ds_read_b64_tr_b16 v[32:33], v3 offset:8960
  ds_read_b64_tr_b16 v[34:35], v3 offset:11008
  v_mfma_f32_32x32x16_bf16 v[80:95], v[36:39], v[132:135], v[80:95]
  buffer_load_dwordx4 v[180:183], v1, s[8:11], s21 offen offset:1024 sc1
  ds_read_b64_tr_b16 v[36:37], v3 offset:12288
  ds_read_b64_tr_b16 v[38:39], v3 offset:14336
  s_waitcnt lgkmcnt(10)
  v_mfma_f32_32x32x16_bf16 v[96:111], v[40:43], v[132:135], v[96:111]
  buffer_load_dwordx4 v[184:187], v1, s[8:11], s21 offen offset:2048 sc1
  ds_read_b64_tr_b16 v[40:41], v3 offset:12544
  ds_read_b64_tr_b16 v[42:43], v3 offset:14592
  v_mfma_f32_32x32x16_bf16 v[112:127], v[16:19], v[132:135], v[112:127]
  buffer_load_dwordx4 v[188:191], v1, s[8:11], s21 offen offset:3072 sc1
  ds_read_b64_tr_b16 v[16:17], v3 offset:12800
  ds_read_b64_tr_b16 v[18:19], v3 offset:14848
  s_waitcnt lgkmcnt(10)
  v_mfma_f32_32x32x16_bf16 v[64:79], v[20:23], v[136:139], v[64:79]
  s_add_u32 s28, s26, 2
  s_and_b32 s28, s28, 3
  s_lshl_b32 s21, s28, 13
  s_add_u32 s21, s21, s22
  buffer_load_dwordx4 v[192:195], v1, s[8:11], s21 offen offset:0 sc1
  ds_read_b64_tr_b16 v[20:21], v3 offset:13056
  ds_read_b64_tr_b16 v[22:23], v3 offset:15104
  v_mfma_f32_32x32x16_bf16 v[80:95], v[24:27], v[136:139], v[80:95]
  buffer_load_dwordx4 v[196:199], v1, s[8:11], s21 offen offset:1024 sc1
  ds_read_b64_tr_b16 v[24:25], v3 offset:16384
  ds_read_b64_tr_b16 v[26:27], v3 offset:18432
  s_waitcnt lgkmcnt(10)
  v_mfma_f32_32x32x16_bf16 v[96:111], v[28:31], v[136:139], v[96:111]
  buffer_load_dwordx4 v[200:203], v1, s[8:11], s21 offen offset:2048 sc1
  ds_read_b64_tr_b16 v[28:29], v3 offset:16640
  ds_read_b64_tr_b16 v[30:31], v3 offset:18688
  v_mfma_f32_32x32x16_bf16 v[112:127], v[32:35], v[136:139], v[112:127]
  buffer_load_dwordx4 v[204:207], v1, s[8:11], s21 offen offset:3072 sc1
  ds_read_b64_tr_b16 v[32:33], v3 offset:16896
  ds_read_b64_tr_b16 v[34:35], v3 offset:18944
  s_waitcnt lgkmcnt(10)
  v_mfma_f32_32x32x16_bf16 v[64:79], v[36:39], v[140:143], v[64:79]
  ds_read_b64_tr_b16 v[36:37], v3 offset:17152
  ds_read_b64_tr_b16 v[38:39], v3 offset:19200
  v_mfma_f32_32x32x16_bf16 v[80:95], v[40:43], v[140:143], v[80:95]
  s_add_u32 s21, s21, 4096
  buffer_load_dwordx4 v[208:211], v1, s[8:11], s21 offen offset:0 sc1
  ds_read_b64_tr_b16 v[40:41], v3 offset:20480
  ds_read_b64_tr_b16 v[42:43], v3 offset:22528
  s_waitcnt lgkmcnt(10)
  v_mfma_f32_32x32x16_bf16 v[96:111], v[16:19], v[140:143], v[96:111]
  buffer_load_dwordx4 v[212:215], v1, s[8:11], s21 offen offset:1024 sc1
  ds_read_b64_tr_b16 v[16:17], v3 offset:20736
  ds_read_b64_tr_b16 v[18:19], v3 offset:22784
  v_mfma_f32_32x32x16_bf16 v[112:127], v[20:23], v[140:143], v[112:127]
  ds_read_b64_tr_b16 v[20:21], v3 offset:20992
  ds_read_b64_tr_b16 v[22:23], v3 offset:23040
  s_waitcnt lgkmcnt(10)
  v_mfma_f32_32x32x16_bf16 v[64:79], v[24:27], v[144:147], v[64:79]
  buffer_load_dwordx4 v[216:219], v1, s[8:11], s21 offen offset:2048 sc1
  ds_read_b64_tr_b16 v[24:25], v3 offset:21248
  ds_read_b64_tr_b16 v[26:27], v3 offset:23296
  v_mfma_f32_32x32x16_bf16 v[80:95], v[28:31], v[144:147], v[80:95]
  buffer_load_dwordx4 v[220:223], v1, s[8:11], s21 offen offset:3072 sc1
  ds_read_b64_tr_b16 v[28:29], v3 offset:24576
  ds_read_b64_tr_b16 v[30:31], v3 offset:26624
  s_waitcnt lgkmcnt(10)
  v_mfma_f32_32x32x16_bf16 v[96:111], v[32:35], v[144:147], v[96:111]
  ds_read_b64_tr_b16 v[32:33], v3 offset:24832
  ds_read_b64_tr_b16 v[34:35], v3 offset:26880
  v_mfma_f32_32x32x16_bf16 v[112:127], v[36:39], v[144:147], v[112:127]
  ds_read_b64_tr_b16 v[36:37], v3 offset:25088
  ds_read_b64_tr_b16 v[38:39], v3 offset:27136
  s_waitcnt lgkmcnt(10)
  v_mfma_f32_32x32x16_bf16 v[64:79], v[40:43], v[148:151], v[64:79]
  ds_read_b64_tr_b16 v[40:41], v3 offset:25344
  ds_read_b64_tr_b16 v[42:43], v3 offset:27392
  v_mfma_f32_32x32x16_bf16 v[80:95], v[16:19], v[148:151], v[80:95]
  ds_read_b64_tr_b16 v[16:17], v3 offset:28672
  ds_read_b64_tr_b16 v[18:19], v3 offset:30720
  s_waitcnt lgkmcnt(10)
  v_mfma_f32_32x32x16_bf16 v[96:111], v[20:23], v[148:151], v[96:111]
  ds_read_b64_tr_b16 v[20:21], v3 offset:28928
  ds_read_b64_tr_b16 v[22:23], v3 offset:30976
  v_mfma_f32_32x32x16_bf16 v[112:127], v[24:27], v[148:151], v[112:127]
  ds_read_b64_tr_b16 v[24:25], v3 offset:29184
  ds_read_b64_tr_b16 v[26:27], v3 offset:31232
  s_waitcnt lgkmcnt(10)
  v_mfma_f32_32x32x16_bf16 v[64:79], v[28:31], v[152:155], v[64:79]
  ds_read_b64_tr_b16 v[28:29], v3 offset:29440
  ds_read_b64_tr_b16 v[30:31], v3 offset:31488
  v_mfma_f32_32x32x16_bf16 v[80:95], v[32:35], v[152:155], v[80:95]
  s_waitcnt lgkmcnt(8)
  v_mfma_f32_32x32x16_bf16 v[96:111], v[36:39], v[152:155], v[96:111]
  v_mfma_f32_32x32x16_bf16 v[112:127], v[40:43], v[152:155], v[112:127]
  s_waitcnt lgkmcnt(4)
  v_mfma_f32_32x32x16_bf16 v[64:79], v[16:19], v[156:159], v[64:79]
  v_mfma_f32_32x32x16_bf16 v[80:95], v[20:23], v[156:159], v[80:95]
  s_waitcnt lgkmcnt(0)
  v_mfma_f32_32x32x16_bf16 v[96:111], v[24:27], v[156:159], v[96:111]
  v_mfma_f32_32x32x16_bf16 v[112:127], v[28:31], v[156:159], v[112:127]
  s_barrier
  v_lshlrev_b32 v5, 3, v8
  v_add_u32 v5, 131072, v5
  ds_read_b64 v[128:129], v5 offset:0
  ds_read_b64 v[130:131], v5 offset:16
  ds_read_b64 v[132:133], v5 offset:32
  ds_read_b64 v[134:135], v5 offset:48
  ds_read_b64 v[136:137], v5 offset:64
  ds_read_b64 v[138:139], v5 offset:80
  ds_read_b64 v[140:141], v5 offset:96
  ds_read_b64 v[142:143], v5 offset:112
  s_waitcnt lgkmcnt(0)
  ds_read_b64_tr_b16 v[32:33], v3 offset:32768
  ds_read_b64_tr_b16 v[34:35], v3 offset:34816
  ds_read_b64_tr_b16 v[36:37], v3 offset:33024
  ds_read_b64_tr_b16 v[38:39], v3 offset:35072
  ds_read_b64_tr_b16 v[40:41], v3 offset:33280
  ds_read_b64_tr_b16 v[42:43], v3 offset:35328
  ds_read_b64_tr_b16 v[16:17], v3 offset:33536
  ds_read_b64_tr_b16 v[18:19], v3 offset:35584
  ds_read_b64_tr_b16 v[20:21], v3 offset:36864
  ds_read_b64_tr_b16 v[22:23], v3 offset:38912
  ds_read_b64_tr_b16 v[24:25], v3 offset:37120
  ds_read_b64_tr_b16 v[26:27], v3 offset:39168
  ds_read_b64_tr_b16 v[28:29], v3 offset:37376
  ds_read_b64_tr_b16 v[30:31], v3 offset:39424
  s_waitcnt vmcnt(8)
  s_waitcnt lgkmcnt(10)
  v_mfma_f32_32x32x16_bf16 v[64:79], v[32:35], v[160:163], v[64:79]
  ds_read_b64_tr_b16 v[32:33], v3 offset:37632
  ds_read_b64_tr_b16 v[34:35], v3 offset:39680
  v_mfma_f32_32x32x16_bf16 v[80:95], v[36:39], v[160:163], v[80:95]
  ds_read_b64_tr_b16 v[36:37], v3 offset:40960
  ds_read_b64_tr_b16 v[38:39], v3 offset:43008
  s_waitcnt lgkmcnt(10)
  v_mfma_f32_32x32x16_bf16 v[96:111], v[40:43], v[160:163], v[96:111]
  s_add_u32 s28, s26, 3
  s_and_b32 s28, s28, 3
  s_lshl_b32 s21, s28, 13
  s_add_u32 s21, s21, s22
  buffer_load_dwordx4 v[224:227], v1, s[8:11], s21 offen offset:0 sc1
  ds_read_b64_tr_b16 v[40:41], v3 offset:41216
  ds_read_b64_tr_b16 v[42:43], v3 offset:43264
  v_mfma_f32_32x32x16_bf16 v[112:127], v[16:19], v[160:163], v[112:127]
  ds_read_b64_tr_b16 v[16:17], v3 offset:41472
  ds_read_b64_tr_b16 v[18:19], v3 offset:43520
  s_waitcnt lgkmcnt(10)
  v_mfma_f32_32x32x16_bf16 v[64:79], v[20:23], v[164:167], v[64:79]
  ds_read_b64_tr_b16 v[20:21], v3 offset:41728
  ds_read_b64_tr_b16 v[22:23], v3 offset:43776
  v_mfma_f32_32x32x16_bf16 v[80:95], v[24:27], v[164:167], v[80:95]
  buffer_load_dwordx4 v[228:231], v1, s[8:11], s21 offen offset:1024 sc1
  ds_read_b64_tr_b16 v[24:25], v3 offset:45056
  ds_read_b64_tr_b16 v[26:27], v3 offset:47104
  s_waitcnt lgkmcnt(10)
  v_mfma_f32_32x32x16_bf16 v[96:111], v[28:31], v[164:167], v[96:111]
  ds_read_b64_tr_b16 v[28:29], v3 offset:45312
  ds_read_b64_tr_b16 v[30:31], v3 offset:47360
  v_mfma_f32_32x32x16_bf16 v[112:127], v[32:35], v[164:167], v[112:127]
  ds_read_b64_tr_b16 v[32:33], v3 offset:45568
  ds_read_b64_tr_b16 v[34:35], v3 offset:47616
  s_waitcnt lgkmcnt(10)
  v_mfma_f32_32x32x16_bf16 v[64:79], v[36:39], v[168:171], v[64:79]
  buffer_load_dwordx4 v[232:235], v1, s[8:11], s21 offen offset:2048 sc1
  ds_read_b64_tr_b16 v[36:37], v3 offset:45824
  ds_read_b64_tr_b16 v[38:39], v3 offset:47872
  v_mfma_f32_32x32x16_bf16 v[80:95], v[40:43], v[168:171], v[80:95]
  ds_read_b64_tr_b16 v[40:41], v3 offset:49152
  ds_read_b64_tr_b16 v[42:43], v3 offset:51200
  s_waitcnt lgkmcnt(10)
  v_mfma_f32_32x32x16_bf16 v[96:111], v[16:19], v[168:171], v[96:111]
  ds_read_b64_tr_b16 v[16:17], v3 offset:49408
  ds_read_b64_tr_b16 v[18:19], v3 offset:51456
  v_mfma_f32_32x32x16_bf16 v[112:127], v[20:23], v[168:171], v[112:127]
  buffer_load_dwordx4 v[236:239], v1, s[8:11], s21 offen offset:3072 sc1
  ds_read_b64_tr_b16 v[20:21], v3 offset:49664
  ds_read_b64_tr_b16 v[22:23], v3 offset:51712
  s_waitcnt lgkmcnt(10)
  v_mfma_f32_32x32x16_bf16 v[64:79], v[24:27], v[172:175], v[64:79]
  ds_read_b64_tr_b16 v[24:25], v3 offset:49920
  ds_read_b64_tr_b16 v[26:27], v3 offset:51968
  v_mfma_f32_32x32x16_bf16 v[80:95], v[28:31], v[172:175], v[80:95]
  ds_read_b64_tr_b16 v[28:29], v3 offset:53248
  ds_read_b64_tr_b16 v[30:31], v3 offset:55296
  s_waitcnt lgkmcnt(10)
  v_mfma_f32_32x32x16_bf16 v[96:111], v[32:35], v[172:175], v[96:111]
  s_add_u32 s21, s21, 4096
  buffer_load_dwordx4 v[240:243], v1, s[8:11], s21 offen offset:0 sc1
  ds_read_b64_tr_b16 v[32:33], v3 offset:53504
  ds_read_b64_tr_b16 v[34:35], v3 offset:55552
  v_mfma_f32_32x32x16_bf16 v[112:127], v[36:39], v[172:175], v[112:127]
  ds_read_b64_tr_b16 v[36:37], v3 offset:53760
  ds_read_b64_tr_b16 v[38:39], v3 offset:55808
  s_waitcnt lgkmcnt(10)
  v_mfma_f32_32x32x16_bf16 v[64:79], v[40:43], v[176:179], v[64:79]
  ds_read_b64_tr_b16 v[40:41], v3 offset:54016
  ds_read_b64_tr_b16 v[42:43], v3 offset:56064
  v_mfma_f32_32x32x16_bf16 v[80:95], v[16:19], v[176:179], v[80:95]
  buffer_load_dwordx4 v[244:247], v1, s[8:11], s21 offen offset:1024 sc1
  ds_read_b64_tr_b16 v[16:17], v3 offset:57344
  ds_read_b64_tr_b16 v[18:19], v3 offset:59392
  s_waitcnt lgkmcnt(10)
  v_mfma_f32_32x32x16_bf16 v[96:111], v[20:23], v[176:179], v[96:111]
  ds_read_b64_tr_b16 v[20:21], v3 offset:57600
  ds_read_b64_tr_b16 v[22:23], v3 offset:59648
  v_mfma_f32_32x32x16_bf16 v[112:127], v[24:27], v[176:179], v[112:127]
  ds_read_b64_tr_b16 v[24:25], v3 offset:57856
  ds_read_b64_tr_b16 v[26:27], v3 offset:59904
  s_waitcnt lgkmcnt(10)
  v_mfma_f32_32x32x16_bf16 v[64:79], v[28:31], v[180:183], v[64:79]
  buffer_load_dwordx4 v[248:251], v1, s[8:11], s21 offen offset:2048 sc1
  ds_read_b64_tr_b16 v[28:29], v3 offset:58112
  ds_read_b64_tr_b16 v[30:31], v3 offset:60160
  v_mfma_f32_32x32x16_bf16 v[80:95], v[32:35], v[180:183], v[80:95]
  ds_read_b64_tr_b16 v[32:33], v3 offset:61440
  ds_read_b64_tr_b16 v[34:35], v3 offset:63488
  s_waitcnt lgkmcnt(10)
  v_mfma_f32_32x32x16_bf16 v[96:111], v[36:39], v[180:183], v[96:111]
  ds_read_b64_tr_b16 v[36:37], v3 offset:61696
  ds_read_b64_tr_b16 v[38:39], v3 offset:63744
  v_mfma_f32_32x32x16_bf16 v[112:127], v[40:43], v[180:183], v[112:127]
  buffer_load_dwordx4 v[252:255], v1, s[8:11], s21 offen offset:3072 sc1
  ds_read_b64_tr_b16 v[40:41], v3 offset:61952
  ds_read_b64_tr_b16 v[42:43], v3 offset:64000
  s_waitcnt lgkmcnt(10)
  v_mfma_f32_32x32x16_bf16 v[64:79], v[16:19], v[184:187], v[64:79]
  ds_read_b64_tr_b16 v[16:17], v3 offset:62208
  ds_read_b64_tr_b16 v[18:19], v3 offset:64256
  v_mfma_f32_32x32x16_bf16 v[80:95], v[20:23], v[184:187], v[80:95]
  s_waitcnt lgkmcnt(8)
  v_mfma_f32_32x32x16_bf16 v[96:111], v[24:27], v[184:187], v[96:111]
  v_mfma_f32_32x32x16_bf16 v[112:127], v[28:31], v[184:187], v[112:127]
  s_waitcnt lgkmcnt(4)
  v_mfma_f32_32x32x16_bf16 v[64:79], v[32:35], v[188:191], v[64:79]
  v_mfma_f32_32x32x16_bf16 v[80:95], v[36:39], v[188:191], v[80:95]
  s_waitcnt lgkmcnt(0)
  v_mfma_f32_32x32x16_bf16 v[96:111], v[40:43], v[188:191], v[96:111]
  v_mfma_f32_32x32x16_bf16 v[112:127], v[16:19], v[188:191], v[112:127]
  s_barrier
  v_lshlrev_b32 v5, 3, v8
  v_add_u32 v5, 131072, v5
  ds_read_b64 v[144:145], v5 offset:128
  ds_read_b64 v[146:147], v5 offset:144
  ds_read_b64 v[148:149], v5 offset:160
  ds_read_b64 v[150:151], v5 offset:176
  ds_read_b64 v[152:153], v5 offset:192
  ds_read_b64 v[154:155], v5 offset:208
  ds_read_b64 v[156:157], v5 offset:224
  ds_read_b64 v[158:159], v5 offset:240
  s_waitcnt lgkmcnt(0)
  ds_read_b64_tr_b16 v[20:21], v4 offset:0
  ds_read_b64_tr_b16 v[22:23], v4 offset:2048
  ds_read_b64_tr_b16 v[24:25], v4 offset:256
  ds_read_b64_tr_b16 v[26:27], v4 offset:2304
  ds_read_b64_tr_b16 v[28:29], v4 offset:512
  ds_read_b64_tr_b16 v[30:31], v4 offset:2560
  ds_read_b64_tr_b16 v[32:33], v4 offset:768
  ds_read_b64_tr_b16 v[34:35], v4 offset:2816
  ds_read_b64_tr_b16 v[36:37], v4 offset:4096
  ds_read_b64_tr_b16 v[38:39], v4 offset:6144
  ds_read_b64_tr_b16 v[40:41], v4 offset:4352
  ds_read_b64_tr_b16 v[42:43], v4 offset:6400
  ds_read_b64_tr_b16 v[16:17], v4 offset:4608
  ds_read_b64_tr_b16 v[18:19], v4 offset:6656
  s_waitcnt vmcnt(8)
  s_waitcnt lgkmcnt(10)
  v_mfma_f32_32x32x16_bf16 v[64:79], v[20:23], v[192:195], v[64:79]
  ds_read_b64_tr_b16 v[20:21], v4 offset:4864
  ds_read_b64_tr_b16 v[22:23], v4 offset:6912
  v_mfma_f32_32x32x16_bf16 v[80:95], v[24:27], v[192:195], v[80:95]
  ds_read_b64_tr_b16 v[24:25], v4 offset:8192
  ds_read_b64_tr_b16 v[26:27], v4 offset:10240
  s_waitcnt lgkmcnt(10)
  v_mfma_f32_32x32x16_bf16 v[96:111], v[28:31], v[192:195], v[96:111]
  ds_read_b64_tr_b16 v[28:29], v4 offset:8448
  ds_read_b64_tr_b16 v[30:31], v4 offset:10496
  v_mfma_f32_32x32x16_bf16 v[112:127], v[32:35], v[192:195], v[112:127]
  ds_read_b64_tr_b16 v[32:33], v4 offset:8704
  ds_read_b64_tr_b16 v[34:35], v4 offset:10752
  s_waitcnt lgkmcnt(10)
  v_mfma_f32_32x32x16_bf16 v[64:79], v[36:39], v[196:199], v[64:79]
  ds_read_b64_tr_b16 v[36:37], v4 offset:8960
  ds_read_b64_tr_b16 v[38:39], v4 offset:11008
  v_mfma_f32_32x32x16_bf16 v[80:95], v[40:43], v[196:199], v[80:95]
  ds_read_b64_tr_b16 v[40:41], v4 offset:12288
  ds_read_b64_tr_b16 v[42:43], v4 offset:14336
  s_waitcnt lgkmcnt(10)
  v_mfma_f32_32x32x16_bf16 v[96:111], v[16:19], v[196:199], v[96:111]
  ds_read_b64_tr_b16 v[16:17], v4 offset:12544
  ds_read_b64_tr_b16 v[18:19], v4 offset:14592
  v_mfma_f32_32x32x16_bf16 v[112:127], v[20:23], v[196:199], v[112:127]
  ds_read_b64_tr_b16 v[20:21], v4 offset:12800
  ds_read_b64_tr_b16 v[22:23], v4 offset:14848
  s_waitcnt lgkmcnt(10)
  v_mfma_f32_32x32x16_bf16 v[64:79], v[24:27], v[200:203], v[64:79]
  ds_read_b64_tr_b16 v[24:25], v4 offset:13056
  ds_read_b64_tr_b16 v[26:27], v4 offset:15104
  v_mfma_f32_32x32x16_bf16 v[80:95], v[28:31], v[200:203], v[80:95]
  ds_read_b64_tr_b16 v[28:29], v4 offset:16384
  ds_read_b64_tr_b16 v[30:31], v4 offset:18432
  s_waitcnt lgkmcnt(10)
  v_mfma_f32_32x32x16_bf16 v[96:111], v[32:35], v[200:203], v[96:111]
  ds_read_b64_tr_b16 v[32:33], v4 offset:16640
  ds_read_b64_tr_b16 v[34:35], v4 offset:18688
  v_mfma_f32_32x32x16_bf16 v[112:127], v[36:39], v[200:203], v[112:127]
  ds_read_b64_tr_b16 v[36:37], v4 offset:16896
  ds_read_b64_tr_b16 v[38:39], v4 offset:18944
  s_waitcnt lgkmcnt(10)
  v_mfma_f32_32x32x16_bf16 v[64:79], v[40:43], v[204:207], v[64:79]
  ds_read_b64_tr_b16 v[40:41], v4 offset:17152
  ds_read_b64_tr_b16 v[42:43], v4 offset:19200
  v_mfma_f32_32x32x16_bf16 v[80:95], v[16:19], v[204:207], v[80:95]
  ds_read_b64_tr_b16 v[16:17], v4 offset:20480
  ds_read_b64_tr_b16 v[18:19], v4 offset:22528
  s_waitcnt lgkmcnt(10)
  v_mfma_f32_32x32x16_bf16 v[96:111], v[20:23], v[204:207], v[96:111]
  ds_read_b64_tr_b16 v[20:21], v4 offset:20736
  ds_read_b64_tr_b16 v[22:23], v4 offset:22784
  v_mfma_f32_32x32x16_bf16 v[112:127], v[24:27], v[204:207], v[112:127]
  ds_read_b64_tr_b16 v[24:25], v4 offset:20992
  ds_read_b64_tr_b16 v[26:27], v4 offset:23040
  s_waitcnt lgkmcnt(10)
  v_mfma_f32_32x32x16_bf16 v[64:79], v[28:31], v[208:211], v[64:79]
  ds_read_b64_tr_b16 v[28:29], v4 offset:21248
  ds_read_b64_tr_b16 v[30:31], v4 offset:23296
  v_mfma_f32_32x32x16_bf16 v[80:95], v[32:35], v[208:211], v[80:95]
  ds_read_b64_tr_b16 v[32:33], v4 offset:24576
  ds_read_b64_tr_b16 v[34:35], v4 offset:26624
  s_waitcnt lgkmcnt(10)
  v_mfma_f32_32x32x16_bf16 v[96:111], v[36:39], v[208:211], v[96:111]
  ds_read_b64_tr_b16 v[36:37], v4 offset:24832
  ds_read_b64_tr_b16 v[38:39], v4 offset:26880
  v_mfma_f32_32x32x16_bf16 v[112:127], v[40:43], v[208:211], v[112:127]
  ds_read_b64_tr_b16 v[40:41], v4 offset:25088
  ds_read_b64_tr_b16 v[42:43], v4 offset:27136
  s_waitcnt lgkmcnt(10)
  v_mfma_f32_32x32x16_bf16 v[64:79], v[16:19], v[212:215], v[64:79]
  ds_read_b64_tr_b16 v[16:17], v4 offset:25344
  ds_read_b64_tr_b16 v[18:19], v4 offset:27392
  v_mfma_f32_32x32x16_bf16 v[80:95], v[20:23], v[212:215], v[80:95]
  ds_read_b64_tr_b16 v[20:21], v4 offset:28672
  ds_read_b64_tr_b16 v[22:23], v4 offset:30720
  s_waitcnt lgkmcnt(10)
  v_mfma_f32_32x32x16_bf16 v[96:111], v[24:27], v[212:215], v[96:111]
  ds_read_b64_tr_b16 v[24:25], v4 offset:28928
  ds_read_b64_tr_b16 v[26:27], v4 offset:30976
  v_mfma_f32_32x32x16_bf16 v[112:127], v[28:31], v[212:215], v[112:127]
  ds_read_b64_tr_b16 v[28:29], v4 offset:29184
  ds_read_b64_tr_b16 v[30:31], v4 offset:31232
  s_waitcnt lgkmcnt(10)
  v_mfma_f32_32x32x16_bf16 v[64:79], v[32:35], v[216:219], v[64:79]
  ds_read_b64_tr_b16 v[32:33], v4 offset:29440
  ds_read_b64_tr_b16 v[34:35], v4 offset:31488
  v_mfma_f32_32x32x16_bf16 v[80:95], v[36:39], v[216:219], v[80:95]
  s_waitcnt lgkmcnt(8)
  v_mfma_f32_32x32x16_bf16 v[96:111], v[40:43], v[216:219], v[96:111]
  v_mfma_f32_32x32x16_bf16 v[112:127], v[16:19], v[216:219], v[112:127]
  s_waitcnt lgkmcnt(4)
  v_mfma_f32_32x32x16_bf16 v[64:79], v[20:23], v[220:223], v[64:79]
  v_mfma_f32_32x32x16_bf16 v[80:95], v[24:27], v[220:223], v[80:95]
  s_waitcnt lgkmcnt(0)
  v_mfma_f32_32x32x16_bf16 v[96:111], v[28:31], v[220:223], v[96:111]
  v_mfma_f32_32x32x16_bf16 v[112:127], v[32:35], v[220:223], v[112:127]
  s_barrier
  s_mul_i32 s48, s25, 114688
  s_lshl_b32 s49, s18, 13
  s_add_u32 s48, s48, s49
  s_add_u32 s48, s48, 0x3a00000
  s_add_u32 s49, s48, 4096
  ds_read_b64_tr_b16 v[36:37], v4 offset:32768
  ds_read_b64_tr_b16 v[38:39], v4 offset:34816
  ds_read_b64_tr_b16 v[40:41], v4 offset:36864
  ds_read_b64_tr_b16 v[42:43], v4 offset:38912
  ds_read_b64_tr_b16 v[16:17], v4 offset:40960
  ds_read_b64_tr_b16 v[18:19], v4 offset:43008
  ds_read_b64_tr_b16 v[20:21], v4 offset:45056
  ds_read_b64_tr_b16 v[22:23], v4 offset:47104
  ds_read_b64_tr_b16 v[24:25], v4 offset:49152
  ds_read_b64_tr_b16 v[26:27], v4 offset:51200
  ds_read_b64_tr_b16 v[28:29], v4 offset:53248
  ds_read_b64_tr_b16 v[30:31], v4 offset:55296
  ds_read_b64_tr_b16 v[32:33], v4 offset:57344
  ds_read_b64_tr_b16 v[34:35], v4 offset:59392
  s_waitcnt vmcnt(0)
  s_waitcnt lgkmcnt(10)
  v_mfma_f32_32x32x16_bf16 v[64:79], v[36:39], v[224:227], v[64:79]
  ds_read_b64_tr_b16 v[36:37], v4 offset:61440
  ds_read_b64_tr_b16 v[38:39], v4 offset:63488
  v_mfma_f32_32x32x16_bf16 v[64:79], v[40:43], v[228:231], v[64:79]
  ds_read_b64_tr_b16 v[40:41], v4 offset:33024
  ds_read_b64_tr_b16 v[42:43], v4 offset:35072
  s_waitcnt lgkmcnt(10)
  v_mfma_f32_32x32x16_bf16 v[64:79], v[16:19], v[232:235], v[64:79]
  ds_read_b64_tr_b16 v[16:17], v4 offset:37120
  ds_read_b64_tr_b16 v[18:19], v4 offset:39168
  v_mfma_f32_32x32x16_bf16 v[64:79], v[20:23], v[236:239], v[64:79]
  ds_read_b64_tr_b16 v[20:21], v4 offset:41216
  ds_read_b64_tr_b16 v[22:23], v4 offset:43264
  s_waitcnt lgkmcnt(10)
  v_mfma_f32_32x32x16_bf16 v[64:79], v[24:27], v[240:243], v[64:79]
  ds_read_b64_tr_b16 v[24:25], v4 offset:45312
  ds_read_b64_tr_b16 v[26:27], v4 offset:47360
  v_mfma_f32_32x32x16_bf16 v[64:79], v[28:31], v[244:247], v[64:79]
  ds_read_b64_tr_b16 v[28:29], v4 offset:49408
  ds_read_b64_tr_b16 v[30:31], v4 offset:51456
  s_waitcnt lgkmcnt(10)
  v_mfma_f32_32x32x16_bf16 v[64:79], v[32:35], v[248:251], v[64:79]
  ds_read_b64_tr_b16 v[32:33], v4 offset:53504
  ds_read_b64_tr_b16 v[34:35], v4 offset:55552
  v_mfma_f32_32x32x16_bf16 v[64:79], v[36:39], v[252:255], v[64:79]
  ds_read_b64_tr_b16 v[36:37], v4 offset:57600
  ds_read_b64_tr_b16 v[38:39], v4 offset:59648
  s_waitcnt lgkmcnt(10)
  v_mfma_f32_32x32x16_bf16 v[80:95], v[40:43], v[224:227], v[80:95]
  ds_read_b64_tr_b16 v[40:41], v4 offset:61696
  ds_read_b64_tr_b16 v[42:43], v4 offset:63744
  v_mfma_f32_32x32x16_bf16 v[80:95], v[16:19], v[228:231], v[80:95]
  ds_read_b64_tr_b16 v[16:17], v4 offset:33280
  ds_read_b64_tr_b16 v[18:19], v4 offset:35328
  s_waitcnt lgkmcnt(10)
  v_mfma_f32_32x32x16_bf16 v[80:95], v[20:23], v[232:235], v[80:95]
  ds_read_b64_tr_b16 v[20:21], v4 offset:37376
  ds_read_b64_tr_b16 v[22:23], v4 offset:39424
  v_mfma_f32_32x32x16_bf16 v[80:95], v[24:27], v[236:239], v[80:95]
  s_nop 3
  v_lshlrev_b32 v176, 16, v128
  v_and_b32 v177, 0xffff0000, v128
  v_lshlrev_b32 v178, 16, v129
  v_and_b32 v179, 0xffff0000, v129
  v_add_f32 v64, v64, v176
  v_add_f32 v65, v65, v177
  v_add_f32 v66, v66, v178
  v_add_f32 v67, v67, v179
  v_lshlrev_b32 v176, 16, v130
  v_and_b32 v177, 0xffff0000, v130
  v_lshlrev_b32 v178, 16, v131
  ds_read_b64_tr_b16 v[24:25], v4 offset:41472
  ds_read_b64_tr_b16 v[26:27], v4 offset:43520
  s_waitcnt lgkmcnt(10)
  v_mfma_f32_32x32x16_bf16 v[80:95], v[28:31], v[240:243], v[80:95]
  v_and_b32 v179, 0xffff0000, v131
  v_add_f32 v68, v68, v176
  v_add_f32 v69, v69, v177
  v_add_f32 v70, v70, v178
  v_add_f32 v71, v71, v179
  v_max_f32 v64, 0, v64
  v_max_f32 v65, 0, v65
  v_max_f32 v66, 0, v66
  v_max_f32 v67, 0, v67
  v_max_f32 v68, 0, v68
  v_max_f32 v69, 0, v69
  v_max_f32 v70, 0, v70
  ds_read_b64_tr_b16 v[28:29], v4 offset:45568
  ds_read_b64_tr_b16 v[30:31], v4 offset:47616
  v_mfma_f32_32x32x16_bf16 v[80:95], v[32:35], v[244:247], v[80:95]
  v_max_f32 v71, 0, v71
  v_mul_f32 v64, v64, v64
  v_mul_f32 v65, v65, v65
  v_mul_f32 v66, v66, v66
  v_mul_f32 v67, v67, v67
  v_mul_f32 v68, v68, v68
  v_mul_f32 v69, v69, v69
  v_mul_f32 v70, v70, v70
  v_mul_f32 v71, v71, v71
  v_cvt_pk_bf16_f32 v64, v64, v65
  v_cvt_pk_bf16_f32 v65, v66, v67
  v_cvt_pk_bf16_f32 v66, v68, v69
  ds_read_b64_tr_b16 v[32:33], v4 offset:49664
  ds_read_b64_tr_b16 v[34:35], v4 offset:51712
  s_waitcnt lgkmcnt(10)
  v_mfma_f32_32x32x16_bf16 v[80:95], v[36:39], v[248:251], v[80:95]
  v_cvt_pk_bf16_f32 v67, v70, v71
  buffer_store_dwordx4 v[64:67], v1, s[8:11], s48 offen offset:0 sc1
  v_lshlrev_b32 v176, 16, v132
  v_and_b32 v177, 0xffff0000, v132
  v_lshlrev_b32 v178, 16, v133
  v_and_b32 v179, 0xffff0000, v133
  v_add_f32 v72, v72, v176
  v_add_f32 v73, v73, v177
  v_add_f32 v74, v74, v178
  v_add_f32 v75, v75, v179
  v_lshlrev_b32 v176, 16, v134
  v_and_b32 v177, 0xffff0000, v134
  ds_read_b64_tr_b16 v[36:37], v4 offset:53760
  ds_read_b64_tr_b16 v[38:39], v4 offset:55808
  v_mfma_f32_32x32x16_bf16 v[80:95], v[40:43], v[252:255], v[80:95]
  v_lshlrev_b32 v178, 16, v135
  v_and_b32 v179, 0xffff0000, v135
  v_add_f32 v76, v76, v176
  v_add_f32 v77, v77, v177
  v_add_f32 v78, v78, v178
  v_add_f32 v79, v79, v179
  v_max_f32 v72, 0, v72
  v_max_f32 v73, 0, v73
  v_max_f32 v74, 0, v74
  v_max_f32 v75, 0, v75
  v_max_f32 v76, 0, v76
  v_max_f32 v77, 0, v77
  ds_read_b64_tr_b16 v[40:41], v4 offset:57856
  ds_read_b64_tr_b16 v[42:43], v4 offset:59904
  s_waitcnt lgkmcnt(10)
  v_mfma_f32_32x32x16_bf16 v[96:111], v[16:19], v[224:227], v[96:111]
  v_max_f32 v78, 0, v78
  v_max_f32 v79, 0, v79
  v_mul_f32 v72, v72, v72
  v_mul_f32 v73, v73, v73
  v_mul_f32 v74, v74, v74
  v_mul_f32 v75, v75, v75
  v_mul_f32 v76, v76, v76
  v_mul_f32 v77, v77, v77
  v_mul_f32 v78, v78, v78
  v_mul_f32 v79, v79, v79
  v_cvt_pk_bf16_f32 v72, v72, v73
  v_cvt_pk_bf16_f32 v73, v74, v75
  ds_read_b64_tr_b16 v[16:17], v4 offset:61952
  ds_read_b64_tr_b16 v[18:19], v4 offset:64000
  v_mfma_f32_32x32x16_bf16 v[96:111], v[20:23], v[228:231], v[96:111]
  v_cvt_pk_bf16_f32 v74, v76, v77
  v_cvt_pk_bf16_f32 v75, v78, v79
  buffer_store_dwordx4 v[72:75], v1, s[8:11], s48 offen offset:1024 sc1
  ds_read_b64_tr_b16 v[20:21], v4 offset:33536
  ds_read_b64_tr_b16 v[22:23], v4 offset:35584
  s_waitcnt lgkmcnt(10)
  v_mfma_f32_32x32x16_bf16 v[96:111], v[24:27], v[232:235], v[96:111]
  ds_read_b64_tr_b16 v[24:25], v4 offset:37632
  ds_read_b64_tr_b16 v[26:27], v4 offset:39680
  v_mfma_f32_32x32x16_bf16 v[96:111], v[28:31], v[236:239], v[96:111]
  s_nop 3
  v_lshlrev_b32 v176, 16, v136
  v_and_b32 v177, 0xffff0000, v136
  v_lshlrev_b32 v178, 16, v137
  v_and_b32 v179, 0xffff0000, v137
  v_add_f32 v80, v80, v176
  v_add_f32 v81, v81, v177
  v_add_f32 v82, v82, v178
  v_add_f32 v83, v83, v179
  v_lshlrev_b32 v176, 16, v138
  v_and_b32 v177, 0xffff0000, v138
  v_lshlrev_b32 v178, 16, v139
  ds_read_b64_tr_b16 v[28:29], v4 offset:41728
  ds_read_b64_tr_b16 v[30:31], v4 offset:43776
  s_waitcnt lgkmcnt(10)
  v_mfma_f32_32x32x16_bf16 v[96:111], v[32:35], v[240:243], v[96:111]
  v_and_b32 v179, 0xffff0000, v139
  v_add_f32 v84, v84, v176
  v_add_f32 v85, v85, v177
  v_add_f32 v86, v86, v178
  v_add_f32 v87, v87, v179
  v_max_f32 v80, 0, v80
  v_max_f32 v81, 0, v81
  v_max_f32 v82, 0, v82
  v_max_f32 v83, 0, v83
  v_max_f32 v84, 0, v84
  v_max_f32 v85, 0, v85
  v_max_f32 v86, 0, v86
  ds_read_b64_tr_b16 v[32:33], v4 offset:45824
  ds_read_b64_tr_b16 v[34:35], v4 offset:47872
  v_mfma_f32_32x32x16_bf16 v[96:111], v[36:39], v[244:247], v[96:111]
  v_max_f32 v87, 0, v87
  v_mul_f32 v80, v80, v80
  v_mul_f32 v81, v81, v81
  v_mul_f32 v82, v82, v82
  v_mul_f32 v83, v83, v83
  v_mul_f32 v84, v84, v84
  v_mul_f32 v85, v85, v85
  v_mul_f32 v86, v86, v86
  v_mul_f32 v87, v87, v87
  v_cvt_pk_bf16_f32 v80, v80, v81
  v_cvt_pk_bf16_f32 v81, v82, v83
  v_cvt_pk_bf16_f32 v82, v84, v85
  ds_read_b64_tr_b16 v[36:37], v4 offset:49920
  ds_read_b64_tr_b16 v[38:39], v4 offset:51968
  s_waitcnt lgkmcnt(10)
  v_mfma_f32_32x32x16_bf16 v[96:111], v[40:43], v[248:251], v[96:111]
  v_cvt_pk_bf16_f32 v83, v86, v87
  buffer_store_dwordx4 v[80:83], v1, s[8:11], s48 offen offset:2048 sc1
  v_lshlrev_b32 v176, 16, v140
  v_and_b32 v177, 0xffff0000, v140
  v_lshlrev_b32 v178, 16, v141
  v_and_b32 v179, 0xffff0000, v141
  v_add_f32 v88, v88, v176
  v_add_f32 v89, v89, v177
  v_add_f32 v90, v90, v178
  v_add_f32 v91, v91, v179
  v_lshlrev_b32 v176, 16, v142
  v_and_b32 v177, 0xffff0000, v142
  ds_read_b64_tr_b16 v[40:41], v4 offset:54016
  ds_read_b64_tr_b16 v[42:43], v4 offset:56064
  v_mfma_f32_32x32x16_bf16 v[96:111], v[16:19], v[252:255], v[96:111]
  v_lshlrev_b32 v178, 16, v143
  v_and_b32 v179, 0xffff0000, v143
  v_add_f32 v92, v92, v176
  v_add_f32 v93, v93, v177
  v_add_f32 v94, v94, v178
  v_add_f32 v95, v95, v179
  v_max_f32 v88, 0, v88
  v_max_f32 v89, 0, v89
  v_max_f32 v90, 0, v90
  v_max_f32 v91, 0, v91
  v_max_f32 v92, 0, v92
  v_max_f32 v93, 0, v93
  ds_read_b64_tr_b16 v[16:17], v4 offset:58112
  ds_read_b64_tr_b16 v[18:19], v4 offset:60160
  s_waitcnt lgkmcnt(10)
  v_mfma_f32_32x32x16_bf16 v[112:127], v[20:23], v[224:227], v[112:127]
  v_max_f32 v94, 0, v94
  v_max_f32 v95, 0, v95
  v_mul_f32 v88, v88, v88
  v_mul_f32 v89, v89, v89
  v_mul_f32 v90, v90, v90
  v_mul_f32 v91, v91, v91
  v_mul_f32 v92, v92, v92
  v_mul_f32 v93, v93, v93
  v_mul_f32 v94, v94, v94
  v_mul_f32 v95, v95, v95
  v_cvt_pk_bf16_f32 v88, v88, v89
  v_cvt_pk_bf16_f32 v89, v90, v91
  ds_read_b64_tr_b16 v[20:21], v4 offset:62208
  ds_read_b64_tr_b16 v[22:23], v4 offset:64256
  v_mfma_f32_32x32x16_bf16 v[112:127], v[24:27], v[228:231], v[112:127]
  v_cvt_pk_bf16_f32 v90, v92, v93
  v_cvt_pk_bf16_f32 v91, v94, v95
  buffer_store_dwordx4 v[88:91], v1, s[8:11], s48 offen offset:3072 sc1
  s_waitcnt lgkmcnt(8)
  v_mfma_f32_32x32x16_bf16 v[112:127], v[28:31], v[232:235], v[112:127]
  v_mfma_f32_32x32x16_bf16 v[112:127], v[32:35], v[236:239], v[112:127]
  s_nop 3
  v_lshlrev_b32 v176, 16, v144
  v_and_b32 v177, 0xffff0000, v144
  v_lshlrev_b32 v178, 16, v145
  v_and_b32 v179, 0xffff0000, v145
  v_add_f32 v96, v96, v176
  v_add_f32 v97, v97, v177
  v_add_f32 v98, v98, v178
  v_add_f32 v99, v99, v179
  v_lshlrev_b32 v176, 16, v146
  v_and_b32 v177, 0xffff0000, v146
  v_lshlrev_b32 v178, 16, v147
  s_waitcnt lgkmcnt(4)
  v_mfma_f32_32x32x16_bf16 v[112:127], v[36:39], v[240:243], v[112:127]
  v_and_b32 v179, 0xffff0000, v147
  v_add_f32 v100, v100, v176
  v_add_f32 v101, v101, v177
  v_add_f32 v102, v102, v178
  v_add_f32 v103, v103, v179
  v_max_f32 v96, 0, v96
  v_max_f32 v97, 0, v97
  v_max_f32 v98, 0, v98
  v_max_f32 v99, 0, v99
  v_max_f32 v100, 0, v100
  v_max_f32 v101, 0, v101
  v_max_f32 v102, 0, v102
  v_mfma_f32_32x32x16_bf16 v[112:127], v[40:43], v[244:247], v[112:127]
  v_max_f32 v103, 0, v103
  v_mul_f32 v96, v96, v96
  v_mul_f32 v97, v97, v97
  v_mul_f32 v98, v98, v98
  v_mul_f32 v99, v99, v99
  v_mul_f32 v100, v100, v100
  v_mul_f32 v101, v101, v101
  v_mul_f32 v102, v102, v102
  v_mul_f32 v103, v103, v103
  v_cvt_pk_bf16_f32 v96, v96, v97
  v_cvt_pk_bf16_f32 v97, v98, v99
  v_cvt_pk_bf16_f32 v98, v100, v101
  s_waitcnt lgkmcnt(0)
  v_mfma_f32_32x32x16_bf16 v[112:127], v[16:19], v[248:251], v[112:127]
  v_cvt_pk_bf16_f32 v99, v102, v103
  buffer_store_dwordx4 v[96:99], v1, s[8:11], s49 offen offset:0 sc1
  v_lshlrev_b32 v176, 16, v148
  v_and_b32 v177, 0xffff0000, v148
  v_lshlrev_b32 v178, 16, v149
  v_and_b32 v179, 0xffff0000, v149
  v_add_f32 v104, v104, v176
  v_add_f32 v105, v105, v177
  v_add_f32 v106, v106, v178
  v_add_f32 v107, v107, v179
  v_lshlrev_b32 v176, 16, v150
  v_and_b32 v177, 0xffff0000, v150
  v_mfma_f32_32x32x16_bf16 v[112:127], v[20:23], v[252:255], v[112:127]
  v_lshlrev_b32 v178, 16, v151
  v_and_b32 v179, 0xffff0000, v151
  v_add_f32 v108, v108, v176
  v_add_f32 v109, v109, v177
  v_add_f32 v110, v110, v178
  v_add_f32 v111, v111, v179
  v_max_f32 v104, 0, v104
  v_max_f32 v105, 0, v105
  v_max_f32 v106, 0, v106
  v_max_f32 v107, 0, v107
  v_max_f32 v108, 0, v108
  v_max_f32 v109, 0, v109
  v_max_f32 v110, 0, v110
  v_max_f32 v111, 0, v111
  v_mul_f32 v104, v104, v104
  v_mul_f32 v105, v105, v105
  v_mul_f32 v106, v106, v106
  v_mul_f32 v107, v107, v107
  v_mul_f32 v108, v108, v108
  v_mul_f32 v109, v109, v109
  v_mul_f32 v110, v110, v110
  v_mul_f32 v111, v111, v111
  v_cvt_pk_bf16_f32 v104, v104, v105
  v_cvt_pk_bf16_f32 v105, v106, v107
  v_cvt_pk_bf16_f32 v106, v108, v109
  v_cvt_pk_bf16_f32 v107, v110, v111
  buffer_store_dwordx4 v[104:107], v1, s[8:11], s49 offen offset:1024 sc1
  s_nop 7
  s_nop 3
  v_lshlrev_b32 v176, 16, v152
  v_and_b32 v177, 0xffff0000, v152
  v_lshlrev_b32 v178, 16, v153
  v_and_b32 v179, 0xffff0000, v153
  v_add_f32 v112, v112, v176
  v_add_f32 v113, v113, v177
  v_add_f32 v114, v114, v178
  v_add_f32 v115, v115, v179
  v_lshlrev_b32 v176, 16, v154
  v_and_b32 v177, 0xffff0000, v154
  v_lshlrev_b32 v178, 16, v155
  v_and_b32 v179, 0xffff0000, v155
  v_add_f32 v116, v116, v176
  v_add_f32 v117, v117, v177
  v_add_f32 v118, v118, v178
  v_add_f32 v119, v119, v179
  v_max_f32 v112, 0, v112
  v_max_f32 v113, 0, v113
  v_max_f32 v114, 0, v114
  v_max_f32 v115, 0, v115
  v_max_f32 v116, 0, v116
  v_max_f32 v117, 0, v117
  v_max_f32 v118, 0, v118
  v_max_f32 v119, 0, v119
  v_mul_f32 v112, v112, v112
  v_mul_f32 v113, v113, v113
  v_mul_f32 v114, v114, v114
  v_mul_f32 v115, v115, v115
  v_mul_f32 v116, v116, v116
  v_mul_f32 v117, v117, v117
  v_mul_f32 v118, v118, v118
  v_mul_f32 v119, v119, v119
  v_cvt_pk_bf16_f32 v112, v112, v113
  v_cvt_pk_bf16_f32 v113, v114, v115
  v_cvt_pk_bf16_f32 v114, v116, v117
  v_cvt_pk_bf16_f32 v115, v118, v119
  buffer_store_dwordx4 v[112:115], v1, s[8:11], s49 offen offset:2048 sc1
  v_lshlrev_b32 v176, 16, v156
  v_and_b32 v177, 0xffff0000, v156
  v_lshlrev_b32 v178, 16, v157
  v_and_b32 v179, 0xffff0000, v157
  v_add_f32 v120, v120, v176
  v_add_f32 v121, v121, v177
  v_add_f32 v122, v122, v178
  v_add_f32 v123, v123, v179
  v_lshlrev_b32 v176, 16, v158
  v_and_b32 v177, 0xffff0000, v158
  v_lshlrev_b32 v178, 16, v159
  v_and_b32 v179, 0xffff0000, v159
  v_add_f32 v124, v124, v176
  v_add_f32 v125, v125, v177
  v_add_f32 v126, v126, v178
  v_add_f32 v127, v127, v179
  v_max_f32 v120, 0, v120
  v_max_f32 v121, 0, v121
  v_max_f32 v122, 0, v122
  v_max_f32 v123, 0, v123
  v_max_f32 v124, 0, v124
  v_max_f32 v125, 0, v125
  v_max_f32 v126, 0, v126
  v_max_f32 v127, 0, v127
  v_mul_f32 v120, v120, v120
  v_mul_f32 v121, v121, v121
  v_mul_f32 v122, v122, v122
  v_mul_f32 v123, v123, v123
  v_mul_f32 v124, v124, v124
  v_mul_f32 v125, v125, v125
  v_mul_f32 v126, v126, v126
  v_mul_f32 v127, v127, v127
  v_cvt_pk_bf16_f32 v120, v120, v121
  v_cvt_pk_bf16_f32 v121, v122, v123
  v_cvt_pk_bf16_f32 v122, v124, v125
  v_cvt_pk_bf16_f32 v123, v126, v127
  buffer_store_dwordx4 v[120:123], v1, s[8:11], s49 offen offset:3072 sc1
  s_waitcnt vmcnt(0)
sequential_preLN__compressed_kv_cla__dense_activation_squared_relu__prompt_kernel_b_t1:
  s_barrier
  s_cmp_lg_u32 s46, 0
  s_cbranch_scc1 Lf3_52
  s_cmp_ge_u32 s2, 224
  s_cbranch_scc1 Lf3_52
  s_lshl_b32 s21, s2, 7
  s_add_u32 s21, s21, 0x5220000
  v_mov_b32 v5, 1
  s_mov_b64 exec, 1
  buffer_store_dword v5, off, s[8:11], s21 sc1
  s_mov_b64 exec, -1
Lf3_52:
  s_load_dwordx2 s[4:5], s[0:1], 72
  s_load_dwordx2 s[16:17], s[0:1], 88
  s_load_dwordx2 s[20:21], s[0:1], 80
  s_load_dwordx2 s[8:9], s[0:1], 104
  s_mov_b32 s24, s46
  s_and_b32 s25, s2, 31
  s_lshr_b32 s26, s2, 5
  v_lshlrev_b32 v1, 4, v0
  v_lshrrev_b32 v4, 5, v0
  v_bfe_u32 v5, v0, 2, 2
  v_lshl_add_u32 v4, v4, 2, v5
  v_lshlrev_b32 v2, 10, v4
  v_bfe_u32 v4, v0, 4, 1
  v_lshl_add_u32 v2, v4, 6, v2
  v_and_b32 v4, 3, v0
  v_lshl_add_u32 v2, v4, 4, v2
  v_lshrrev_b32 v4, 5, v0
  v_lshlrev_b32 v3, 9, v4
  v_bfe_u32 v4, v0, 2, 2
  v_lshl_add_u32 v3, v4, 6, v3
  v_bfe_u32 v4, v0, 4, 1
  v_lshl_add_u32 v3, v4, 5, v3
  v_and_b32 v4, 3, v0
  v_lshl_add_u32 v3, v4, 3, v3
  s_mul_i32 s33, s24, 18432
  v_add_u32 v3, s33, v3
  s_waitcnt lgkmcnt(0)
  s_mov_b32 s6, 0x1c0000
  s_mov_b32 s7, 0x20000
  s_mov_b32 s10, 0x10000000
  s_mov_b32 s11, 0x20000
  s_mov_b32 s18, 0x200000
  s_mov_b32 s19, 0x20000
  s_mov_b32 s22, 0x400
  s_mov_b32 s23, 0x20000
  s_mul_i32 s30, s25, 229376
  s_mul_i32 s27, s24, 14336
  s_add_u32 s30, s30, s27
  s_add_u32 s30, s30, 0x3a00000
  s_add_u32 s31, s30, 114688
  s_mul_i32 s32, s24, 229376
  s_lshl_b32 s27, s26, 7
  s_add_u32 s32, s32, s27
  s_lshl_b32 s34, s26, 2
  s_lshr_b32 s27, s25, 3
  s_lshl_b32 s27, s27, 3
  s_add_u32 s34, s34, s27
  s_and_b32 s34, s34, 31
  s_mul_i32 s34, s34, 7
  s_lshr_b32 s34, s34, 4
  s_mov_b32 s34, 0
  s_mov_b32 s41, s34
  s_lshl_b32 s27, s34, 14
  s_add_u32 s27, s27, s32
  s_add_u32 m0, s33, 0
  s_add_u32 s28, s27, 8192
  buffer_load_dwordx4 v2, s[4:7], s27 offen lds
  s_add_u32 m0, s33, 1024
  s_nop 0
  buffer_load_dwordx4 v2, s[4:7], s28 offen lds
  s_add_u32 s34, s34, 1
  s_cmp_eq_u32 s34, 14
  s_cselect_b32 s34, 0, s34
  s_lshl_b32 s27, s34, 14
  s_add_u32 s27, s27, s32
  s_add_u32 m0, s33, 2048
  s_add_u32 s28, s27, 8192
  buffer_load_dwordx4 v2, s[4:7], s27 offen lds
  s_add_u32 m0, s33, 3072
  s_nop 0
  buffer_load_dwordx4 v2, s[4:7], s28 offen lds
  s_add_u32 s34, s34, 1
  s_cmp_eq_u32 s34, 14
  s_cselect_b32 s34, 0, s34
  s_lshl_b32 s27, s34, 14
  s_add_u32 s27, s27, s32
  s_add_u32 m0, s33, 4096
  s_add_u32 s28, s27, 8192
  buffer_load_dwordx4 v2, s[4:7], s27 offen lds
  s_add_u32 m0, s33, 5120
  s_nop 0
  buffer_load_dwordx4 v2, s[4:7], s28 offen lds
  s_add_u32 s34, s34, 1
  s_cmp_eq_u32 s34, 14
  s_cselect_b32 s34, 0, s34
  s_lshl_b32 s27, s34, 14
  s_add_u32 s27, s27, s32
  s_add_u32 m0, s33, 6144
  s_add_u32 s28, s27, 8192
  buffer_load_dwordx4 v2, s[4:7], s27 offen lds
  s_add_u32 m0, s33, 7168
  s_nop 0
  buffer_load_dwordx4 v2, s[4:7], s28 offen lds
  s_add_u32 s34, s34, 1
  s_cmp_eq_u32 s34, 14
  s_cselect_b32 s34, 0, s34
  s_lshl_b32 s27, s34, 14
  s_add_u32 s27, s27, s32
  s_add_u32 m0, s33, 8192
  s_add_u32 s28, s27, 8192
  buffer_load_dwordx4 v2, s[4:7], s27 offen lds
  s_add_u32 m0, s33, 9216
  s_nop 0
  buffer_load_dwordx4 v2, s[4:7], s28 offen lds
  s_add_u32 s34, s34, 1
  s_cmp_eq_u32 s34, 14
  s_cselect_b32 s34, 0, s34
  s_lshl_b32 s27, s34, 14
  s_add_u32 s27, s27, s32
  s_add_u32 m0, s33, 10240
  s_add_u32 s28, s27, 8192
  buffer_load_dwordx4 v2, s[4:7], s27 offen lds
  s_add_u32 m0, s33, 11264
  s_nop 0
  buffer_load_dwordx4 v2, s[4:7], s28 offen lds
  s_add_u32 s34, s34, 1
  s_cmp_eq_u32 s34, 14
  s_cselect_b32 s34, 0, s34
  s_lshl_b32 s27, s34, 14
  s_add_u32 s27, s27, s32
  s_add_u32 m0, s33, 12288
  s_add_u32 s28, s27, 8192
  buffer_load_dwordx4 v2, s[4:7], s27 offen lds
  s_add_u32 m0, s33, 13312
  s_nop 0
  buffer_load_dwordx4 v2, s[4:7], s28 offen lds
  s_add_u32 s34, s34, 1
  s_cmp_eq_u32 s34, 14
  s_cselect_b32 s34, 0, s34
  s_lshl_b32 s27, s34, 14
  s_add_u32 s27, s27, s32
  s_add_u32 m0, s33, 14336
  s_add_u32 s28, s27, 8192
  buffer_load_dwordx4 v2, s[4:7], s27 offen lds
  s_add_u32 m0, s33, 15360
  s_nop 0
  buffer_load_dwordx4 v2, s[4:7], s28 offen lds
  s_add_u32 s34, s34, 1
  s_cmp_eq_u32 s34, 14
  s_cselect_b32 s34, 0, s34
  s_mov_b32 s34, s41
  s_cmp_lg_u32 s24, 0
  s_cbranch_scc1 Lpw_53
  v_cmp_gt_u32 vcc, 14, v0
  s_nop 1
  v_cndmask_b32 v4, 0, v0, vcc
  v_lshrrev_b32 v5, 1, v4
  v_lshlrev_b32 v5, 5, v5
  v_and_b32 v4, 1, v4
  v_add_u32 v4, v4, v5
  s_lshr_b32 s27, s25, 1
  s_and_b32 s28, s27, 3
  s_lshl_b32 s28, s28, 3
  s_lshr_b32 s27, s27, 2
  s_lshl_b32 s27, s27, 1
  s_add_u32 s27, s27, s28
  v_add_u32 v4, s27, v4
  v_lshlrev_b32 v4, 7, v4
  s_mov_b32 s29, 0x5220000
  s_mov_b32 s42, 0x40000
Lfsp_57:
  buffer_load_dword v5, v4, s[8:11], s29 offen sc1
  s_waitcnt vmcnt(0)
  v_cmp_eq_u32 vcc, 1, v5
  s_nop 3
  s_cmp_eq_u64 vcc, -1
  s_cbranch_scc1 Lfok_56
  s_sleep 3
  s_sub_u32 s42, s42, 1
  s_cbranch_scc0 Lfsp_57
Lfok_56:
Lpw_53:
  s_barrier
  s_lshl_b32 s27, s34, 10
  s_add_u32 s29, s30, s27
  s_add_u32 s28, s31, s27
  s_add_u32 s34, s34, 1
  s_cmp_eq_u32 s34, 14
  s_cselect_b32 s34, 0, s34
  buffer_load_dwordx4 v[128:131], v1, s[8:11], s29 offen sc1
  buffer_load_dwordx4 v[132:135], v1, s[8:11], s28 offen sc1
  s_lshl_b32 s27, s34, 10
  s_add_u32 s29, s30, s27
  s_add_u32 s28, s31, s27
  s_add_u32 s34, s34, 1
  s_cmp_eq_u32 s34, 14
  s_cselect_b32 s34, 0, s34
  buffer_load_dwordx4 v[136:139], v1, s[8:11], s29 offen sc1
  buffer_load_dwordx4 v[140:143], v1, s[8:11], s28 offen sc1
  s_lshl_b32 s27, s34, 10
  s_add_u32 s29, s30, s27
  s_add_u32 s28, s31, s27
  s_add_u32 s34, s34, 1
  s_cmp_eq_u32 s34, 14
  s_cselect_b32 s34, 0, s34
  buffer_load_dwordx4 v[144:147], v1, s[8:11], s29 offen sc1
  buffer_load_dwordx4 v[148:151], v1, s[8:11], s28 offen sc1
  s_lshl_b32 s27, s34, 10
  s_add_u32 s29, s30, s27
  s_add_u32 s28, s31, s27
  s_add_u32 s34, s34, 1
  s_cmp_eq_u32 s34, 14
  s_cselect_b32 s34, 0, s34
  buffer_load_dwordx4 v[152:155], v1, s[8:11], s29 offen sc1
  buffer_load_dwordx4 v[156:159], v1, s[8:11], s28 offen sc1
  s_lshl_b32 s27, s34, 10
  s_add_u32 s29, s30, s27
  s_add_u32 s28, s31, s27
  s_add_u32 s34, s34, 1
  s_cmp_eq_u32 s34, 14
  s_cselect_b32 s34, 0, s34
  buffer_load_dwordx4 v[160:163], v1, s[8:11], s29 offen sc1
  buffer_load_dwordx4 v[164:167], v1, s[8:11], s28 offen sc1
  s_lshl_b32 s27, s34, 10
  s_add_u32 s29, s30, s27
  s_add_u32 s28, s31, s27
  s_add_u32 s34, s34, 1
  s_cmp_eq_u32 s34, 14
  s_cselect_b32 s34, 0, s34
  buffer_load_dwordx4 v[168:171], v1, s[8:11], s29 offen sc1
  buffer_load_dwordx4 v[172:175], v1, s[8:11], s28 offen sc1
  s_lshl_b32 s27, s34, 10
  s_add_u32 s29, s30, s27
  s_add_u32 s28, s31, s27
  s_add_u32 s34, s34, 1
  s_cmp_eq_u32 s34, 14
  s_cselect_b32 s34, 0, s34
  buffer_load_dwordx4 v[176:179], v1, s[8:11], s29 offen sc1
  buffer_load_dwordx4 v[180:183], v1, s[8:11], s28 offen sc1
  s_lshl_b32 s27, s34, 10
  s_add_u32 s29, s30, s27
  s_add_u32 s28, s31, s27
  s_add_u32 s34, s34, 1
  s_cmp_eq_u32 s34, 14
  s_cselect_b32 s34, 0, s34
  buffer_load_dwordx4 v[184:187], v1, s[8:11], s29 offen sc1
  buffer_load_dwordx4 v[188:191], v1, s[8:11], s28 offen sc1
  s_lshr_b32 s36, s24, 2
  s_bfe_u32 s37, s24, 0x10001
  s_and_b32 s38, s24, 1
  s_lshl_b32 s39, s25, 1
  s_add_u32 s39, s39, s37
  s_lshl_b32 s40, s26, 2
  s_lshl_b32 s27, s36, 1
  s_add_u32 s40, s40, s27
  s_add_u32 s40, s40, s38
  v_and_b32 v8, 31, v0
  v_lshrrev_b32 v9, 5, v0
  s_lshl_b32 s27, s39, 5
  s_add_u32 s27, s27, s40
  s_lshl_b32 s27, s27, 10
  s_add_u32 s27, s27, 0x3800000
  buffer_load_dwordx4 v[40:43], v1, s[8:11], s27 offen sc1
  v_lshlrev_b32 v10, 3, v9
  s_lshl_b32 s28, s40, 5
  buffer_load_dwordx2 v[44:45], v10, s[20:23], s28 offen
  buffer_load_dwordx2 v[46:47], v10, s[20:23], s28 offen offset:16
  s_waitcnt vmcnt(17)
  ds_read_b64_tr_b16 v[16:17], v3 offset:0
  ds_read_b64_tr_b16 v[18:19], v3 offset:1024
  ds_read_b64_tr_b16 v[20:21], v3 offset:256
  ds_read_b64_tr_b16 v[22:23], v3 offset:1280
  s_waitcnt vmcnt(15)
  ds_read_b64_tr_b16 v[24:25], v3 offset:2048
  ds_read_b64_tr_b16 v[26:27], v3 offset:3072
  ds_read_b64_tr_b16 v[28:29], v3 offset:2304
  ds_read_b64_tr_b16 v[30:31], v3 offset:3328
  s_waitcnt lgkmcnt(4)
  v_mfma_f32_32x32x16_bf16 v[64:79], v[16:19], v[128:131], 0
  v_mfma_f32_32x32x16_bf16 v[80:95], v[16:19], v[132:135], 0
  v_mfma_f32_32x32x16_bf16 v[96:111], v[20:23], v[128:131], 0
  v_mfma_f32_32x32x16_bf16 v[112:127], v[20:23], v[132:135], 0
  s_lshl_b32 s27, s34, 14
  s_add_u32 s27, s27, s32
  s_add_u32 m0, s33, 0
  s_add_u32 s28, s27, 8192
  buffer_load_dwordx4 v2, s[4:7], s27 offen lds
  s_add_u32 m0, s33, 1024
  s_nop 0
  buffer_load_dwordx4 v2, s[4:7], s28 offen lds
  s_lshl_b32 s27, s34, 10
  s_add_u32 s29, s30, s27
  s_add_u32 s28, s31, s27
  s_add_u32 s34, s34, 1
  s_cmp_eq_u32 s34, 14
  s_cselect_b32 s34, 0, s34
  buffer_load_dwordx4 v[128:131], v1, s[8:11], s29 offen sc1
  buffer_load_dwordx4 v[132:135], v1, s[8:11], s28 offen sc1
  s_waitcnt vmcnt(17)
  ds_read_b64_tr_b16 v[16:17], v3 offset:4096
  ds_read_b64_tr_b16 v[18:19], v3 offset:5120
  ds_read_b64_tr_b16 v[20:21], v3 offset:4352
  ds_read_b64_tr_b16 v[22:23], v3 offset:5376
  s_waitcnt lgkmcnt(4)
  v_mfma_f32_32x32x16_bf16 v[64:79], v[24:27], v[136:139], v[64:79]
  v_mfma_f32_32x32x16_bf16 v[80:95], v[24:27], v[140:143], v[80:95]
  v_mfma_f32_32x32x16_bf16 v[96:111], v[28:31], v[136:139], v[96:111]
  v_mfma_f32_32x32x16_bf16 v[112:127], v[28:31], v[140:143], v[112:127]
  s_lshl_b32 s27, s34, 14
  s_add_u32 s27, s27, s32
  s_add_u32 m0, s33, 2048
  s_add_u32 s28, s27, 8192
  buffer_load_dwordx4 v2, s[4:7], s27 offen lds
  s_add_u32 m0, s33, 3072
  s_nop 0
  buffer_load_dwordx4 v2, s[4:7], s28 offen lds
  s_lshl_b32 s27, s34, 10
  s_add_u32 s29, s30, s27
  s_add_u32 s28, s31, s27
  s_add_u32 s34, s34, 1
  s_cmp_eq_u32 s34, 14
  s_cselect_b32 s34, 0, s34
  buffer_load_dwordx4 v[136:139], v1, s[8:11], s29 offen sc1
  buffer_load_dwordx4 v[140:143], v1, s[8:11], s28 offen sc1
  s_waitcnt vmcnt(19)
  ds_read_b64_tr_b16 v[24:25], v3 offset:6144
  ds_read_b64_tr_b16 v[26:27], v3 offset:7168
  ds_read_b64_tr_b16 v[28:29], v3 offset:6400
  ds_read_b64_tr_b16 v[30:31], v3 offset:7424
  s_waitcnt lgkmcnt(4)
  v_mfma_f32_32x32x16_bf16 v[64:79], v[16:19], v[144:147], v[64:79]
  v_mfma_f32_32x32x16_bf16 v[80:95], v[16:19], v[148:151], v[80:95]
  v_mfma_f32_32x32x16_bf16 v[96:111], v[20:23], v[144:147], v[96:111]
  v_mfma_f32_32x32x16_bf16 v[112:127], v[20:23], v[148:151], v[112:127]
  s_lshl_b32 s27, s34, 14
  s_add_u32 s27, s27, s32
  s_add_u32 m0, s33, 4096
  s_add_u32 s28, s27, 8192
  buffer_load_dwordx4 v2, s[4:7], s27 offen lds
  s_add_u32 m0, s33, 5120
  s_nop 0
  buffer_load_dwordx4 v2, s[4:7], s28 offen lds
  s_lshl_b32 s27, s34, 10
  s_add_u32 s29, s30, s27
  s_add_u32 s28, s31, s27
  s_add_u32 s34, s34, 1
  s_cmp_eq_u32 s34, 14
  s_cselect_b32 s34, 0, s34
  buffer_load_dwordx4 v[144:147], v1, s[8:11], s29 offen sc1
  buffer_load_dwordx4 v[148:151], v1, s[8:11], s28 offen sc1
  s_waitcnt vmcnt(21)
  ds_read_b64_tr_b16 v[16:17], v3 offset:8192
  ds_read_b64_tr_b16 v[18:19], v3 offset:9216
  ds_read_b64_tr_b16 v[20:21], v3 offset:8448
  ds_read_b64_tr_b16 v[22:23], v3 offset:9472
  s_waitcnt lgkmcnt(4)
  v_mfma_f32_32x32x16_bf16 v[64:79], v[24:27], v[152:155], v[64:79]
  v_mfma_f32_32x32x16_bf16 v[80:95], v[24:27], v[156:159], v[80:95]
  v_mfma_f32_32x32x16_bf16 v[96:111], v[28:31], v[152:155], v[96:111]
  v_mfma_f32_32x32x16_bf16 v[112:127], v[28:31], v[156:159], v[112:127]
  s_lshl_b32 s27, s34, 14
  s_add_u32 s27, s27, s32
  s_add_u32 m0, s33, 6144
  s_add_u32 s28, s27, 8192
  buffer_load_dwordx4 v2, s[4:7], s27 offen lds
  s_add_u32 m0, s33, 7168
  s_nop 0
  buffer_load_dwordx4 v2, s[4:7], s28 offen lds
  s_lshl_b32 s27, s34, 10
  s_add_u32 s29, s30, s27
  s_add_u32 s28, s31, s27
  s_add_u32 s34, s34, 1
  s_cmp_eq_u32 s34, 14
  s_cselect_b32 s34, 0, s34
  buffer_load_dwordx4 v[152:155], v1, s[8:11], s29 offen sc1
  buffer_load_dwordx4 v[156:159], v1, s[8:11], s28 offen sc1
  s_waitcnt vmcnt(23)
  ds_read_b64_tr_b16 v[24:25], v3 offset:10240
  ds_read_b64_tr_b16 v[26:27], v3 offset:11264
  ds_read_b64_tr_b16 v[28:29], v3 offset:10496
  ds_read_b64_tr_b16 v[30:31], v3 offset:11520
  s_waitcnt lgkmcnt(4)
  v_mfma_f32_32x32x16_bf16 v[64:79], v[16:19], v[160:163], v[64:79]
  v_mfma_f32_32x32x16_bf16 v[80:95], v[16:19], v[164:167], v[80:95]
  v_mfma_f32_32x32x16_bf16 v[96:111], v[20:23], v[160:163], v[96:111]
  v_mfma_f32_32x32x16_bf16 v[112:127], v[20:23], v[164:167], v[112:127]
  s_lshl_b32 s27, s34, 14
  s_add_u32 s27, s27, s32
  s_add_u32 m0, s33, 8192
  s_add_u32 s28, s27, 8192
  buffer_load_dwordx4 v2, s[4:7], s27 offen lds
  s_add_u32 m0, s33, 9216
  s_nop 0
  buffer_load_dwordx4 v2, s[4:7], s28 offen lds
  s_lshl_b32 s27, s34, 10
  s_add_u32 s29, s30, s27
  s_add_u32 s28, s31, s27
  s_add_u32 s34, s34, 1
  s_cmp_eq_u32 s34, 14
  s_cselect_b32 s34, 0, s34
  buffer_load_dwordx4 v[160:163], v1, s[8:11], s29 offen sc1
  buffer_load_dwordx4 v[164:167], v1, s[8:11], s28 offen sc1
  s_waitcnt vmcnt(25)
  ds_read_b64_tr_b16 v[16:17], v3 offset:12288
  ds_read_b64_tr_b16 v[18:19], v3 offset:13312
  ds_read_b64_tr_b16 v[20:21], v3 offset:12544
  ds_read_b64_tr_b16 v[22:23], v3 offset:13568
  s_waitcnt lgkmcnt(4)
  v_mfma_f32_32x32x16_bf16 v[64:79], v[24:27], v[168:171], v[64:79]
  v_mfma_f32_32x32x16_bf16 v[80:95], v[24:27], v[172:175], v[80:95]
  v_mfma_f32_32x32x16_bf16 v[96:111], v[28:31], v[168:171], v[96:111]
  v_mfma_f32_32x32x16_bf16 v[112:127], v[28:31], v[172:175], v[112:127]
  s_lshl_b32 s27, s34, 14
  s_add_u32 s27, s27, s32
  s_add_u32 m0, s33, 10240
  s_add_u32 s28, s27, 8192
  buffer_load_dwordx4 v2, s[4:7], s27 offen lds
  s_add_u32 m0, s33, 11264
  s_nop 0
  buffer_load_dwordx4 v2, s[4:7], s28 offen lds
  s_lshl_b32 s27, s34, 10
  s_add_u32 s29, s30, s27
  s_add_u32 s28, s31, s27
  s_add_u32 s34, s34, 1
  s_cmp_eq_u32 s34, 14
  s_cselect_b32 s34, 0, s34
  buffer_load_dwordx4 v[168:171], v1, s[8:11], s29 offen sc1
  buffer_load_dwordx4 v[172:175], v1, s[8:11], s28 offen sc1
  s_waitcnt vmcnt(27)
  ds_read_b64_tr_b16 v[24:25], v3 offset:14336
  ds_read_b64_tr_b16 v[26:27], v3 offset:15360
  ds_read_b64_tr_b16 v[28:29], v3 offset:14592
  ds_read_b64_tr_b16 v[30:31], v3 offset:15616
  s_waitcnt lgkmcnt(4)
  v_mfma_f32_32x32x16_bf16 v[64:79], v[16:19], v[176:179], v[64:79]
  v_mfma_f32_32x32x16_bf16 v[80:95], v[16:19], v[180:183], v[80:95]
  v_mfma_f32_32x32x16_bf16 v[96:111], v[20:23], v[176:179], v[96:111]
  v_mfma_f32_32x32x16_bf16 v[112:127], v[20:23], v[180:183], v[112:127]
  s_waitcnt vmcnt(20)
  ds_read_b64_tr_b16 v[16:17], v3 offset:0
  ds_read_b64_tr_b16 v[18:19], v3 offset:1024
  ds_read_b64_tr_b16 v[20:21], v3 offset:256
  ds_read_b64_tr_b16 v[22:23], v3 offset:1280
  s_waitcnt lgkmcnt(4)
  v_mfma_f32_32x32x16_bf16 v[64:79], v[24:27], v[184:187], v[64:79]
  v_mfma_f32_32x32x16_bf16 v[80:95], v[24:27], v[188:191], v[80:95]
  v_mfma_f32_32x32x16_bf16 v[96:111], v[28:31], v[184:187], v[96:111]
  v_mfma_f32_32x32x16_bf16 v[112:127], v[28:31], v[188:191], v[112:127]
  s_waitcnt vmcnt(16)
  ds_read_b64_tr_b16 v[24:25], v3 offset:2048
  ds_read_b64_tr_b16 v[26:27], v3 offset:3072
  ds_read_b64_tr_b16 v[28:29], v3 offset:2304
  ds_read_b64_tr_b16 v[30:31], v3 offset:3328
  s_waitcnt lgkmcnt(4)
  v_mfma_f32_32x32x16_bf16 v[64:79], v[16:19], v[128:131], v[64:79]
  v_mfma_f32_32x32x16_bf16 v[80:95], v[16:19], v[132:135], v[80:95]
  v_mfma_f32_32x32x16_bf16 v[96:111], v[20:23], v[128:131], v[96:111]
  v_mfma_f32_32x32x16_bf16 v[112:127], v[20:23], v[132:135], v[112:127]
  s_waitcnt vmcnt(12)
  ds_read_b64_tr_b16 v[16:17], v3 offset:4096
  ds_read_b64_tr_b16 v[18:19], v3 offset:5120
  ds_read_b64_tr_b16 v[20:21], v3 offset:4352
  ds_read_b64_tr_b16 v[22:23], v3 offset:5376
  s_waitcnt lgkmcnt(4)
  v_mfma_f32_32x32x16_bf16 v[64:79], v[24:27], v[136:139], v[64:79]
  v_mfma_f32_32x32x16_bf16 v[80:95], v[24:27], v[140:143], v[80:95]
  v_mfma_f32_32x32x16_bf16 v[96:111], v[28:31], v[136:139], v[96:111]
  v_mfma_f32_32x32x16_bf16 v[112:127], v[28:31], v[140:143], v[112:127]
  s_waitcnt vmcnt(8)
  ds_read_b64_tr_b16 v[24:25], v3 offset:6144
  ds_read_b64_tr_b16 v[26:27], v3 offset:7168
  ds_read_b64_tr_b16 v[28:29], v3 offset:6400
  ds_read_b64_tr_b16 v[30:31], v3 offset:7424
  s_waitcnt lgkmcnt(4)
  v_mfma_f32_32x32x16_bf16 v[64:79], v[16:19], v[144:147], v[64:79]
  v_mfma_f32_32x32x16_bf16 v[80:95], v[16:19], v[148:151], v[80:95]
  v_mfma_f32_32x32x16_bf16 v[96:111], v[20:23], v[144:147], v[96:111]
  v_mfma_f32_32x32x16_bf16 v[112:127], v[20:23], v[148:151], v[112:127]
  s_waitcnt vmcnt(4)
  ds_read_b64_tr_b16 v[16:17], v3 offset:8192
  ds_read_b64_tr_b16 v[18:19], v3 offset:9216
  ds_read_b64_tr_b16 v[20:21], v3 offset:8448
  ds_read_b64_tr_b16 v[22:23], v3 offset:9472
  s_waitcnt lgkmcnt(4)
  v_mfma_f32_32x32x16_bf16 v[64:79], v[24:27], v[152:155], v[64:79]
  v_mfma_f32_32x32x16_bf16 v[80:95], v[24:27], v[156:159], v[80:95]
  v_mfma_f32_32x32x16_bf16 v[96:111], v[28:31], v[152:155], v[96:111]
  v_mfma_f32_32x32x16_bf16 v[112:127], v[28:31], v[156:159], v[112:127]
  s_waitcnt vmcnt(0)
  ds_read_b64_tr_b16 v[24:25], v3 offset:10240
  ds_read_b64_tr_b16 v[26:27], v3 offset:11264
  ds_read_b64_tr_b16 v[28:29], v3 offset:10496
  ds_read_b64_tr_b16 v[30:31], v3 offset:11520
  s_waitcnt lgkmcnt(4)
  v_mfma_f32_32x32x16_bf16 v[64:79], v[16:19], v[160:163], v[64:79]
  v_mfma_f32_32x32x16_bf16 v[80:95], v[16:19], v[164:167], v[80:95]
  v_mfma_f32_32x32x16_bf16 v[96:111], v[20:23], v[160:163], v[96:111]
  v_mfma_f32_32x32x16_bf16 v[112:127], v[20:23], v[164:167], v[112:127]
  s_waitcnt lgkmcnt(0)
  v_mfma_f32_32x32x16_bf16 v[64:79], v[24:27], v[168:171], v[64:79]
  v_mfma_f32_32x32x16_bf16 v[80:95], v[24:27], v[172:175], v[80:95]
  v_mfma_f32_32x32x16_bf16 v[96:111], v[28:31], v[168:171], v[96:111]
  v_mfma_f32_32x32x16_bf16 v[112:127], v[28:31], v[172:175], v[112:127]
  s_mul_i32 s27, s24, 18432
  v_add_u32 v4, s27, v1
  s_nop 7
  ds_write_b128 v4, v[64:67] offset:0
  ds_write_b128 v4, v[68:71] offset:1024
  ds_write_b128 v4, v[72:75] offset:2048
  ds_write_b128 v4, v[76:79] offset:3072
  ds_write_b128 v4, v[80:83] offset:4096
  ds_write_b128 v4, v[84:87] offset:5120
  ds_write_b128 v4, v[88:91] offset:6144
  ds_write_b128 v4, v[92:95] offset:7168
  ds_write_b128 v4, v[96:99] offset:8192
  ds_write_b128 v4, v[100:103] offset:9216
  ds_write_b128 v4, v[104:107] offset:10240
  ds_write_b128 v4, v[108:111] offset:11264
  ds_write_b128 v4, v[112:115] offset:12288
  ds_write_b128 v4, v[116:119] offset:13312
  ds_write_b128 v4, v[120:123] offset:14336
  ds_write_b128 v4, v[124:127] offset:15360
  s_waitcnt lgkmcnt(0)
  s_barrier
  s_lshr_b32 s27, s24, 1
  s_lshl_b32 s27, s27, 2
  s_lshl_b32 s28, s38, 1
  s_add_u32 s27, s27, s28
  s_lshl_b32 s27, s27, 10
  v_add_u32 v4, s27, v1
  v_add_u32 v5, 55296, v4
  v_add_u32 v6, 110592, v4
  ds_read_b128 v[64:67], v4 offset:0
  ds_read_b128 v[68:71], v4 offset:1024
  ds_read_b128 v[72:75], v4 offset:18432
  ds_read_b128 v[76:79], v4 offset:19456
  ds_read_b128 v[80:83], v4 offset:36864
  ds_read_b128 v[84:87], v4 offset:37888
  ds_read_b128 v[88:91], v5 offset:0
  ds_read_b128 v[92:95], v5 offset:1024
  s_waitcnt lgkmcnt(0)
  ds_read_b128 v[96:99], v5 offset:18432
  ds_read_b128 v[100:103], v5 offset:19456
  ds_read_b128 v[104:107], v5 offset:36864
  ds_read_b128 v[108:111], v5 offset:37888
  ds_read_b128 v[112:115], v6 offset:0
  ds_read_b128 v[116:119], v6 offset:1024
  ds_read_b128 v[120:123], v6 offset:18432
  ds_read_b128 v[124:127], v6 offset:19456
  s_waitcnt lgkmcnt(0)
  v_add_f32 v64, v64, v72
  v_add_f32 v65, v65, v73
  v_add_f32 v66, v66, v74
  v_add_f32 v67, v67, v75
  v_add_f32 v68, v68, v76
  v_add_f32 v69, v69, v77
  v_add_f32 v70, v70, v78
  v_add_f32 v71, v71, v79
  v_add_f32 v64, v64, v80
  v_add_f32 v65, v65, v81
  v_add_f32 v66, v66, v82
  v_add_f32 v67, v67, v83
  v_add_f32 v68, v68, v84
  v_add_f32 v69, v69, v85
  v_add_f32 v70, v70, v86
  v_add_f32 v71, v71, v87
  v_add_f32 v64, v64, v88
  v_add_f32 v65, v65, v89
  v_add_f32 v66, v66, v90
  v_add_f32 v67, v67, v91
  v_add_f32 v68, v68, v92
  v_add_f32 v69, v69, v93
  v_add_f32 v70, v70, v94
  v_add_f32 v71, v71, v95
  v_add_f32 v64, v64, v96
  v_add_f32 v65, v65, v97
  v_add_f32 v66, v66, v98
  v_add_f32 v67, v67, v99
  v_add_f32 v68, v68, v100
  v_add_f32 v69, v69, v101
  v_add_f32 v70, v70, v102
  v_add_f32 v71, v71, v103
  v_add_f32 v64, v64, v104
  v_add_f32 v65, v65, v105
  v_add_f32 v66, v66, v106
  v_add_f32 v67, v67, v107
  v_add_f32 v68, v68, v108
  v_add_f32 v69, v69, v109
  v_add_f32 v70, v70, v110
  v_add_f32 v71, v71, v111
  v_add_f32 v64, v64, v112
  v_add_f32 v65, v65, v113
  v_add_f32 v66, v66, v114
  v_add_f32 v67, v67, v115
  v_add_f32 v68, v68, v116
  v_add_f32 v69, v69, v117
  v_add_f32 v70, v70, v118
  v_add_f32 v71, v71, v119
  v_add_f32 v64, v64, v120
  v_add_f32 v65, v65, v121
  v_add_f32 v66, v66, v122
  v_add_f32 v67, v67, v123
  v_add_f32 v68, v68, v124
  v_add_f32 v69, v69, v125
  v_add_f32 v70, v70, v126
  v_add_f32 v71, v71, v127
  v_lshlrev_b32 v48, 16, v40
  v_and_b32 v49, 0xffff0000, v40
  v_lshlrev_b32 v50, 16, v41
  v_and_b32 v51, 0xffff0000, v41
  v_lshlrev_b32 v52, 16, v42
  v_and_b32 v53, 0xffff0000, v42
  v_lshlrev_b32 v54, 16, v43
  v_and_b32 v55, 0xffff0000, v43
  v_add_f32 v64, v64, v48
  v_add_f32 v65, v65, v49
  v_add_f32 v66, v66, v50
  v_add_f32 v67, v67, v51
  v_add_f32 v68, v68, v52
  v_add_f32 v69, v69, v53
  v_add_f32 v70, v70, v54
  v_add_f32 v71, v71, v55
  v_lshlrev_b32 v48, 16, v44
  v_and_b32 v49, 0xffff0000, v44
  v_lshlrev_b32 v50, 16, v45
  v_and_b32 v51, 0xffff0000, v45
  v_lshlrev_b32 v52, 16, v46
  v_and_b32 v53, 0xffff0000, v46
  v_lshlrev_b32 v54, 16, v47
  v_and_b32 v55, 0xffff0000, v47
  v_add_f32 v64, v64, v48
  v_add_f32 v65, v65, v49
  v_add_f32 v66, v66, v50
  v_add_f32 v67, v67, v51
  v_add_f32 v68, v68, v52
  v_add_f32 v69, v69, v53
  v_add_f32 v70, v70, v54
  v_add_f32 v71, v71, v55
  v_cvt_pk_bf16_f32 v48, v64, v65
  v_cvt_pk_bf16_f32 v49, v66, v67
  v_cvt_pk_bf16_f32 v50, v68, v69
  v_cvt_pk_bf16_f32 v51, v70, v71
  s_nop 1
  v_permlane32_swap_b32 v48, v50
  v_permlane32_swap_b32 v49, v51
  v_lshlrev_b32 v10, 10, v8
  v_lshl_add_u32 v10, v9, 4, v10
  s_lshl_b32 s27, s39, 15
  s_lshl_b32 s28, s40, 5
  s_add_u32 s27, s27, s28
  buffer_store_dwordx4 v[48:51], v10, s[16:19], s27 offen
  s_endpgm
  s_endpgm
  s_endpgm
sequential_preLN__compressed_kv_cla__dense_activation_squared_relu__prompt_kernel_end:
  s_endpgm
sequential_preLN__compressed_kv_cla__dense_activation_squared_relu__prompt_kernel_chk1_B:
  s_call_b64 s[70:71], sequential_preLN__compressed_kv_cla__dense_activation_squared_relu__prompt_kernel_slow1_3
  s_branch sequential_preLN__compressed_kv_cla__dense_activation_squared_relu__prompt_kernel_chk1_B_ret
sequential_preLN__compressed_kv_cla__dense_activation_squared_relu__prompt_kernel_chk0_B:
  s_call_b64 s[70:71], sequential_preLN__compressed_kv_cla__dense_activation_squared_relu__prompt_kernel_slow0_3
  s_branch sequential_preLN__compressed_kv_cla__dense_activation_squared_relu__prompt_kernel_chk0_B_ret
sequential_preLN__compressed_kv_cla__dense_activation_squared_relu__prompt_kernel_chk1_Bm:
  s_call_b64 s[70:71], sequential_preLN__compressed_kv_cla__dense_activation_squared_relu__prompt_kernel_slow1_3
  s_branch sequential_preLN__compressed_kv_cla__dense_activation_squared_relu__prompt_kernel_chk1_Bm_ret
sequential_preLN__compressed_kv_cla__dense_activation_squared_relu__prompt_kernel_chk0_Bm:
  s_call_b64 s[70:71], sequential_preLN__compressed_kv_cla__dense_activation_squared_relu__prompt_kernel_slow0_3
  s_branch sequential_preLN__compressed_kv_cla__dense_activation_squared_relu__prompt_kernel_chk0_Bm_ret
sequential_preLN__compressed_kv_cla__dense_activation_squared_relu__prompt_kernel_chk1_Bme:
  s_call_b64 s[70:71], sequential_preLN__compressed_kv_cla__dense_activation_squared_relu__prompt_kernel_slow1_3
  s_branch sequential_preLN__compressed_kv_cla__dense_activation_squared_relu__prompt_kernel_chk1_Bme_ret
sequential_preLN__compressed_kv_cla__dense_activation_squared_relu__prompt_kernel_chk0_Bme:
  s_call_b64 s[70:71], sequential_preLN__compressed_kv_cla__dense_activation_squared_relu__prompt_kernel_slow0_9
  s_branch sequential_preLN__compressed_kv_cla__dense_activation_squared_relu__prompt_kernel_chk0_Bme_ret
sequential_preLN__compressed_kv_cla__dense_activation_squared_relu__prompt_kernel_chk1_finB:
  s_call_b64 s[70:71], sequential_preLN__compressed_kv_cla__dense_activation_squared_relu__prompt_kernel_slow1_9
  s_branch sequential_preLN__compressed_kv_cla__dense_activation_squared_relu__prompt_kernel_chk1_finB_ret
sequential_preLN__compressed_kv_cla__dense_activation_squared_relu__prompt_kernel_chk1_A:
  s_call_b64 s[70:71], sequential_preLN__compressed_kv_cla__dense_activation_squared_relu__prompt_kernel_slow1_3
  s_branch sequential_preLN__compressed_kv_cla__dense_activation_squared_relu__prompt_kernel_chk1_A_ret
sequential_preLN__compressed_kv_cla__dense_activation_squared_relu__prompt_kernel_chk0_A:
  s_call_b64 s[70:71], sequential_preLN__compressed_kv_cla__dense_activation_squared_relu__prompt_kernel_slow0_3
  s_branch sequential_preLN__compressed_kv_cla__dense_activation_squared_relu__prompt_kernel_chk0_A_ret
sequential_preLN__compressed_kv_cla__dense_activation_squared_relu__prompt_kernel_chk1_Am:
  s_call_b64 s[70:71], sequential_preLN__compressed_kv_cla__dense_activation_squared_relu__prompt_kernel_slow1_3
  s_branch sequential_preLN__compressed_kv_cla__dense_activation_squared_relu__prompt_kernel_chk1_Am_ret
sequential_preLN__compressed_kv_cla__dense_activation_squared_relu__prompt_kernel_chk0_Am:
  s_call_b64 s[70:71], sequential_preLN__compressed_kv_cla__dense_activation_squared_relu__prompt_kernel_slow0_3
  s_branch sequential_preLN__compressed_kv_cla__dense_activation_squared_relu__prompt_kernel_chk0_Am_ret
sequential_preLN__compressed_kv_cla__dense_activation_squared_relu__prompt_kernel_chk1_Ame:
  s_call_b64 s[70:71], sequential_preLN__compressed_kv_cla__dense_activation_squared_relu__prompt_kernel_slow1_3
  s_branch sequential_preLN__compressed_kv_cla__dense_activation_squared_relu__prompt_kernel_chk1_Ame_ret
sequential_preLN__compressed_kv_cla__dense_activation_squared_relu__prompt_kernel_chk0_Ame:
  s_call_b64 s[70:71], sequential_preLN__compressed_kv_cla__dense_activation_squared_relu__prompt_kernel_slow0_9
  s_branch sequential_preLN__compressed_kv_cla__dense_activation_squared_relu__prompt_kernel_chk0_Ame_ret
sequential_preLN__compressed_kv_cla__dense_activation_squared_relu__prompt_kernel_chk1_finA:
  s_call_b64 s[70:71], sequential_preLN__compressed_kv_cla__dense_activation_squared_relu__prompt_kernel_slow1_9
  s_branch sequential_preLN__compressed_kv_cla__dense_activation_squared_relu__prompt_kernel_chk1_finA_ret
sequential_preLN__compressed_kv_cla__dense_activation_squared_relu__prompt_kernel_slow1_3:
  s_nop 15
  v_max3_f32 v89, v176, v177, v178
  v_max3_f32 v89, v89, v179, v180
  v_max3_f32 v89, v89, v181, v182
  v_max3_f32 v89, v89, v183, v184
  v_max3_f32 v89, v89, v185, v186
  v_max3_f32 v89, v89, v187, v188
  v_max3_f32 v89, v89, v189, v190
  v_max_f32 v89, v89, v191
  v_mov_b32 v90, v89
  s_nop 1
  v_permlane32_swap_b32 v89, v90
  s_nop 1
  v_max_f32 v89, v89, v90
  v_ceil_f32 v89, v89
  v_max_f32 v89, 0, v89
  v_sub_f32 v90, 0, v89
  v_exp_f32 v90, v90
  s_nop 0
  v_mul_f32 v192, v192, v90
  v_mul_f32 v193, v193, v90
  v_mul_f32 v194, v194, v90
  v_mul_f32 v195, v195, v90
  v_mul_f32 v196, v196, v90
  v_mul_f32 v197, v197, v90
  v_mul_f32 v198, v198, v90
  v_mul_f32 v199, v199, v90
  v_mul_f32 v200, v200, v90
  v_mul_f32 v201, v201, v90
  v_mul_f32 v202, v202, v90
  v_mul_f32 v203, v203, v90
  v_mul_f32 v204, v204, v90
  v_mul_f32 v205, v205, v90
  v_mul_f32 v206, v206, v90
  v_mul_f32 v207, v207, v90
  v_mul_f32 v208, v208, v90
  v_mul_f32 v209, v209, v90
  v_mul_f32 v210, v210, v90
  v_mul_f32 v211, v211, v90
  v_mul_f32 v212, v212, v90
  v_mul_f32 v213, v213, v90
  v_mul_f32 v214, v214, v90
  v_mul_f32 v215, v215, v90
  v_mul_f32 v216, v216, v90
  v_mul_f32 v217, v217, v90
  v_mul_f32 v218, v218, v90
  v_mul_f32 v219, v219, v90
  v_mul_f32 v220, v220, v90
  v_mul_f32 v221, v221, v90
  v_mul_f32 v222, v222, v90
  v_mul_f32 v223, v223, v90
  v_mul_f32 v224, v224, v90
  v_mul_f32 v225, v225, v90
  v_mul_f32 v226, v226, v90
  v_mul_f32 v227, v227, v90
  v_mul_f32 v228, v228, v90
  v_mul_f32 v229, v229, v90
  v_mul_f32 v230, v230, v90
  v_mul_f32 v231, v231, v90
  v_mul_f32 v232, v232, v90
  v_mul_f32 v233, v233, v90
  v_mul_f32 v234, v234, v90
  v_mul_f32 v235, v235, v90
  v_mul_f32 v236, v236, v90
  v_mul_f32 v237, v237, v90
  v_mul_f32 v238, v238, v90
  v_mul_f32 v239, v239, v90
  v_mul_f32 v240, v240, v90
  v_mul_f32 v241, v241, v90
  v_mul_f32 v242, v242, v90
  v_mul_f32 v243, v243, v90
  v_mul_f32 v244, v244, v90
  v_mul_f32 v245, v245, v90
  v_mul_f32 v246, v246, v90
  v_mul_f32 v247, v247, v90
  v_mul_f32 v248, v248, v90
  v_mul_f32 v249, v249, v90
  v_mul_f32 v250, v250, v90
  v_mul_f32 v251, v251, v90
  v_mul_f32 v252, v252, v90
  v_mul_f32 v253, v253, v90
  v_mul_f32 v254, v254, v90
  v_mul_f32 v255, v255, v90
  v_mul_f32 v86, v86, v90
  v_sub_f32 v160, v160, v89
  v_sub_f32 v161, v161, v89
  v_sub_f32 v162, v162, v89
  v_sub_f32 v163, v163, v89
  v_sub_f32 v164, v164, v89
  v_sub_f32 v165, v165, v89
  v_sub_f32 v166, v166, v89
  v_sub_f32 v167, v167, v89
  v_sub_f32 v168, v168, v89
  v_sub_f32 v169, v169, v89
  v_sub_f32 v170, v170, v89
  v_sub_f32 v171, v171, v89
  v_sub_f32 v172, v172, v89
  v_sub_f32 v173, v173, v89
  v_sub_f32 v174, v174, v89
  v_sub_f32 v175, v175, v89
  v_sub_f32 v176, v176, v89
  v_sub_f32 v177, v177, v89
  v_sub_f32 v178, v178, v89
  v_sub_f32 v179, v179, v89
  v_sub_f32 v180, v180, v89
  v_sub_f32 v181, v181, v89
  v_sub_f32 v182, v182, v89
  v_sub_f32 v183, v183, v89
  v_sub_f32 v184, v184, v89
  v_sub_f32 v185, v185, v89
  v_sub_f32 v186, v186, v89
  v_sub_f32 v187, v187, v89
  v_sub_f32 v188, v188, v89
  v_sub_f32 v189, v189, v89
  v_sub_f32 v190, v190, v89
  v_sub_f32 v191, v191, v89
  v_sub_f32 v128, v128, v89
  v_sub_f32 v129, v129, v89
  v_sub_f32 v130, v130, v89
  v_sub_f32 v131, v131, v89
  v_sub_f32 v132, v132, v89
  v_sub_f32 v133, v133, v89
  v_sub_f32 v134, v134, v89
  v_sub_f32 v135, v135, v89
  v_sub_f32 v136, v136, v89
  v_sub_f32 v137, v137, v89
  v_sub_f32 v138, v138, v89
  v_sub_f32 v139, v139, v89
  v_sub_f32 v140, v140, v89
  v_sub_f32 v141, v141, v89
  v_sub_f32 v142, v142, v89
  v_sub_f32 v143, v143, v89
  v_exp_f32 v80, v176
  v_exp_f32 v81, v177
  v_exp_f32 v82, v178
  v_add_f32 v85, v80, v81
  v_cvt_pk_bf16_f32 v152, v80, v81
  v_exp_f32 v83, v179
  v_add_f32 v85, v85, v82
  v_exp_f32 v80, v180
  v_add_f32 v85, v85, v83
  v_cvt_pk_bf16_f32 v153, v82, v83
  v_exp_f32 v81, v181
  v_add_f32 v85, v85, v80
  v_exp_f32 v82, v182
  v_add_f32 v85, v85, v81
  v_cvt_pk_bf16_f32 v154, v80, v81
  v_exp_f32 v83, v183
  v_add_f32 v85, v85, v82
  v_exp_f32 v80, v184
  v_add_f32 v85, v85, v83
  v_cvt_pk_bf16_f32 v155, v82, v83
  v_exp_f32 v81, v185
  v_add_f32 v85, v85, v80
  v_exp_f32 v82, v186
  v_add_f32 v85, v85, v81
  v_cvt_pk_bf16_f32 v156, v80, v81
  v_exp_f32 v83, v187
  v_add_f32 v85, v85, v82
  v_exp_f32 v80, v188
  v_add_f32 v85, v85, v83
  v_cvt_pk_bf16_f32 v157, v82, v83
  v_exp_f32 v81, v189
  v_add_f32 v85, v85, v80
  v_exp_f32 v82, v190
  v_add_f32 v85, v85, v81
  v_cvt_pk_bf16_f32 v158, v80, v81
  v_exp_f32 v83, v191
  v_add_f32 v85, v85, v82
  s_nop 0
  v_add_f32 v85, v85, v83
  v_cvt_pk_bf16_f32 v159, v82, v83
  s_nop 0
  v_exp_f32 v80, v160
  v_exp_f32 v81, v161
  v_exp_f32 v82, v162
  v_add_f32 v84, v80, v81
  v_cvt_pk_bf16_f32 v144, v80, v81
  v_exp_f32 v83, v163
  v_add_f32 v84, v84, v82
  s_nop 0
  s_nop 1
  s_setpc_b64 s[70:71]
sequential_preLN__compressed_kv_cla__dense_activation_squared_relu__prompt_kernel_slow0_3:
  s_nop 15
  v_max3_f32 v89, v160, v161, v162
  v_max3_f32 v89, v89, v163, v164
  v_max3_f32 v89, v89, v165, v166
  v_max3_f32 v89, v89, v167, v168
  v_max3_f32 v89, v89, v169, v170
  v_max3_f32 v89, v89, v171, v172
  v_max3_f32 v89, v89, v173, v174
  v_max_f32 v89, v89, v175
  v_mov_b32 v90, v89
  s_nop 1
  v_permlane32_swap_b32 v89, v90
  s_nop 1
  v_max_f32 v89, v89, v90
  v_ceil_f32 v89, v89
  v_max_f32 v89, 0, v89
  v_sub_f32 v90, 0, v89
  v_exp_f32 v90, v90
  s_nop 0
  v_mul_f32 v192, v192, v90
  v_mul_f32 v193, v193, v90
  v_mul_f32 v194, v194, v90
  v_mul_f32 v195, v195, v90
  v_mul_f32 v196, v196, v90
  v_mul_f32 v197, v197, v90
  v_mul_f32 v198, v198, v90
  v_mul_f32 v199, v199, v90
  v_mul_f32 v200, v200, v90
  v_mul_f32 v201, v201, v90
  v_mul_f32 v202, v202, v90
  v_mul_f32 v203, v203, v90
  v_mul_f32 v204, v204, v90
  v_mul_f32 v205, v205, v90
  v_mul_f32 v206, v206, v90
  v_mul_f32 v207, v207, v90
  v_mul_f32 v208, v208, v90
  v_mul_f32 v209, v209, v90
  v_mul_f32 v210, v210, v90
  v_mul_f32 v211, v211, v90
  v_mul_f32 v212, v212, v90
  v_mul_f32 v213, v213, v90
  v_mul_f32 v214, v214, v90
  v_mul_f32 v215, v215, v90
  v_mul_f32 v216, v216, v90
  v_mul_f32 v217, v217, v90
  v_mul_f32 v218, v218, v90
  v_mul_f32 v219, v219, v90
  v_mul_f32 v220, v220, v90
  v_mul_f32 v221, v221, v90
  v_mul_f32 v222, v222, v90
  v_mul_f32 v223, v223, v90
  v_mul_f32 v224, v224, v90
  v_mul_f32 v225, v225, v90
  v_mul_f32 v226, v226, v90
  v_mul_f32 v227, v227, v90
  v_mul_f32 v228, v228, v90
  v_mul_f32 v229, v229, v90
  v_mul_f32 v230, v230, v90
  v_mul_f32 v231, v231, v90
  v_mul_f32 v232, v232, v90
  v_mul_f32 v233, v233, v90
  v_mul_f32 v234, v234, v90
  v_mul_f32 v235, v235, v90
  v_mul_f32 v236, v236, v90
  v_mul_f32 v237, v237, v90
  v_mul_f32 v238, v238, v90
  v_mul_f32 v239, v239, v90
  v_mul_f32 v240, v240, v90
  v_mul_f32 v241, v241, v90
  v_mul_f32 v242, v242, v90
  v_mul_f32 v243, v243, v90
  v_mul_f32 v244, v244, v90
  v_mul_f32 v245, v245, v90
  v_mul_f32 v246, v246, v90
  v_mul_f32 v247, v247, v90
  v_mul_f32 v248, v248, v90
  v_mul_f32 v249, v249, v90
  v_mul_f32 v250, v250, v90
  v_mul_f32 v251, v251, v90
  v_mul_f32 v252, v252, v90
  v_mul_f32 v253, v253, v90
  v_mul_f32 v254, v254, v90
  v_mul_f32 v255, v255, v90
  v_mul_f32 v86, v86, v90
  v_sub_f32 v160, v160, v89
  v_sub_f32 v161, v161, v89
  v_sub_f32 v162, v162, v89
  v_sub_f32 v163, v163, v89
  v_sub_f32 v164, v164, v89
  v_sub_f32 v165, v165, v89
  v_sub_f32 v166, v166, v89
  v_sub_f32 v167, v167, v89
  v_sub_f32 v168, v168, v89
  v_sub_f32 v169, v169, v89
  v_sub_f32 v170, v170, v89
  v_sub_f32 v171, v171, v89
  v_sub_f32 v172, v172, v89
  v_sub_f32 v173, v173, v89
  v_sub_f32 v174, v174, v89
  v_sub_f32 v175, v175, v89
  v_sub_f32 v176, v176, v89
  v_sub_f32 v177, v177, v89
  v_sub_f32 v178, v178, v89
  v_sub_f32 v179, v179, v89
  v_sub_f32 v180, v180, v89
  v_sub_f32 v181, v181, v89
  v_sub_f32 v182, v182, v89
  v_sub_f32 v183, v183, v89
  v_sub_f32 v184, v184, v89
  v_sub_f32 v185, v185, v89
  v_sub_f32 v186, v186, v89
  v_sub_f32 v187, v187, v89
  v_sub_f32 v188, v188, v89
  v_sub_f32 v189, v189, v89
  v_sub_f32 v190, v190, v89
  v_sub_f32 v191, v191, v89
  v_sub_f32 v128, v128, v89
  v_sub_f32 v129, v129, v89
  v_sub_f32 v130, v130, v89
  v_sub_f32 v131, v131, v89
  v_sub_f32 v132, v132, v89
  v_sub_f32 v133, v133, v89
  v_sub_f32 v134, v134, v89
  v_sub_f32 v135, v135, v89
  v_sub_f32 v136, v136, v89
  v_sub_f32 v137, v137, v89
  v_sub_f32 v138, v138, v89
  v_sub_f32 v139, v139, v89
  v_sub_f32 v140, v140, v89
  v_sub_f32 v141, v141, v89
  v_sub_f32 v142, v142, v89
  v_sub_f32 v143, v143, v89
  v_exp_f32 v80, v160
  v_exp_f32 v81, v161
  v_exp_f32 v82, v162
  v_add_f32 v84, v80, v81
  v_cvt_pk_bf16_f32 v144, v80, v81
  v_exp_f32 v83, v163
  v_add_f32 v84, v84, v82
  v_exp_f32 v80, v164
  v_add_f32 v84, v84, v83
  v_cvt_pk_bf16_f32 v145, v82, v83
  v_exp_f32 v81, v165
  v_add_f32 v84, v84, v80
  v_exp_f32 v82, v166
  v_add_f32 v84, v84, v81
  v_cvt_pk_bf16_f32 v146, v80, v81
  v_exp_f32 v83, v167
  v_add_f32 v84, v84, v82
  v_exp_f32 v80, v168
  v_add_f32 v84, v84, v83
  v_cvt_pk_bf16_f32 v147, v82, v83
  v_exp_f32 v81, v169
  v_add_f32 v84, v84, v80
  v_exp_f32 v82, v170
  v_add_f32 v84, v84, v81
  v_cvt_pk_bf16_f32 v148, v80, v81
  v_exp_f32 v83, v171
  v_add_f32 v84, v84, v82
  v_exp_f32 v80, v172
  v_add_f32 v84, v84, v83
  v_cvt_pk_bf16_f32 v149, v82, v83
  v_exp_f32 v81, v173
  v_add_f32 v84, v84, v80
  v_exp_f32 v82, v174
  v_add_f32 v84, v84, v81
  v_cvt_pk_bf16_f32 v150, v80, v81
  v_exp_f32 v83, v175
  v_add_f32 v84, v84, v82
  s_nop 0
  v_add_f32 v84, v84, v83
  v_cvt_pk_bf16_f32 v151, v82, v83
  s_nop 0
  v_exp_f32 v80, v176
  v_exp_f32 v81, v177
  v_exp_f32 v82, v178
  v_add_f32 v85, v80, v81
  v_cvt_pk_bf16_f32 v152, v80, v81
  v_exp_f32 v83, v179
  v_add_f32 v85, v85, v82
  s_nop 0
  s_nop 1
  s_setpc_b64 s[70:71]
sequential_preLN__compressed_kv_cla__dense_activation_squared_relu__prompt_kernel_slow0_9:
  s_nop 15
  v_max3_f32 v89, v160, v161, v162
  v_max3_f32 v89, v89, v163, v164
  v_max3_f32 v89, v89, v165, v166
  v_max3_f32 v89, v89, v167, v168
  v_max3_f32 v89, v89, v169, v170
  v_max3_f32 v89, v89, v171, v172
  v_max3_f32 v89, v89, v173, v174
  v_max_f32 v89, v89, v175
  v_mov_b32 v90, v89
  s_nop 1
  v_permlane32_swap_b32 v89, v90
  s_nop 1
  v_max_f32 v89, v89, v90
  v_ceil_f32 v89, v89
  v_max_f32 v89, 0, v89
  v_sub_f32 v90, 0, v89
  v_exp_f32 v90, v90
  s_nop 0
  v_mul_f32 v192, v192, v90
  v_mul_f32 v193, v193, v90
  v_mul_f32 v194, v194, v90
  v_mul_f32 v195, v195, v90
  v_mul_f32 v196, v196, v90
  v_mul_f32 v197, v197, v90
  v_mul_f32 v198, v198, v90
  v_mul_f32 v199, v199, v90
  v_mul_f32 v200, v200, v90
  v_mul_f32 v201, v201, v90
  v_mul_f32 v202, v202, v90
  v_mul_f32 v203, v203, v90
  v_mul_f32 v204, v204, v90
  v_mul_f32 v205, v205, v90
  v_mul_f32 v206, v206, v90
  v_mul_f32 v207, v207, v90
  v_mul_f32 v208, v208, v90
  v_mul_f32 v209, v209, v90
  v_mul_f32 v210, v210, v90
  v_mul_f32 v211, v211, v90
  v_mul_f32 v212, v212, v90
  v_mul_f32 v213, v213, v90
  v_mul_f32 v214, v214, v90
  v_mul_f32 v215, v215, v90
  v_mul_f32 v216, v216, v90
  v_mul_f32 v217, v217, v90
  v_mul_f32 v218, v218, v90
  v_mul_f32 v219, v219, v90
  v_mul_f32 v220, v220, v90
  v_mul_f32 v221, v221, v90
  v_mul_f32 v222, v222, v90
  v_mul_f32 v223, v223, v90
  v_mul_f32 v224, v224, v90
  v_mul_f32 v225, v225, v90
  v_mul_f32 v226, v226, v90
  v_mul_f32 v227, v227, v90
  v_mul_f32 v228, v228, v90
  v_mul_f32 v229, v229, v90
  v_mul_f32 v230, v230, v90
  v_mul_f32 v231, v231, v90
  v_mul_f32 v232, v232, v90
  v_mul_f32 v233, v233, v90
  v_mul_f32 v234, v234, v90
  v_mul_f32 v235, v235, v90
  v_mul_f32 v236, v236, v90
  v_mul_f32 v237, v237, v90
  v_mul_f32 v238, v238, v90
  v_mul_f32 v239, v239, v90
  v_mul_f32 v240, v240, v90
  v_mul_f32 v241, v241, v90
  v_mul_f32 v242, v242, v90
  v_mul_f32 v243, v243, v90
  v_mul_f32 v244, v244, v90
  v_mul_f32 v245, v245, v90
  v_mul_f32 v246, v246, v90
  v_mul_f32 v247, v247, v90
  v_mul_f32 v248, v248, v90
  v_mul_f32 v249, v249, v90
  v_mul_f32 v250, v250, v90
  v_mul_f32 v251, v251, v90
  v_mul_f32 v252, v252, v90
  v_mul_f32 v253, v253, v90
  v_mul_f32 v254, v254, v90
  v_mul_f32 v255, v255, v90
  v_mul_f32 v86, v86, v90
  v_sub_f32 v160, v160, v89
  v_sub_f32 v161, v161, v89
  v_sub_f32 v162, v162, v89
  v_sub_f32 v163, v163, v89
  v_sub_f32 v164, v164, v89
  v_sub_f32 v165, v165, v89
  v_sub_f32 v166, v166, v89
  v_sub_f32 v167, v167, v89
  v_sub_f32 v168, v168, v89
  v_sub_f32 v169, v169, v89
  v_sub_f32 v170, v170, v89
  v_sub_f32 v171, v171, v89
  v_sub_f32 v172, v172, v89
  v_sub_f32 v173, v173, v89
  v_sub_f32 v174, v174, v89
  v_sub_f32 v175, v175, v89
  v_sub_f32 v176, v176, v89
  v_sub_f32 v177, v177, v89
  v_sub_f32 v178, v178, v89
  v_sub_f32 v179, v179, v89
  v_sub_f32 v180, v180, v89
  v_sub_f32 v181, v181, v89
  v_sub_f32 v182, v182, v89
  v_sub_f32 v183, v183, v89
  v_sub_f32 v184, v184, v89
  v_sub_f32 v185, v185, v89
  v_sub_f32 v186, v186, v89
  v_sub_f32 v187, v187, v89
  v_sub_f32 v188, v188, v89
  v_sub_f32 v189, v189, v89
  v_sub_f32 v190, v190, v89
  v_sub_f32 v191, v191, v89
  v_sub_f32 v128, v128, v89
  v_sub_f32 v129, v129, v89
  v_sub_f32 v130, v130, v89
  v_sub_f32 v131, v131, v89
  v_sub_f32 v132, v132, v89
  v_sub_f32 v133, v133, v89
  v_sub_f32 v134, v134, v89
  v_sub_f32 v135, v135, v89
  v_sub_f32 v136, v136, v89
  v_sub_f32 v137, v137, v89
  v_sub_f32 v138, v138, v89
  v_sub_f32 v139, v139, v89
  v_sub_f32 v140, v140, v89
  v_sub_f32 v141, v141, v89
  v_sub_f32 v142, v142, v89
  v_sub_f32 v143, v143, v89
  v_exp_f32 v80, v160
  v_exp_f32 v81, v161
  v_exp_f32 v82, v162
  v_add_f32 v84, v80, v81
  v_cvt_pk_bf16_f32 v144, v80, v81
  v_exp_f32 v83, v163
  v_add_f32 v84, v84, v82
  v_exp_f32 v80, v164
  v_add_f32 v84, v84, v83
  v_cvt_pk_bf16_f32 v145, v82, v83
  v_exp_f32 v81, v165
  v_add_f32 v84, v84, v80
  v_exp_f32 v82, v166
  v_add_f32 v84, v84, v81
  v_cvt_pk_bf16_f32 v146, v80, v81
  v_exp_f32 v83, v167
  v_add_f32 v84, v84, v82
  v_exp_f32 v80, v168
  v_add_f32 v84, v84, v83
  v_cvt_pk_bf16_f32 v147, v82, v83
  v_exp_f32 v81, v169
  v_add_f32 v84, v84, v80
  v_exp_f32 v82, v170
  v_add_f32 v84, v84, v81
  v_cvt_pk_bf16_f32 v148, v80, v81
  v_exp_f32 v83, v171
  v_add_f32 v84, v84, v82
  v_exp_f32 v80, v172
  v_add_f32 v84, v84, v83
  v_cvt_pk_bf16_f32 v149, v82, v83
  v_exp_f32 v81, v173
  v_add_f32 v84, v84, v80
  v_exp_f32 v82, v174
  v_add_f32 v84, v84, v81
  v_cvt_pk_bf16_f32 v150, v80, v81
  v_exp_f32 v83, v175
  v_add_f32 v84, v84, v82
  s_nop 0
  v_add_f32 v84, v84, v83
  v_cvt_pk_bf16_f32 v151, v82, v83
  s_nop 0
  s_nop 1
  s_setpc_b64 s[70:71]
sequential_preLN__compressed_kv_cla__dense_activation_squared_relu__prompt_kernel_slow1_9:
  s_nop 15
  v_max3_f32 v89, v176, v177, v178
  v_max3_f32 v89, v89, v179, v180
  v_max3_f32 v89, v89, v181, v182
  v_max3_f32 v89, v89, v183, v184
  v_max3_f32 v89, v89, v185, v186
  v_max3_f32 v89, v89, v187, v188
  v_max3_f32 v89, v89, v189, v190
  v_max_f32 v89, v89, v191
  v_mov_b32 v90, v89
  s_nop 1
  v_permlane32_swap_b32 v89, v90
  s_nop 1
  v_max_f32 v89, v89, v90
  v_ceil_f32 v89, v89
  v_max_f32 v89, 0, v89
  v_sub_f32 v90, 0, v89
  v_exp_f32 v90, v90
  s_nop 0
  v_mul_f32 v192, v192, v90
  v_mul_f32 v193, v193, v90
  v_mul_f32 v194, v194, v90
  v_mul_f32 v195, v195, v90
  v_mul_f32 v196, v196, v90
  v_mul_f32 v197, v197, v90
  v_mul_f32 v198, v198, v90
  v_mul_f32 v199, v199, v90
  v_mul_f32 v200, v200, v90
  v_mul_f32 v201, v201, v90
  v_mul_f32 v202, v202, v90
  v_mul_f32 v203, v203, v90
  v_mul_f32 v204, v204, v90
  v_mul_f32 v205, v205, v90
  v_mul_f32 v206, v206, v90
  v_mul_f32 v207, v207, v90
  v_mul_f32 v208, v208, v90
  v_mul_f32 v209, v209, v90
  v_mul_f32 v210, v210, v90
  v_mul_f32 v211, v211, v90
  v_mul_f32 v212, v212, v90
  v_mul_f32 v213, v213, v90
  v_mul_f32 v214, v214, v90
  v_mul_f32 v215, v215, v90
  v_mul_f32 v216, v216, v90
  v_mul_f32 v217, v217, v90
  v_mul_f32 v218, v218, v90
  v_mul_f32 v219, v219, v90
  v_mul_f32 v220, v220, v90
  v_mul_f32 v221, v221, v90
  v_mul_f32 v222, v222, v90
  v_mul_f32 v223, v223, v90
  v_mul_f32 v224, v224, v90
  v_mul_f32 v225, v225, v90
  v_mul_f32 v226, v226, v90
  v_mul_f32 v227, v227, v90
  v_mul_f32 v228, v228, v90
  v_mul_f32 v229, v229, v90
  v_mul_f32 v230, v230, v90
  v_mul_f32 v231, v231, v90
  v_mul_f32 v232, v232, v90
  v_mul_f32 v233, v233, v90
  v_mul_f32 v234, v234, v90
  v_mul_f32 v235, v235, v90
  v_mul_f32 v236, v236, v90
  v_mul_f32 v237, v237, v90
  v_mul_f32 v238, v238, v90
  v_mul_f32 v239, v239, v90
  v_mul_f32 v240, v240, v90
  v_mul_f32 v241, v241, v90
  v_mul_f32 v242, v242, v90
  v_mul_f32 v243, v243, v90
  v_mul_f32 v244, v244, v90
  v_mul_f32 v245, v245, v90
  v_mul_f32 v246, v246, v90
  v_mul_f32 v247, v247, v90
  v_mul_f32 v248, v248, v90
  v_mul_f32 v249, v249, v90
  v_mul_f32 v250, v250, v90
  v_mul_f32 v251, v251, v90
  v_mul_f32 v252, v252, v90
  v_mul_f32 v253, v253, v90
  v_mul_f32 v254, v254, v90
  v_mul_f32 v255, v255, v90
  v_mul_f32 v86, v86, v90
  v_sub_f32 v160, v160, v89
  v_sub_f32 v161, v161, v89
  v_sub_f32 v162, v162, v89
  v_sub_f32 v163, v163, v89
  v_sub_f32 v164, v164, v89
  v_sub_f32 v165, v165, v89
  v_sub_f32 v166, v166, v89
  v_sub_f32 v167, v167, v89
  v_sub_f32 v168, v168, v89
  v_sub_f32 v169, v169, v89
  v_sub_f32 v170, v170, v89
  v_sub_f32 v171, v171, v89
  v_sub_f32 v172, v172, v89
  v_sub_f32 v173, v173, v89
  v_sub_f32 v174, v174, v89
  v_sub_f32 v175, v175, v89
  v_sub_f32 v176, v176, v89
  v_sub_f32 v177, v177, v89
  v_sub_f32 v178, v178, v89
  v_sub_f32 v179, v179, v89
  v_sub_f32 v180, v180, v89
  v_sub_f32 v181, v181, v89
  v_sub_f32 v182, v182, v89
  v_sub_f32 v183, v183, v89
  v_sub_f32 v184, v184, v89
  v_sub_f32 v185, v185, v89
  v_sub_f32 v186, v186, v89
  v_sub_f32 v187, v187, v89
  v_sub_f32 v188, v188, v89
  v_sub_f32 v189, v189, v89
  v_sub_f32 v190, v190, v89
  v_sub_f32 v191, v191, v89
  v_sub_f32 v128, v128, v89
  v_sub_f32 v129, v129, v89
  v_sub_f32 v130, v130, v89
  v_sub_f32 v131, v131, v89
  v_sub_f32 v132, v132, v89
  v_sub_f32 v133, v133, v89
  v_sub_f32 v134, v134, v89
  v_sub_f32 v135, v135, v89
  v_sub_f32 v136, v136, v89
  v_sub_f32 v137, v137, v89
  v_sub_f32 v138, v138, v89
  v_sub_f32 v139, v139, v89
  v_sub_f32 v140, v140, v89
  v_sub_f32 v141, v141, v89
  v_sub_f32 v142, v142, v89
  v_sub_f32 v143, v143, v89
  v_exp_f32 v80, v176
  v_exp_f32 v81, v177
  v_exp_f32 v82, v178
  v_add_f32 v85, v80, v81
  v_cvt_pk_bf16_f32 v152, v80, v81
  v_exp_f32 v83, v179
  v_add_f32 v85, v85, v82
  v_exp_f32 v80, v180
  v_add_f32 v85, v85, v83
  v_cvt_pk_bf16_f32 v153, v82, v83
  v_exp_f32 v81, v181
  v_add_f32 v85, v85, v80
  v_exp_f32 v82, v182
  v_add_f32 v85, v85, v81
  v_cvt_pk_bf16_f32 v154, v80, v81
  v_exp_f32 v83, v183
  v_add_f32 v85, v85, v82
  v_exp_f32 v80, v184
  v_add_f32 v85, v85, v83
  v_cvt_pk_bf16_f32 v155, v82, v83
  v_exp_f32 v81, v185
  v_add_f32 v85, v85, v80
  v_exp_f32 v82, v186
  v_add_f32 v85, v85, v81
  v_cvt_pk_bf16_f32 v156, v80, v81
  v_exp_f32 v83, v187
  v_add_f32 v85, v85, v82
  v_exp_f32 v80, v188
  v_add_f32 v85, v85, v83
  v_cvt_pk_bf16_f32 v157, v82, v83
  v_exp_f32 v81, v189
  v_add_f32 v85, v85, v80
  v_exp_f32 v82, v190
  v_add_f32 v85, v85, v81
  v_cvt_pk_bf16_f32 v158, v80, v81
  v_exp_f32 v83, v191
  v_add_f32 v85, v85, v82
  s_nop 0
  v_add_f32 v85, v85, v83
  v_cvt_pk_bf16_f32 v159, v82, v83
  s_nop 0
  s_nop 1
  s_setpc_b64 s[70:71]
all_code_end:
  s_endpgm
.section .rodata,"a"
.p2align 6
.amdhsa_kernel sequential_preLN__compressed_kv_cla__dense_activation_squared_relu__prompt_kernel
  .amdhsa_next_free_vgpr 256
  .amdhsa_next_free_sgpr 102
  .amdhsa_accum_offset 256
  .amdhsa_group_segment_fixed_size 0
  .amdhsa_kernarg_size 112
  .amdhsa_user_sgpr_count 2
  .amdhsa_user_sgpr_kernarg_segment_ptr 1
  .amdhsa_system_sgpr_workgroup_id_x 1
  .amdhsa_float_denorm_mode_32 3
.end_amdhsa_kernel
```
